```python
import torch

def _softmax(x, axis=-1):
    return torch.softmax(x, dim=axis)

def _gelu(x):
    return torch.nn.functional.gelu(x, approximate='tanh')

def _silu(x):
    return torch.nn.functional.silu(x)

def _sigmoid(x):
    return torch.sigmoid(x)

def _layernorm(x, axis=-1, eps=1e-05):
    m = x.mean(dim=axis, keepdim=True)
    v = x.var(dim=axis, keepdim=True, unbiased=False)
    return (x - m) / torch.sqrt(v + eps)

def _scatter_add(tgt, idx, src, axis=0):
    return tgt.clone().index_add_(axis, idx, src)

def _segment_sum(src, seg, n):
    out = torch.zeros((n,) + src.shape[1:], dtype=src.dtype)
    return out.index_add_(0, seg, src)

def _pad(x, pw):
    flat = tuple((v for pair in reversed(pw) for v in pair))
    return torch.nn.functional.pad(x, flat)
kernel_name = 'sequential_preLN__memory_aug_recurrent_mem_tr__dense_activation_relu__prompt'

def setup_inputs():

    _w = lambda a: (lambda t: t.to(torch.bfloat16) if t.is_floating_point() else t)(torch.as_tensor(a))

    def _A_setup():
        B, S, Dm = (1, 2048, 512)
        H, Dh = (32, 128)
        M, seg = (8, 32)
        seg = min(seg, S)
        S = S // seg * seg
        return {'x': _w((lambda *s: torch.randn(*s, dtype=torch.bfloat16) * 0.05)(B, S, Dm)), 'mem0': _w((lambda *s: torch.randn(*s, dtype=torch.bfloat16) * 0.2)(B, M, Dm)), 'Wq': _w((lambda *s: torch.randn(*s, dtype=torch.bfloat16) * 1.6)(Dm, H, Dh) * Dm ** (-0.5)), 'Wk': _w((lambda *s: torch.randn(*s, dtype=torch.bfloat16) * 1.6)(Dm, H, Dh) * Dm ** (-0.5)), 'Wv': _w((lambda *s: torch.randn(*s, dtype=torch.bfloat16) * 0.2)(Dm, H, Dh) * Dm ** (-0.5)), 'Wo': _w((lambda *s: torch.randn(*s, dtype=torch.bfloat16) * 0.2)(H, Dh, Dm) * (H * Dh) ** (-0.5)), 'seg_len': seg}
    _A_in = _A_setup()

    def _B_setup():
        B, S, D, Dff = (1, 2048, 512, 1792)
        return {'x': _w((lambda *s: torch.randn(*s, dtype=torch.bfloat16) * 0.05)(B, S, D)), 'w1': _w((lambda *s: torch.randn(*s, dtype=torch.bfloat16) * 0.05)(D, Dff)), 'w2': _w((lambda *s: torch.randn(*s, dtype=torch.bfloat16) * 0.05)(Dff, D))}
    _B_in = _B_setup()
    return {'A_x': _A_in['x'], 'A_mem0': _A_in['mem0'], 'A_Wq': _A_in['Wq'], 'A_Wk': _A_in['Wk'], 'A_Wv': _A_in['Wv'], 'A_Wo': _A_in['Wo'], 'A_seg_len': _A_in['seg_len'], 'B_x': _B_in['x'], 'B_w1': _B_in['w1'], 'B_w2': _B_in['w2']}

def reference(A_x, A_mem0, A_Wq, A_Wk, A_Wv, A_Wo, A_seg_len, B_x, B_w1, B_w2):

    def _A_ref(x, mem0, Wq, Wk, Wv, Wo, seg_len):
        B, S, Dm = x.shape
        H, Dh = (Wq.shape[1], Wq.shape[2])
        M = mem0.shape[1]
        scale = Dh ** (-0.5)
        n_seg = S // seg_len
        L = M + seg_len
        idx = torch.arange(L)
        mask = (idx[:, None] < M) | (idx[:, None] >= idx[None, :])
        mem = mem0
        outs = []
        for s in range(n_seg):
            xs = x[:, s * seg_len:(s + 1) * seg_len, :].clone()
            h = torch.concatenate([mem, xs], axis=1)
            q = torch.einsum('btd,dhe->bhte', h, Wq)
            k = torch.einsum('btd,dhe->bhte', h, Wk)
            v = torch.einsum('btd,dhe->bhte', h, Wv)
            scores = torch.einsum('bhqe,bhke->bhqk', q, k) * scale
            scores = torch.where(mask[None, None], scores, -1000000000.0)
            p = _softmax(scores, axis=-1)
            o = torch.einsum('bhqk,bhke->bhqe', p, v)
            o = torch.einsum('bhte,hed->btd', o, Wo)
            mem = o[:, :M, :].clone()
            outs.append(o[:, M:, :])
        return torch.concatenate(outs, axis=1)

    def _B_ref(x, w1, w2):
        h = torch.einsum('bsd,df->bsf', x, w1)
        zero = torch.zeros_like(h)
        h = torch.maximum(h, zero)
        return torch.einsum('bsf,fd->bsd', h, w2)
    x = A_x
    h = x + _A_ref(_layernorm(x, axis=-1), A_mem0, A_Wq, A_Wk, A_Wv, A_Wo, A_seg_len)
    h2 = h + _B_ref(_layernorm(h, axis=-1), B_w1, B_w2)
    return h2
```

```asm
; @launch grid=(256,1,1) block=(256,1,1) lds=163840
.amdgcn_target "amdgcn-amd-amdhsa--gfx950"
.text
.globl sequential_preLN__memory_aug_recurrent_mem_tr__dense_activation_relu__prompt_kernel
.p2align 8
.type sequential_preLN__memory_aug_recurrent_mem_tr__dense_activation_relu__prompt_kernel,@function
sequential_preLN__memory_aug_recurrent_mem_tr__dense_activation_relu__prompt_kernel:
    s_cmp_ge_u32 s2, 256
    s_cbranch_scc1 L_end_1
    s_load_dwordx4 s[4:7], s[0:1], 88
    v_lshrrev_b32 v40, 6, v0
    s_nop 0
    v_readfirstlane_b32 s32, v40
    s_waitcnt lgkmcnt(0)
    s_cmp_lg_u32 s32, 0
    s_cbranch_scc1 L_el_skip_3
    s_getreg_b32 s58, hwreg(HW_REG_XCC_ID)
    s_and_b32 s58, s58, 15
    s_min_u32 s58, s58, 7
    s_mov_b64 exec, 1
    v_mov_b32 v41, 1
    v_mov_b32 v44, 0
    s_lshl_b32 s59, s58, 4
    v_mov_b32 v40, s59
    global_atomic_add v42, v40, v41, s[4:5] sc0
    s_mov_b32 s33, -1
    s_mov_b32 s35, -1
    s_waitcnt vmcnt(0)
    s_nop 0
    v_readfirstlane_b32 s36, v42
    s_nop 3
    s_cmp_ge_u32 s36, 32
    s_cbranch_scc1 L_el_surp_5
    s_cmp_lg_u32 s58, 0
    s_cbranch_scc1 L_el_work_6
    s_mov_b32 s33, s36
    s_branch L_el_done_4
L_el_work_6:
    s_sub_u32 s35, s58, 1
    s_branch L_el_done_4
L_el_surp_5:
    global_atomic_add v42, v44, v41, s[4:5] offset:204 sc0
    s_waitcnt vmcnt(0)
    s_nop 0
    v_readfirstlane_b32 s83, v42
    s_nop 3
    s_mov_b64 exec, 0xff
    v_mbcnt_lo_u32_b32 v40, -1, 0
    v_lshlrev_b32 v40, 4, v40
    s_mov_b32 s61, 0
L_el_swait_7:
    global_load_dword v42, v40, s[4:5] sc1
    s_waitcnt vmcnt(0)
    s_mov_b32 s84, 0
    v_readlane_b32 s86, v42, 0
    v_readlane_b32 s87, v42, 1
    v_readlane_b32 s88, v42, 2
    v_readlane_b32 s89, v42, 3
    v_readlane_b32 s90, v42, 4
    v_readlane_b32 s91, v42, 5
    v_readlane_b32 s92, v42, 6
    v_readlane_b32 s93, v42, 7
    s_nop 3
    s_add_u32 s84, s84, s86
    s_add_u32 s84, s84, s87
    s_add_u32 s84, s84, s88
    s_add_u32 s84, s84, s89
    s_add_u32 s84, s84, s90
    s_add_u32 s84, s84, s91
    s_add_u32 s84, s84, s92
    s_add_u32 s84, s84, s93
    s_cmp_ge_u32 s84, 256
    s_cbranch_scc1 L_el_sscan_8
    s_add_u32 s61, s61, 1
    s_cmp_lt_u32 s61, 0x100000
    s_cbranch_scc0 L_el_snone_9
    s_sleep 8
    s_branch L_el_swait_7
L_el_sscan_8:
    s_min_u32 s84, s86, 32
    s_sub_u32 s85, 32, s84
    s_cmp_lt_u32 s83, s85
    s_cbranch_scc0 L_el_x_10
    s_add_u32 s36, s84, s83
    s_mov_b32 s33, s36
    s_branch L_el_snone_9
L_el_x_10:
    s_sub_u32 s83, s83, s85
    s_min_u32 s84, s87, 32
    s_sub_u32 s85, 32, s84
    s_cmp_lt_u32 s83, s85
    s_cbranch_scc0 L_el_x_11
    s_add_u32 s36, s84, s83
    s_mov_b32 s35, 0
    s_branch L_el_snone_9
L_el_x_11:
    s_sub_u32 s83, s83, s85
    s_min_u32 s84, s88, 32
    s_sub_u32 s85, 32, s84
    s_cmp_lt_u32 s83, s85
    s_cbranch_scc0 L_el_x_12
    s_add_u32 s36, s84, s83
    s_mov_b32 s35, 1
    s_branch L_el_snone_9
L_el_x_12:
    s_sub_u32 s83, s83, s85
    s_min_u32 s84, s89, 32
    s_sub_u32 s85, 32, s84
    s_cmp_lt_u32 s83, s85
    s_cbranch_scc0 L_el_x_13
    s_add_u32 s36, s84, s83
    s_mov_b32 s35, 2
    s_branch L_el_snone_9
L_el_x_13:
    s_sub_u32 s83, s83, s85
    s_min_u32 s84, s90, 32
    s_sub_u32 s85, 32, s84
    s_cmp_lt_u32 s83, s85
    s_cbranch_scc0 L_el_x_14
    s_add_u32 s36, s84, s83
    s_mov_b32 s35, 3
    s_branch L_el_snone_9
L_el_x_14:
    s_sub_u32 s83, s83, s85
    s_min_u32 s84, s91, 32
    s_sub_u32 s85, 32, s84
    s_cmp_lt_u32 s83, s85
    s_cbranch_scc0 L_el_x_15
    s_add_u32 s36, s84, s83
    s_mov_b32 s35, 4
    s_branch L_el_snone_9
L_el_x_15:
    s_sub_u32 s83, s83, s85
    s_min_u32 s84, s92, 32
    s_sub_u32 s85, 32, s84
    s_cmp_lt_u32 s83, s85
    s_cbranch_scc0 L_el_x_16
    s_add_u32 s36, s84, s83
    s_mov_b32 s35, 5
    s_branch L_el_snone_9
L_el_x_16:
    s_sub_u32 s83, s83, s85
    s_min_u32 s84, s93, 32
    s_sub_u32 s85, 32, s84
    s_cmp_lt_u32 s83, s85
    s_cbranch_scc0 L_el_x_17
    s_add_u32 s36, s84, s83
    s_mov_b32 s35, 6
    s_branch L_el_snone_9
L_el_x_17:
    s_sub_u32 s83, s83, s85
L_el_snone_9:
    s_mov_b64 exec, 1
L_el_done_4:
    v_mov_b32 v40, s33
    v_mov_b32 v42, s35
    v_mov_b32 v43, s36
    v_mov_b32 v44, 0
    ds_write_b128 v44, v[40:43]
    s_waitcnt lgkmcnt(0)
    s_mov_b64 exec, -1
L_el_skip_3:
    s_barrier
    v_mov_b32 v44, 0
    ds_read_b128 v[40:43], v44
    s_waitcnt lgkmcnt(0)
    s_nop 0
    v_readfirstlane_b32 s33, v40
    v_readfirstlane_b32 s35, v42
    v_readfirstlane_b32 s36, v43
    s_nop 3
    s_barrier
    s_cmp_eq_u32 s33, -1
    s_cbranch_scc1 L_worker_2
    s_load_dwordx4 s[44:47], s[0:1], 8
    s_load_dwordx4 s[48:51], s[0:1], 24
    s_load_dwordx2 s[52:53], s[0:1], 40
    s_waitcnt lgkmcnt(0)
    s_mov_b32 s8, s6
    s_and_b32 s9, s7, 0xffff
    s_mov_b32 s10, 0x10000000
    s_mov_b32 s11, 0x20000
    s_mov_b32 s28, s44
    s_and_b32 s29, s45, 0xffff
    s_mov_b32 s30, 0x2000
    s_mov_b32 s31, 0x20000
    s_mov_b32 s12, s46
    s_and_b32 s13, s47, 0xffff
    s_mov_b32 s14, 0x400000
    s_mov_b32 s15, 0x20000
    s_mov_b32 s16, s48
    s_and_b32 s17, s49, 0xffff
    s_mov_b32 s18, 0x400000
    s_mov_b32 s19, 0x20000
    s_mov_b32 s20, s50
    s_and_b32 s21, s51, 0xffff
    s_mov_b32 s22, 0x400000
    s_mov_b32 s23, 0x20000
    s_mov_b32 s24, s52
    s_and_b32 s25, s53, 0xffff
    s_mov_b32 s26, 0x400000
    s_mov_b32 s27, 0x20000
    s_mov_b32 s63, 0
    v_and_b32 v40, 63, v0
    v_and_b32 v41, 15, v0
    v_lshrrev_b32 v42, 4, v40
    v_lshrrev_b32 v43, 1, v41
    v_and_b32 v43, 1, v43
    v_lshrrev_b32 v44, 2, v41
    v_lshlrev_b32 v44, 1, v44
    v_and_b32 v45, 1, v41
    v_add_u32 v44, v44, v45
    v_mov_b32 v0, 0x4444
    v_mov_b32 v46, 0xeeee
    v_cmp_eq_u32 vcc, 1, v43
    s_nop 1
    v_cndmask_b32 v0, v0, v46, vcc
    v_mov_b32 v46, 0x3f80
    v_mov_b32 v47, 0x3f800000
    v_cmp_eq_u32 vcc, 1, v45
    s_nop 1
    v_cndmask_b32 v4, v46, v47, vcc
    v_mov_b32 v5, v4
    v_mov_b32 v6, v4
    v_mov_b32 v7, v4
    v_lshrrev_b32 v48, 2, v41
    v_and_b32 v48, 1, v48
    v_cmp_eq_u32 vcc, 1, v48
    s_nop 1
    v_cndmask_b32 v48, v46, v47, vcc
    v_and_b32 v49, 3, v41
    v_cmp_eq_u32 vcc, 0, v49
    s_nop 1
    v_cndmask_b32 v8, 0, v48, vcc
    v_cmp_eq_u32 vcc, 1, v49
    s_nop 1
    v_cndmask_b32 v9, 0, v48, vcc
    v_cmp_eq_u32 vcc, 2, v49
    s_nop 1
    v_cndmask_b32 v10, 0, v48, vcc
    v_cmp_eq_u32 vcc, 3, v49
    s_nop 1
    v_cndmask_b32 v11, 0, v48, vcc
    s_lshl_b32 s58, s32, 11
    v_lshlrev_b32 v1, 4, v40
    v_add_u32 v1, s58, v1
    v_lshrrev_b32 v46, 2, v41
    v_lshl_add_u32 v46, v42, 2, v46
    v_lshlrev_b32 v46, 6, v46
    v_lshl_add_u32 v46, v49, 4, v46
    s_lshl_b32 s58, s32, 11
    v_add_u32 v2, s58, v46
    s_mul_i32 s58, s32, 65536
    s_lshl_b32 s59, s33, 6
    s_add_u32 s58, s58, s59
    v_mul_u32_u24 v46, 8192, v42
    v_lshrrev_b32 v47, 2, v41
    v_lshl_add_u32 v46, v47, 11, v46
    v_lshl_add_u32 v46, v49, 4, v46
    v_add_u32 v3, s58, v46
    s_and_b32 s58, s33, 3
    s_lshl_b32 s58, s58, 11
    s_lshr_b32 s59, s33, 2
    s_lshl_b32 s59, s59, 7
    s_add_u32 s58, s58, s59
    s_lshl_b32 s59, s32, 5
    s_add_u32 s58, s58, s59
    v_and_b32 v46, 1, v42
    v_lshlrev_b32 v46, 10, v46
    v_lshl_add_u32 v46, v49, 3, v46
    v_add_u32 v50, s58, v46
    v_lshrrev_b32 v47, 1, v42
    v_lshrrev_b32 v48, 2, v41
    v_or_b32 v47, v47, v48
    v_mov_b32 v46, 0x70000000
    v_cmp_eq_u32 vcc, 0, v47
    s_nop 1
    v_cndmask_b32 v27, v46, v50, vcc
    s_lshl_b32 s58, s32, 1
    s_and_b32 s59, s58, 3
    s_lshl_b32 s59, s59, 2
    v_xor_b32 v46, s59, v40
    v_lshlrev_b32 v12, 4, v46
    s_lshl_b32 s58, s58, 10
    s_add_u32 s58, s58, 147456
    v_add_u32 v12, s58, v12
    v_xor_b32 v13, 64, v12
    v_add_u32 v13, 1024, v13
    v_lshlrev_b32 v46, 1, v42
    v_add_u32 v46, v46, v43
    v_and_b32 v47, 1, v44
    v_lshlrev_b32 v47, 2, v47
    v_xor_b32 v46, v46, v47
    v_lshlrev_b32 v46, 4, v46
    v_lshrrev_b32 v47, 1, v44
    v_and_b32 v47, 1, v47
    v_lshlrev_b32 v47, 7, v47
    v_lshlrev_b32 v48, 10, v44
    v_add_u32 v48, v48, v46
    v_add_u32 v48, 147456, v48
    v_add_u32 v14, v48, v47
    v_sub_u32 v15, v48, v47
    v_mul_u32_u24 v46, 288, v44
    v_add_u32 v46, 147456, v46
    v_lshl_add_u32 v24, v42, 4, v46
    s_lshl_b32 s58, s32, 6
    v_lshl_add_u32 v46, v42, 3, v46
    v_lshl_add_u32 v46, v43, 2, v46
    v_add_u32 v19, s58, v46
    s_lshl_b32 s58, s32, 10
    v_lshlrev_b32 v46, 5, v41
    v_lshrrev_b32 v47, 3, v41
    v_lshlrev_b32 v47, 7, v47
    v_xor_b32 v46, v46, v47
    v_lshrrev_b32 v47, 2, v41
    v_xor_b32 v47, v47, v42
    v_and_b32 v47, 3, v47
    v_lshl_add_u32 v46, v47, 3, v46
    v_add_u32 v46, s58, v46
    v_add_u32 v16, 155648, v46
    v_lshlrev_b32 v46, 8, v42
    v_lshrrev_b32 v47, 2, v41
    v_lshl_add_u32 v46, v47, 5, v46
    v_and_b32 v47, 1, v42
    v_lshl_add_u32 v46, v47, 7, v46
    v_lshlrev_b32 v47, 1, v42
    v_and_b32 v47, 3, v47
    v_and_b32 v48, 3, v41
    v_xor_b32 v47, v47, v48
    v_lshl_add_u32 v46, v47, 3, v46
    v_add_u32 v17, 155648, v46
    v_xor_b32 v18, 136, v17
    v_or_b32 v46, 0, v42
    v_xor_b32 v46, v46, v41
    v_lshlrev_b32 v46, 4, v46
    v_lshl_add_u32 v46, v41, 8, v46
    v_add_u32 v20, 131072, v46
    v_or_b32 v46, 4, v42
    v_xor_b32 v46, v46, v41
    v_lshlrev_b32 v46, 4, v46
    v_lshl_add_u32 v46, v41, 8, v46
    v_add_u32 v21, 131072, v46
    v_or_b32 v46, 8, v42
    v_xor_b32 v46, v46, v41
    v_lshlrev_b32 v46, 4, v46
    v_lshl_add_u32 v46, v41, 8, v46
    v_add_u32 v22, 131072, v46
    v_or_b32 v46, 12, v42
    v_xor_b32 v46, v46, v41
    v_lshlrev_b32 v46, 4, v46
    v_lshl_add_u32 v46, v41, 8, v46
    v_add_u32 v23, 131072, v46
    s_lshl_b32 s58, s32, 14
    v_lshlrev_b32 v25, 4, v40
    v_add_u32 v25, s58, v25
    v_add_u32 v26, 0x10000, v25
    v_mov_b32 v28, 0
    v_mov_b32 v29, 0
    v_mov_b32 v30, 0
    v_mov_b32 v31, 0
    v_mov_b32 v32, 0
    v_mov_b32 v33, 0
    v_mov_b32 v34, 0
    v_mov_b32 v35, 0
    s_mov_b32 s62, 0x3e0293ee
    v_cmp_eq_u32 s[100:101], 0, v43
    v_lshlrev_b32 v46, 13, v42
    v_lshl_add_u32 v46, v41, 4, v46
    v_lshrrev_b32 v47, 5, v40
    v_lshlrev_b32 v47, 10, v47
    v_and_b32 v48, 31, v40
    v_lshl_add_u32 v47, v48, 4, v47
    v_mov_b32 v52, -1
    v_mov_b32 v53, -1
    v_mov_b32 v54, -1
    v_mov_b32 v55, -1
    s_mul_i32 s58, s33, 8192
    s_add_u32 s58, s58, 0x4000000
    s_add_u32 s59, s58, 0x40000
    buffer_store_dwordx4 v[52:55], v1, s[8:11], s58 offen sc1
    buffer_store_dwordx4 v[52:55], v1, s[8:11], s58 offen offset:1024 sc1
    s_mov_b32 s58, 0x4102000
    buffer_store_dwordx2 v[52:53], v27, s[8:11], s58 offen sc1
    s_mov_b32 s58, 0x4104000
    buffer_store_dwordx2 v[52:53], v27, s[8:11], s58 offen sc1
    s_and_b32 s58, s33, 3
    s_lshl_b32 s58, s58, 11
    s_lshr_b32 s59, s33, 2
    s_lshl_b32 s59, s59, 7
    s_add_u32 s58, s58, s59
    s_lshl_b32 s59, s32, 3
    s_add_u32 s58, s58, s59
    v_and_b32 v56, 1, v42
    v_lshlrev_b32 v56, 10, v56
    v_and_b32 v57, 3, v41
    v_lshl_add_u32 v56, v57, 1, v56
    v_add_u32 v60, s58, v56
    buffer_load_ushort v56, v60, s[28:31], 0 offen offset:0
    buffer_load_ushort v57, v60, s[28:31], 0 offen offset:32
    buffer_load_ushort v58, v60, s[28:31], 0 offen offset:64
    buffer_load_ushort v59, v60, s[28:31], 0 offen offset:96
    s_lshl_b32 s99, s33, 2
    s_or_b32 s99, s99, s32
    s_mov_b32 s58, 0xa000000
    s_cmp_eq_u32 s99, 0
    s_cselect_b32 s99, s58, 0x70000000
    v_mov_b32 v61, 0
    buffer_store_dword v61, off, s[8:11], s99 sc1
    s_lshl_b32 s94, s33, 2
    s_add_u32 s94, s94, 0xa000a00
    s_cmp_eq_u32 s32, 0
    s_cselect_b32 s94, s94, 0x70000000
    buffer_store_dword v61, off, s[8:11], s94 sc1
    s_lshl_b32 s58, s32, 18
    s_lshl_b32 s59, s33, 8
    s_add_u32 s58, s58, s59
    s_lshl_b32 s59, s32, 13
    s_add_u32 s59, s59, 98304
    s_add_u32 s60, s59, 8192
L_wdma_19:
    s_mov_b32 m0, s59
    s_add_u32 s59, s59, 1024
    buffer_load_dwordx4 v46, s[12:15], s58 offen lds
    s_add_u32 s58, s58, 0x8000
    s_cmp_lt_u32 s59, s60
    s_cbranch_scc1 L_wdma_19
    s_lshl_b32 s58, s32, 18
    s_lshl_b32 s59, s33, 8
    s_add_u32 s58, s58, s59
    s_add_u32 s58, s58, 0x100000
    s_lshl_b32 s59, s32, 13
    s_add_u32 s59, s59, 131072
    s_add_u32 s60, s59, 8192
L_wdma_20:
    s_mov_b32 m0, s59
    s_add_u32 s59, s59, 1024
    buffer_load_dwordx4 v46, s[12:15], s58 offen lds
    s_add_u32 s58, s58, 0x8000
    s_cmp_lt_u32 s59, s60
    s_cbranch_scc1 L_wdma_20
    s_lshl_b32 s58, s32, 18
    s_lshl_b32 s59, s33, 8
    s_add_u32 s58, s58, s59
    s_add_u32 s58, s58, 0x200000
    s_lshl_b32 s59, s32, 13
    s_add_u32 s59, s59, 0
    s_add_u32 s60, s59, 8192
L_wdma_21:
    s_mov_b32 m0, s59
    s_add_u32 s59, s59, 1024
    buffer_load_dwordx4 v46, s[12:15], s58 offen lds
    s_add_u32 s58, s58, 0x8000
    s_cmp_lt_u32 s59, s60
    s_cbranch_scc1 L_wdma_21
    s_lshl_b32 s58, s32, 18
    s_lshl_b32 s59, s33, 8
    s_add_u32 s58, s58, s59
    s_add_u32 s58, s58, 0x300000
    s_lshl_b32 s59, s32, 13
    s_add_u32 s59, s59, 32768
    s_add_u32 s60, s59, 8192
L_wdma_22:
    s_mov_b32 m0, s59
    s_add_u32 s59, s59, 1024
    buffer_load_dwordx4 v46, s[12:15], s58 offen lds
    s_add_u32 s58, s58, 0x8000
    s_cmp_lt_u32 s59, s60
    s_cbranch_scc1 L_wdma_22
    v_lshrrev_b32 v50, 2, v41
    v_and_b32 v51, 1, v50
    v_lshlrev_b32 v51, 4, v51
    v_lshrrev_b32 v50, 1, v50
    v_lshl_add_u32 v50, v50, 1, v51
    v_lshrrev_b32 v51, 1, v42
    v_lshl_add_u32 v50, v51, 2, v50
    v_and_b32 v51, 1, v42
    v_add_u32 v50, v50, v51
    v_and_b32 v51, 3, v41
    v_lshlrev_b32 v51, 3, v51
    v_lshl_add_u32 v48, v50, 8, v51
    s_lshl_b32 s58, s32, 6
    v_add_u32 v48, s58, v48
    v_lshrrev_b32 v49, 1, v42
    v_lshlrev_b32 v49, 3, v49
    v_and_b32 v50, 1, v42
    v_lshl_add_u32 v49, v50, 2, v49
    v_lshrrev_b32 v50, 2, v41
    v_add_u32 v49, v49, v50
    v_lshl_add_u32 v49, v49, 9, v51
    s_lshl_b32 s58, s32, 7
    v_add_u32 v49, s58, v49
    s_lshl_b32 s58, s32, 13
    v_lshlrev_b32 v50, 4, v40
    v_add_u32 v50, s58, v50
    s_waitcnt vmcnt(32)
    v_lshl_or_b32 v56, v57, 16, v56
    v_lshl_or_b32 v57, v59, 16, v58
    v_min_u32 v56, -2, v56
    v_min_u32 v57, -2, v57
    s_mov_b32 s58, 0x4100000
    buffer_store_dwordx2 v[56:57], v27, s[8:11], s58 offen sc1
    s_waitcnt vmcnt(24)
    s_barrier
    s_lshl_b32 s58, s32, 18
    s_lshl_b32 s59, s33, 8
    s_add_u32 s58, s58, s59
    s_lshl_b32 s59, s32, 13
    s_add_u32 s59, s59, 65536
    s_add_u32 s60, s59, 8192
L_wdma_24:
    s_mov_b32 m0, s59
    s_add_u32 s59, s59, 1024
    buffer_load_dwordx4 v46, s[16:19], s58 offen lds
    s_add_u32 s58, s58, 0x8000
    s_cmp_lt_u32 s59, s60
    s_cbranch_scc1 L_wdma_24
    v_add_u32 v51, 98304, v48
    ds_read_b64_tr_b16 a[0:1], v51 offset:0
    ds_read_b64_tr_b16 a[2:3], v51 offset:8192
    ds_read_b64_tr_b16 a[4:5], v51 offset:2048
    ds_read_b64_tr_b16 a[6:7], v51 offset:10240
    ds_read_b64_tr_b16 a[64:65], v51 offset:32
    ds_read_b64_tr_b16 a[66:67], v51 offset:8224
    ds_read_b64_tr_b16 a[68:69], v51 offset:2080
    ds_read_b64_tr_b16 a[70:71], v51 offset:10272
    ds_read_b64_tr_b16 a[8:9], v51 offset:16384
    ds_read_b64_tr_b16 a[10:11], v51 offset:24576
    ds_read_b64_tr_b16 a[12:13], v51 offset:18432
    ds_read_b64_tr_b16 a[14:15], v51 offset:26624
    ds_read_b64_tr_b16 a[72:73], v51 offset:16416
    ds_read_b64_tr_b16 a[74:75], v51 offset:24608
    ds_read_b64_tr_b16 a[76:77], v51 offset:18464
    ds_read_b64_tr_b16 a[78:79], v51 offset:26656
    s_waitcnt lgkmcnt(0)
    s_waitcnt vmcnt(24)
    s_barrier
    s_lshl_b32 s58, s32, 18
    s_lshl_b32 s59, s33, 8
    s_add_u32 s58, s58, s59
    s_add_u32 s58, s58, 0x100000
    s_lshl_b32 s59, s32, 13
    s_add_u32 s59, s59, 98304
    s_add_u32 s60, s59, 8192
L_wdma_25:
    s_mov_b32 m0, s59
    s_add_u32 s59, s59, 1024
    buffer_load_dwordx4 v46, s[16:19], s58 offen lds
    s_add_u32 s58, s58, 0x8000
    s_cmp_lt_u32 s59, s60
    s_cbranch_scc1 L_wdma_25
    v_add_u32 v51, 131072, v48
    ds_read_b64_tr_b16 a[16:17], v51 offset:0
    ds_read_b64_tr_b16 a[18:19], v51 offset:8192
    ds_read_b64_tr_b16 a[20:21], v51 offset:2048
    ds_read_b64_tr_b16 a[22:23], v51 offset:10240
    ds_read_b64_tr_b16 a[80:81], v51 offset:32
    ds_read_b64_tr_b16 a[82:83], v51 offset:8224
    ds_read_b64_tr_b16 a[84:85], v51 offset:2080
    ds_read_b64_tr_b16 a[86:87], v51 offset:10272
    ds_read_b64_tr_b16 a[24:25], v51 offset:16384
    ds_read_b64_tr_b16 a[26:27], v51 offset:24576
    ds_read_b64_tr_b16 a[28:29], v51 offset:18432
    ds_read_b64_tr_b16 a[30:31], v51 offset:26624
    ds_read_b64_tr_b16 a[88:89], v51 offset:16416
    ds_read_b64_tr_b16 a[90:91], v51 offset:24608
    ds_read_b64_tr_b16 a[92:93], v51 offset:18464
    ds_read_b64_tr_b16 a[94:95], v51 offset:26656
    s_waitcnt lgkmcnt(0)
    s_waitcnt vmcnt(24)
    s_barrier
    s_lshl_b32 s58, s32, 18
    s_lshl_b32 s59, s33, 8
    s_add_u32 s58, s58, s59
    s_add_u32 s58, s58, 0x200000
    s_lshl_b32 s59, s32, 13
    s_add_u32 s59, s59, 131072
    s_add_u32 s60, s59, 8192
L_wdma_26:
    s_mov_b32 m0, s59
    s_add_u32 s59, s59, 1024
    buffer_load_dwordx4 v46, s[16:19], s58 offen lds
    s_add_u32 s58, s58, 0x8000
    s_cmp_lt_u32 s59, s60
    s_cbranch_scc1 L_wdma_26
    v_add_u32 v51, 0, v48
    ds_read_b64_tr_b16 a[32:33], v51 offset:0
    ds_read_b64_tr_b16 a[34:35], v51 offset:8192
    ds_read_b64_tr_b16 a[36:37], v51 offset:2048
    ds_read_b64_tr_b16 a[38:39], v51 offset:10240
    ds_read_b64_tr_b16 a[96:97], v51 offset:32
    ds_read_b64_tr_b16 a[98:99], v51 offset:8224
    ds_read_b64_tr_b16 a[100:101], v51 offset:2080
    ds_read_b64_tr_b16 a[102:103], v51 offset:10272
    ds_read_b64_tr_b16 a[40:41], v51 offset:16384
    ds_read_b64_tr_b16 a[42:43], v51 offset:24576
    ds_read_b64_tr_b16 a[44:45], v51 offset:18432
    ds_read_b64_tr_b16 a[46:47], v51 offset:26624
    ds_read_b64_tr_b16 a[104:105], v51 offset:16416
    ds_read_b64_tr_b16 a[106:107], v51 offset:24608
    ds_read_b64_tr_b16 a[108:109], v51 offset:18464
    ds_read_b64_tr_b16 a[110:111], v51 offset:26656
    s_waitcnt lgkmcnt(0)
    s_waitcnt vmcnt(24)
    s_barrier
    s_lshl_b32 s58, s32, 18
    s_lshl_b32 s59, s33, 8
    s_add_u32 s58, s58, s59
    s_add_u32 s58, s58, 0x300000
    s_lshl_b32 s59, s32, 13
    s_add_u32 s59, s59, 0
    s_add_u32 s60, s59, 8192
L_wdma_27:
    s_mov_b32 m0, s59
    s_add_u32 s59, s59, 1024
    buffer_load_dwordx4 v46, s[16:19], s58 offen lds
    s_add_u32 s58, s58, 0x8000
    s_cmp_lt_u32 s59, s60
    s_cbranch_scc1 L_wdma_27
    v_add_u32 v51, 32768, v48
    ds_read_b64_tr_b16 a[48:49], v51 offset:0
    ds_read_b64_tr_b16 a[50:51], v51 offset:8192
    ds_read_b64_tr_b16 a[52:53], v51 offset:2048
    ds_read_b64_tr_b16 a[54:55], v51 offset:10240
    ds_read_b64_tr_b16 a[112:113], v51 offset:32
    ds_read_b64_tr_b16 a[114:115], v51 offset:8224
    ds_read_b64_tr_b16 a[116:117], v51 offset:2080
    ds_read_b64_tr_b16 a[118:119], v51 offset:10272
    ds_read_b64_tr_b16 a[56:57], v51 offset:16384
    ds_read_b64_tr_b16 a[58:59], v51 offset:24576
    ds_read_b64_tr_b16 a[60:61], v51 offset:18432
    ds_read_b64_tr_b16 a[62:63], v51 offset:26624
    ds_read_b64_tr_b16 a[120:121], v51 offset:16416
    ds_read_b64_tr_b16 a[122:123], v51 offset:24608
    ds_read_b64_tr_b16 a[124:125], v51 offset:18464
    ds_read_b64_tr_b16 a[126:127], v51 offset:26656
    s_waitcnt lgkmcnt(0)
    s_waitcnt vmcnt(24)
    s_barrier
    s_lshl_b32 s58, s32, 18
    s_lshl_b32 s59, s33, 8
    s_add_u32 s58, s58, s59
    s_lshl_b32 s59, s32, 13
    s_add_u32 s59, s59, 32768
    s_add_u32 s60, s59, 8192
L_wdma_28:
    s_mov_b32 m0, s59
    s_add_u32 s59, s59, 1024
    buffer_load_dwordx4 v46, s[20:23], s58 offen lds
    s_add_u32 s58, s58, 0x8000
    s_cmp_lt_u32 s59, s60
    s_cbranch_scc1 L_wdma_28
    v_add_u32 v51, 65536, v48
    ds_read_b64_tr_b16 a[128:129], v51 offset:0
    ds_read_b64_tr_b16 a[130:131], v51 offset:8192
    ds_read_b64_tr_b16 a[132:133], v51 offset:2048
    ds_read_b64_tr_b16 a[134:135], v51 offset:10240
    ds_read_b64_tr_b16 a[192:193], v51 offset:32
    ds_read_b64_tr_b16 a[194:195], v51 offset:8224
    ds_read_b64_tr_b16 a[196:197], v51 offset:2080
    ds_read_b64_tr_b16 a[198:199], v51 offset:10272
    ds_read_b64_tr_b16 a[136:137], v51 offset:16384
    ds_read_b64_tr_b16 a[138:139], v51 offset:24576
    ds_read_b64_tr_b16 a[140:141], v51 offset:18432
    ds_read_b64_tr_b16 a[142:143], v51 offset:26624
    ds_read_b64_tr_b16 a[200:201], v51 offset:16416
    ds_read_b64_tr_b16 a[202:203], v51 offset:24608
    ds_read_b64_tr_b16 a[204:205], v51 offset:18464
    ds_read_b64_tr_b16 a[206:207], v51 offset:26656
    s_waitcnt lgkmcnt(0)
    s_waitcnt vmcnt(24)
    s_barrier
    s_lshl_b32 s58, s32, 18
    s_lshl_b32 s59, s33, 8
    s_add_u32 s58, s58, s59
    s_add_u32 s58, s58, 0x100000
    s_lshl_b32 s59, s32, 13
    s_add_u32 s59, s59, 65536
    s_add_u32 s60, s59, 8192
L_wdma_29:
    s_mov_b32 m0, s59
    s_add_u32 s59, s59, 1024
    buffer_load_dwordx4 v46, s[20:23], s58 offen lds
    s_add_u32 s58, s58, 0x8000
    s_cmp_lt_u32 s59, s60
    s_cbranch_scc1 L_wdma_29
    s_cmp_lg_u32 s32, 0
    s_cbranch_scc1 L_arrive_skip_30
    s_mov_b64 exec, 1
    v_mov_b32 v62, 0
    v_mov_b32 v63, 1
    global_atomic_add v62, v63, s[4:5] offset:200
    global_atomic_add v62, v63, s[4:5] offset:4
    s_mov_b64 exec, -1
L_arrive_skip_30:
    v_add_u32 v51, 98304, v48
    ds_read_b64_tr_b16 a[144:145], v51 offset:0
    ds_read_b64_tr_b16 a[146:147], v51 offset:8192
    ds_read_b64_tr_b16 a[148:149], v51 offset:2048
    ds_read_b64_tr_b16 a[150:151], v51 offset:10240
    ds_read_b64_tr_b16 a[208:209], v51 offset:32
    ds_read_b64_tr_b16 a[210:211], v51 offset:8224
    ds_read_b64_tr_b16 a[212:213], v51 offset:2080
    ds_read_b64_tr_b16 a[214:215], v51 offset:10272
    ds_read_b64_tr_b16 a[152:153], v51 offset:16384
    ds_read_b64_tr_b16 a[154:155], v51 offset:24576
    ds_read_b64_tr_b16 a[156:157], v51 offset:18432
    ds_read_b64_tr_b16 a[158:159], v51 offset:26624
    ds_read_b64_tr_b16 a[216:217], v51 offset:16416
    ds_read_b64_tr_b16 a[218:219], v51 offset:24608
    ds_read_b64_tr_b16 a[220:221], v51 offset:18464
    ds_read_b64_tr_b16 a[222:223], v51 offset:26656
    s_waitcnt lgkmcnt(0)
    s_waitcnt vmcnt(24)
    s_barrier
    s_lshl_b32 s58, s32, 18
    s_lshl_b32 s59, s33, 8
    s_add_u32 s58, s58, s59
    s_add_u32 s58, s58, 0x200000
    s_lshl_b32 s59, s32, 13
    s_add_u32 s59, s59, 98304
    s_add_u32 s60, s59, 8192
L_wdma_31:
    s_mov_b32 m0, s59
    s_add_u32 s59, s59, 1024
    buffer_load_dwordx4 v46, s[20:23], s58 offen lds
    s_add_u32 s58, s58, 0x8000
    s_cmp_lt_u32 s59, s60
    s_cbranch_scc1 L_wdma_31
    v_add_u32 v51, 131072, v48
    ds_read_b64_tr_b16 a[160:161], v51 offset:0
    ds_read_b64_tr_b16 a[162:163], v51 offset:8192
    ds_read_b64_tr_b16 a[164:165], v51 offset:2048
    ds_read_b64_tr_b16 a[166:167], v51 offset:10240
    ds_read_b64_tr_b16 a[224:225], v51 offset:32
    ds_read_b64_tr_b16 a[226:227], v51 offset:8224
    ds_read_b64_tr_b16 a[228:229], v51 offset:2080
    ds_read_b64_tr_b16 a[230:231], v51 offset:10272
    ds_read_b64_tr_b16 a[168:169], v51 offset:16384
    ds_read_b64_tr_b16 a[170:171], v51 offset:24576
    ds_read_b64_tr_b16 a[172:173], v51 offset:18432
    ds_read_b64_tr_b16 a[174:175], v51 offset:26624
    ds_read_b64_tr_b16 a[232:233], v51 offset:16416
    ds_read_b64_tr_b16 a[234:235], v51 offset:24608
    ds_read_b64_tr_b16 a[236:237], v51 offset:18464
    ds_read_b64_tr_b16 a[238:239], v51 offset:26656
    s_waitcnt lgkmcnt(0)
    s_waitcnt vmcnt(24)
    s_barrier
    s_lshl_b32 s58, s32, 18
    s_lshl_b32 s59, s33, 8
    s_add_u32 s58, s58, s59
    s_add_u32 s58, s58, 0x300000
    s_lshl_b32 s59, s32, 13
    s_add_u32 s59, s59, 131072
    s_add_u32 s60, s59, 8192
L_wdma_32:
    s_mov_b32 m0, s59
    s_add_u32 s59, s59, 1024
    buffer_load_dwordx4 v46, s[20:23], s58 offen lds
    s_add_u32 s58, s58, 0x8000
    s_cmp_lt_u32 s59, s60
    s_cbranch_scc1 L_wdma_32
    v_add_u32 v51, 0, v48
    ds_read_b64_tr_b16 a[176:177], v51 offset:0
    ds_read_b64_tr_b16 a[178:179], v51 offset:8192
    ds_read_b64_tr_b16 a[180:181], v51 offset:2048
    ds_read_b64_tr_b16 a[182:183], v51 offset:10240
    ds_read_b64_tr_b16 a[240:241], v51 offset:32
    ds_read_b64_tr_b16 a[242:243], v51 offset:8224
    ds_read_b64_tr_b16 a[244:245], v51 offset:2080
    ds_read_b64_tr_b16 a[246:247], v51 offset:10272
    ds_read_b64_tr_b16 a[184:185], v51 offset:16384
    ds_read_b64_tr_b16 a[186:187], v51 offset:24576
    ds_read_b64_tr_b16 a[188:189], v51 offset:18432
    ds_read_b64_tr_b16 a[190:191], v51 offset:26624
    ds_read_b64_tr_b16 a[248:249], v51 offset:16416
    ds_read_b64_tr_b16 a[250:251], v51 offset:24608
    ds_read_b64_tr_b16 a[252:253], v51 offset:18464
    ds_read_b64_tr_b16 a[254:255], v51 offset:26656
    s_waitcnt lgkmcnt(0)
    s_waitcnt vmcnt(24)
    s_barrier
    s_lshl_b32 s58, s32, 14
    s_lshl_b32 s59, s33, 17
    s_add_u32 s58, s58, s59
    s_add_u32 s58, s58, 0x0
    s_lshl_b32 s59, s32, 13
    s_add_u32 s59, s59, 0
    s_add_u32 s60, s59, 8192
L_wdma_33:
    s_mov_b32 m0, s59
    s_add_u32 s59, s59, 1024
    buffer_load_dwordx4 v47, s[24:27], s58 offen lds
    s_add_u32 s58, s58, 0x800
    s_cmp_lt_u32 s59, s60
    s_cbranch_scc1 L_wdma_33
    v_add_u32 v51, 32768, v48
    ds_read_b64_tr_b16 v[128:129], v51 offset:0
    ds_read_b64_tr_b16 v[130:131], v51 offset:8192
    ds_read_b64_tr_b16 v[132:133], v51 offset:2048
    ds_read_b64_tr_b16 v[134:135], v51 offset:10240
    ds_read_b64_tr_b16 v[192:193], v51 offset:32
    ds_read_b64_tr_b16 v[194:195], v51 offset:8224
    ds_read_b64_tr_b16 v[196:197], v51 offset:2080
    ds_read_b64_tr_b16 v[198:199], v51 offset:10272
    ds_read_b64_tr_b16 v[136:137], v51 offset:16384
    ds_read_b64_tr_b16 v[138:139], v51 offset:24576
    ds_read_b64_tr_b16 v[140:141], v51 offset:18432
    ds_read_b64_tr_b16 v[142:143], v51 offset:26624
    ds_read_b64_tr_b16 v[200:201], v51 offset:16416
    ds_read_b64_tr_b16 v[202:203], v51 offset:24608
    ds_read_b64_tr_b16 v[204:205], v51 offset:18464
    ds_read_b64_tr_b16 v[206:207], v51 offset:26656
    s_waitcnt lgkmcnt(0)
    s_waitcnt vmcnt(24)
    s_barrier
    s_lshl_b32 s58, s32, 14
    s_lshl_b32 s59, s33, 17
    s_add_u32 s58, s58, s59
    s_add_u32 s58, s58, 0x200
    s_lshl_b32 s59, s32, 13
    s_add_u32 s59, s59, 32768
    s_add_u32 s60, s59, 8192
L_wdma_34:
    s_mov_b32 m0, s59
    s_add_u32 s59, s59, 1024
    buffer_load_dwordx4 v47, s[24:27], s58 offen lds
    s_add_u32 s58, s58, 0x800
    s_cmp_lt_u32 s59, s60
    s_cbranch_scc1 L_wdma_34
    v_add_u32 v51, 65536, v48
    ds_read_b64_tr_b16 v[144:145], v51 offset:0
    ds_read_b64_tr_b16 v[146:147], v51 offset:8192
    ds_read_b64_tr_b16 v[148:149], v51 offset:2048
    ds_read_b64_tr_b16 v[150:151], v51 offset:10240
    ds_read_b64_tr_b16 v[208:209], v51 offset:32
    ds_read_b64_tr_b16 v[210:211], v51 offset:8224
    ds_read_b64_tr_b16 v[212:213], v51 offset:2080
    ds_read_b64_tr_b16 v[214:215], v51 offset:10272
    ds_read_b64_tr_b16 v[152:153], v51 offset:16384
    ds_read_b64_tr_b16 v[154:155], v51 offset:24576
    ds_read_b64_tr_b16 v[156:157], v51 offset:18432
    ds_read_b64_tr_b16 v[158:159], v51 offset:26624
    ds_read_b64_tr_b16 v[216:217], v51 offset:16416
    ds_read_b64_tr_b16 v[218:219], v51 offset:24608
    ds_read_b64_tr_b16 v[220:221], v51 offset:18464
    ds_read_b64_tr_b16 v[222:223], v51 offset:26656
    s_waitcnt lgkmcnt(0)
    s_waitcnt vmcnt(24)
    s_barrier
    s_lshl_b32 s58, s32, 14
    s_lshl_b32 s59, s33, 17
    s_add_u32 s58, s58, s59
    s_add_u32 s58, s58, 0x10000
    s_lshl_b32 s59, s32, 13
    s_add_u32 s59, s59, 65536
    s_add_u32 s60, s59, 8192
L_wdma_35:
    s_mov_b32 m0, s59
    s_add_u32 s59, s59, 1024
    buffer_load_dwordx4 v47, s[24:27], s58 offen lds
    s_add_u32 s58, s58, 0x800
    s_cmp_lt_u32 s59, s60
    s_cbranch_scc1 L_wdma_35
    v_add_u32 v51, 98304, v48
    ds_read_b64_tr_b16 v[160:161], v51 offset:0
    ds_read_b64_tr_b16 v[162:163], v51 offset:8192
    ds_read_b64_tr_b16 v[164:165], v51 offset:2048
    ds_read_b64_tr_b16 v[166:167], v51 offset:10240
    ds_read_b64_tr_b16 v[224:225], v51 offset:32
    ds_read_b64_tr_b16 v[226:227], v51 offset:8224
    ds_read_b64_tr_b16 v[228:229], v51 offset:2080
    ds_read_b64_tr_b16 v[230:231], v51 offset:10272
    ds_read_b64_tr_b16 v[168:169], v51 offset:16384
    ds_read_b64_tr_b16 v[170:171], v51 offset:24576
    ds_read_b64_tr_b16 v[172:173], v51 offset:18432
    ds_read_b64_tr_b16 v[174:175], v51 offset:26624
    ds_read_b64_tr_b16 v[232:233], v51 offset:16416
    ds_read_b64_tr_b16 v[234:235], v51 offset:24608
    ds_read_b64_tr_b16 v[236:237], v51 offset:18464
    ds_read_b64_tr_b16 v[238:239], v51 offset:26656
    s_waitcnt lgkmcnt(0)
    s_waitcnt vmcnt(24)
    s_barrier
    s_lshl_b32 s58, s32, 14
    s_lshl_b32 s59, s33, 17
    s_add_u32 s58, s58, s59
    s_add_u32 s58, s58, 0x10200
    s_lshl_b32 s59, s32, 13
    s_add_u32 s59, s59, 98304
    s_add_u32 s60, s59, 8192
L_wdma_36:
    s_mov_b32 m0, s59
    s_add_u32 s59, s59, 1024
    buffer_load_dwordx4 v47, s[24:27], s58 offen lds
    s_add_u32 s58, s58, 0x800
    s_cmp_lt_u32 s59, s60
    s_cbranch_scc1 L_wdma_36
    v_add_u32 v51, 131072, v48
    ds_read_b64_tr_b16 v[176:177], v51 offset:0
    ds_read_b64_tr_b16 v[178:179], v51 offset:8192
    ds_read_b64_tr_b16 v[180:181], v51 offset:2048
    ds_read_b64_tr_b16 v[182:183], v51 offset:10240
    ds_read_b64_tr_b16 v[240:241], v51 offset:32
    ds_read_b64_tr_b16 v[242:243], v51 offset:8224
    ds_read_b64_tr_b16 v[244:245], v51 offset:2080
    ds_read_b64_tr_b16 v[246:247], v51 offset:10272
    ds_read_b64_tr_b16 v[184:185], v51 offset:16384
    ds_read_b64_tr_b16 v[186:187], v51 offset:24576
    ds_read_b64_tr_b16 v[188:189], v51 offset:18432
    ds_read_b64_tr_b16 v[190:191], v51 offset:26624
    ds_read_b64_tr_b16 v[248:249], v51 offset:16416
    ds_read_b64_tr_b16 v[250:251], v51 offset:24608
    ds_read_b64_tr_b16 v[252:253], v51 offset:18464
    ds_read_b64_tr_b16 v[254:255], v51 offset:26656
    s_waitcnt lgkmcnt(0)
    s_waitcnt vmcnt(24)
    s_barrier
    v_add_u32 v51, 0, v49
    ds_read_b64_tr_b16 v[64:65], v51 offset:0
    ds_read_b64_tr_b16 v[66:67], v51 offset:32
    ds_read_b64_tr_b16 v[68:69], v51 offset:8192
    ds_read_b64_tr_b16 v[70:71], v51 offset:8224
    ds_read_b64_tr_b16 v[72:73], v51 offset:16384
    ds_read_b64_tr_b16 v[74:75], v51 offset:16416
    ds_read_b64_tr_b16 v[76:77], v51 offset:24576
    ds_read_b64_tr_b16 v[78:79], v51 offset:24608
    ds_read_b64_tr_b16 v[80:81], v51 offset:64
    ds_read_b64_tr_b16 v[82:83], v51 offset:96
    ds_read_b64_tr_b16 v[84:85], v51 offset:8256
    ds_read_b64_tr_b16 v[86:87], v51 offset:8288
    ds_read_b64_tr_b16 v[88:89], v51 offset:16448
    ds_read_b64_tr_b16 v[90:91], v51 offset:16480
    ds_read_b64_tr_b16 v[92:93], v51 offset:24640
    ds_read_b64_tr_b16 v[94:95], v51 offset:24672
    s_waitcnt lgkmcnt(0)
    s_barrier
    v_add_u32 v51, 0, v50
    v_mov_b32 v96, v65
    v_mov_b32 v65, v66
    v_mov_b32 v66, v96
    ds_write_b128 v51, v[64:67] offset:0
    v_mov_b32 v96, v69
    v_mov_b32 v69, v70
    v_mov_b32 v70, v96
    ds_write_b128 v51, v[68:71] offset:1024
    v_mov_b32 v96, v73
    v_mov_b32 v73, v74
    v_mov_b32 v74, v96
    ds_write_b128 v51, v[72:75] offset:2048
    v_mov_b32 v96, v77
    v_mov_b32 v77, v78
    v_mov_b32 v78, v96
    ds_write_b128 v51, v[76:79] offset:3072
    v_mov_b32 v96, v81
    v_mov_b32 v81, v82
    v_mov_b32 v82, v96
    ds_write_b128 v51, v[80:83] offset:4096
    v_mov_b32 v96, v85
    v_mov_b32 v85, v86
    v_mov_b32 v86, v96
    ds_write_b128 v51, v[84:87] offset:5120
    v_mov_b32 v96, v89
    v_mov_b32 v89, v90
    v_mov_b32 v90, v96
    ds_write_b128 v51, v[88:91] offset:6144
    v_mov_b32 v96, v93
    v_mov_b32 v93, v94
    v_mov_b32 v94, v96
    ds_write_b128 v51, v[92:95] offset:7168
    s_waitcnt lgkmcnt(0)
    s_waitcnt vmcnt(16)
    s_barrier
    v_mov_b32 v126, 0
    v_and_b32 v125, 15, v40
    v_lshlrev_b32 v125, 2, v125
    global_load_dword v127, v126, s[4:5] offset:200 sc1
    global_load_dword v124, v126, s[4:5] sc1
    global_load_dword v123, v125, s[4:5] offset:128 sc1
    v_add_u32 v51, 32768, v49
    ds_read_b64_tr_b16 v[64:65], v51 offset:0
    ds_read_b64_tr_b16 v[66:67], v51 offset:32
    ds_read_b64_tr_b16 v[68:69], v51 offset:8192
    ds_read_b64_tr_b16 v[70:71], v51 offset:8224
    ds_read_b64_tr_b16 v[72:73], v51 offset:16384
    ds_read_b64_tr_b16 v[74:75], v51 offset:16416
    ds_read_b64_tr_b16 v[76:77], v51 offset:24576
    ds_read_b64_tr_b16 v[78:79], v51 offset:24608
    ds_read_b64_tr_b16 v[80:81], v51 offset:64
    ds_read_b64_tr_b16 v[82:83], v51 offset:96
    ds_read_b64_tr_b16 v[84:85], v51 offset:8256
    ds_read_b64_tr_b16 v[86:87], v51 offset:8288
    ds_read_b64_tr_b16 v[88:89], v51 offset:16448
    ds_read_b64_tr_b16 v[90:91], v51 offset:16480
    ds_read_b64_tr_b16 v[92:93], v51 offset:24640
    ds_read_b64_tr_b16 v[94:95], v51 offset:24672
    s_waitcnt lgkmcnt(0)
    s_barrier
    v_add_u32 v51, 32768, v50
    v_mov_b32 v96, v65
    v_mov_b32 v65, v66
    v_mov_b32 v66, v96
    ds_write_b128 v51, v[64:67] offset:0
    v_mov_b32 v96, v69
    v_mov_b32 v69, v70
    v_mov_b32 v70, v96
    ds_write_b128 v51, v[68:71] offset:1024
    v_mov_b32 v96, v73
    v_mov_b32 v73, v74
    v_mov_b32 v74, v96
    ds_write_b128 v51, v[72:75] offset:2048
    v_mov_b32 v96, v77
    v_mov_b32 v77, v78
    v_mov_b32 v78, v96
    ds_write_b128 v51, v[76:79] offset:3072
    v_mov_b32 v96, v81
    v_mov_b32 v81, v82
    v_mov_b32 v82, v96
    ds_write_b128 v51, v[80:83] offset:4096
    v_mov_b32 v96, v85
    v_mov_b32 v85, v86
    v_mov_b32 v86, v96
    ds_write_b128 v51, v[84:87] offset:5120
    v_mov_b32 v96, v89
    v_mov_b32 v89, v90
    v_mov_b32 v90, v96
    ds_write_b128 v51, v[88:91] offset:6144
    v_mov_b32 v96, v93
    v_mov_b32 v93, v94
    v_mov_b32 v94, v96
    ds_write_b128 v51, v[92:95] offset:7168
    s_waitcnt lgkmcnt(0)
    s_waitcnt vmcnt(8)
    s_barrier
    v_add_u32 v51, 65536, v49
    ds_read_b64_tr_b16 v[64:65], v51 offset:0
    ds_read_b64_tr_b16 v[66:67], v51 offset:32
    ds_read_b64_tr_b16 v[68:69], v51 offset:8192
    ds_read_b64_tr_b16 v[70:71], v51 offset:8224
    ds_read_b64_tr_b16 v[72:73], v51 offset:16384
    ds_read_b64_tr_b16 v[74:75], v51 offset:16416
    ds_read_b64_tr_b16 v[76:77], v51 offset:24576
    ds_read_b64_tr_b16 v[78:79], v51 offset:24608
    ds_read_b64_tr_b16 v[80:81], v51 offset:64
    ds_read_b64_tr_b16 v[82:83], v51 offset:96
    ds_read_b64_tr_b16 v[84:85], v51 offset:8256
    ds_read_b64_tr_b16 v[86:87], v51 offset:8288
    ds_read_b64_tr_b16 v[88:89], v51 offset:16448
    ds_read_b64_tr_b16 v[90:91], v51 offset:16480
    ds_read_b64_tr_b16 v[92:93], v51 offset:24640
    ds_read_b64_tr_b16 v[94:95], v51 offset:24672
    s_waitcnt lgkmcnt(0)
    s_barrier
    v_add_u32 v51, 65536, v50
    v_mov_b32 v96, v65
    v_mov_b32 v65, v66
    v_mov_b32 v66, v96
    ds_write_b128 v51, v[64:67] offset:0
    v_mov_b32 v96, v69
    v_mov_b32 v69, v70
    v_mov_b32 v70, v96
    ds_write_b128 v51, v[68:71] offset:1024
    v_mov_b32 v96, v73
    v_mov_b32 v73, v74
    v_mov_b32 v74, v96
    ds_write_b128 v51, v[72:75] offset:2048
    v_mov_b32 v96, v77
    v_mov_b32 v77, v78
    v_mov_b32 v78, v96
    ds_write_b128 v51, v[76:79] offset:3072
    v_mov_b32 v96, v81
    v_mov_b32 v81, v82
    v_mov_b32 v82, v96
    ds_write_b128 v51, v[80:83] offset:4096
    v_mov_b32 v96, v85
    v_mov_b32 v85, v86
    v_mov_b32 v86, v96
    ds_write_b128 v51, v[84:87] offset:5120
    v_mov_b32 v96, v89
    v_mov_b32 v89, v90
    v_mov_b32 v90, v96
    ds_write_b128 v51, v[88:91] offset:6144
    v_mov_b32 v96, v93
    v_mov_b32 v93, v94
    v_mov_b32 v94, v96
    ds_write_b128 v51, v[92:95] offset:7168
    s_waitcnt lgkmcnt(0)
    s_waitcnt vmcnt(0)
    s_barrier
    v_readfirstlane_b32 s67, v127
    v_readfirstlane_b32 s68, v124
    s_mov_b32 s95, 0
    s_mov_b32 s69, 0
    v_and_b32 v123, 0xffff, v123
    v_cmp_le_u32 vcc, 64, v123
    s_nop 3
    s_not_b32 s60, vcc_lo
    s_or_b32 s60, s60, 0x10000
    s_ff1_i32_b32 s95, s60
    s_cmp_eq_u32 s95, 0
    s_cbranch_scc1 L_nopf_37
    s_lshl_b32 s58, s33, 13
    s_add_u32 s43, s58, 0x1000000
    s_add_u32 s54, s58, 0x2000000
    s_add_u32 s55, s58, 0x3000000
    s_lshl_b32 s57, s32, 11
    s_add_u32 s57, s57, 131072
    s_mov_b32 m0, s57
    s_nop 0
    buffer_load_dwordx4 v1, s[8:11], s43 offen sc1 lds
    buffer_load_dwordx4 v1, s[8:11], s43 offen offset:1024 sc1 lds
    buffer_load_dwordx4 v[36:39], v1, s[8:11], s54 offen sc1
    buffer_load_dwordx4 v[40:43], v1, s[8:11], s54 offen offset:1024 sc1
    s_mov_b32 s69, 1
L_nopf_37:
    v_add_u32 v51, 98304, v49
    ds_read_b64_tr_b16 v[64:65], v51 offset:0
    ds_read_b64_tr_b16 v[66:67], v51 offset:32
    ds_read_b64_tr_b16 v[68:69], v51 offset:8192
    ds_read_b64_tr_b16 v[70:71], v51 offset:8224
    ds_read_b64_tr_b16 v[72:73], v51 offset:16384
    ds_read_b64_tr_b16 v[74:75], v51 offset:16416
    ds_read_b64_tr_b16 v[76:77], v51 offset:24576
    ds_read_b64_tr_b16 v[78:79], v51 offset:24608
    ds_read_b64_tr_b16 v[80:81], v51 offset:64
    ds_read_b64_tr_b16 v[82:83], v51 offset:96
    ds_read_b64_tr_b16 v[84:85], v51 offset:8256
    ds_read_b64_tr_b16 v[86:87], v51 offset:8288
    ds_read_b64_tr_b16 v[88:89], v51 offset:16448
    ds_read_b64_tr_b16 v[90:91], v51 offset:16480
    ds_read_b64_tr_b16 v[92:93], v51 offset:24640
    ds_read_b64_tr_b16 v[94:95], v51 offset:24672
    s_waitcnt lgkmcnt(0)
    s_barrier
    v_add_u32 v51, 98304, v50
    v_mov_b32 v96, v65
    v_mov_b32 v65, v66
    v_mov_b32 v66, v96
    ds_write_b128 v51, v[64:67] offset:0
    v_mov_b32 v96, v69
    v_mov_b32 v69, v70
    v_mov_b32 v70, v96
    ds_write_b128 v51, v[68:71] offset:1024
    v_mov_b32 v96, v73
    v_mov_b32 v73, v74
    v_mov_b32 v74, v96
    ds_write_b128 v51, v[72:75] offset:2048
    v_mov_b32 v96, v77
    v_mov_b32 v77, v78
    v_mov_b32 v78, v96
    ds_write_b128 v51, v[76:79] offset:3072
    v_mov_b32 v96, v81
    v_mov_b32 v81, v82
    v_mov_b32 v82, v96
    ds_write_b128 v51, v[80:83] offset:4096
    v_mov_b32 v96, v85
    v_mov_b32 v85, v86
    v_mov_b32 v86, v96
    ds_write_b128 v51, v[84:87] offset:5120
    v_mov_b32 v96, v89
    v_mov_b32 v89, v90
    v_mov_b32 v90, v96
    ds_write_b128 v51, v[88:91] offset:6144
    v_mov_b32 v96, v93
    v_mov_b32 v93, v94
    v_mov_b32 v94, v96
    ds_write_b128 v51, v[92:95] offset:7168
    s_waitcnt lgkmcnt(0)
    s_barrier
    s_mov_b32 s58, s67
    s_mov_b32 s59, s68
    s_nop 3
    s_cmp_ge_u32 s58, 32
    s_cbranch_scc1 L_go_23
    s_waitcnt vmcnt(0)
    v_mov_b32 v126, 0
    global_load_dword v127, v126, s[4:5] sc1
    s_waitcnt vmcnt(0)
    s_nop 0
    v_readfirstlane_b32 s59, v127
    s_nop 3
L_go_23:
    s_cmp_lt_u32 s59, 32
    s_cbranch_scc1 L_slowpath_18
    s_mov_b32 s59, 0
    s_cmp_lt_u32 s59, s95
    s_cbranch_scc1 L_kv_ok_41
L_kv_again_42:
    v_mbcnt_lo_u32_b32 v80, -1, 0
    v_mbcnt_hi_u32_b32 v80, -1, v80
    v_and_b32 v80, 15, v80
    v_lshlrev_b32 v80, 2, v80
    global_load_dword v81, v80, s[4:5] offset:128 sc1
    s_waitcnt vmcnt(0)
    v_and_b32 v81, 0xffff, v81
    v_cmp_le_u32 vcc, 64, v81
    s_nop 3
    s_not_b32 s58, vcc_lo
    s_or_b32 s58, s58, 0x10000
    s_ff1_i32_b32 s95, s58
    s_cmp_lt_u32 s59, s95
    s_cbranch_scc1 L_kv_ok_41_t
    s_add_u32 s63, s63, 1
    s_cmp_lt_u32 s63, 0x80000
    s_cbranch_scc0 L_end_1
    s_sleep 32
    s_branch L_kv_again_42
L_kv_ok_41_t:
L_kv_ok_41:
    s_cmp_eq_u32 s69, 1
    s_cbranch_scc1 L_pf0_43
    s_lshl_b32 s58, s33, 13
    s_add_u32 s43, s58, 0x1000000
    s_add_u32 s54, s58, 0x2000000
    s_add_u32 s55, s58, 0x3000000
    s_lshl_b32 s57, s32, 11
    s_add_u32 s57, s57, 131072
    s_mov_b32 m0, s57
    s_nop 0
    buffer_load_dwordx4 v1, s[8:11], s43 offen sc1 lds
    buffer_load_dwordx4 v1, s[8:11], s43 offen offset:1024 sc1 lds
    buffer_load_dwordx4 v[36:39], v1, s[8:11], s54 offen sc1
    buffer_load_dwordx4 v[40:43], v1, s[8:11], s54 offen offset:1024 sc1
L_pf0_43:
    s_mov_b32 s56, 0
    s_mov_b32 s98, 0
    s_mov_b32 s35, 0
    s_mov_b32 s36, 0x4100000
    s_mov_b32 s37, 0x4102000
    s_mov_b32 s38, 0x4104000
    s_mul_i32 s58, s33, 8192
    s_add_u32 s40, s58, 0x4000000
    s_add_u32 s41, s40, 1024
    s_mov_b32 s12, 0x4000000
    s_mov_b32 s13, 0x4008000
    s_waitcnt vmcnt(0)
    v_mov_b64 v[84:85], 0
    v_mov_b64 v[86:87], 0
    v_mov_b64 v[88:89], 0
    v_mov_b64 v[90:91], 0
    v_mov_b64 v[92:93], 0
    v_mov_b64 v[94:95], 0
    v_mov_b64 v[96:97], 0
    v_mov_b64 v[98:99], 0
    v_mov_b64 v[100:101], 0
    v_mov_b64 v[102:103], 0
    v_mov_b64 v[104:105], 0
    v_mov_b64 v[106:107], 0
    s_add_u32 s43, s43, 0x40000
    s_add_u32 s54, s54, 0x40000
    s_xor_b32 s57, s57, 0x2000
    s_mov_b32 m0, s57
L_step_38:
    buffer_load_dwordx4 v[108:111], v1, s[8:11], s36 offen sc1
    buffer_load_dwordx4 v[112:115], v1, s[8:11], s36 offen offset:1024 sc1
    s_waitcnt vmcnt(0)
    ds_write_b128 v12, v[108:111]
    ds_write_b128 v13, v[112:115]
    v_max3_u32 v116, v108, v109, v110
    v_max3_u32 v117, v111, v112, v113
    v_max3_u32 v116, v116, v114, v115
    v_max_u32 v116, v116, v117
    v_cmp_eq_u32 vcc, -1, v116
    s_cbranch_vccz L_ag_ok_45
L_poll_ag_44:
    s_mov_b64 exec, vcc
    buffer_load_dwordx4 v[108:111], v1, s[8:11], s36 offen sc1
    buffer_load_dwordx4 v[112:115], v1, s[8:11], s36 offen offset:1024 sc1
    s_waitcnt vmcnt(0)
    ds_write_b128 v12, v[108:111]
    ds_write_b128 v13, v[112:115]
    v_max3_u32 v116, v108, v109, v110
    v_max3_u32 v117, v111, v112, v113
    v_max3_u32 v116, v116, v114, v115
    v_max_u32 v116, v116, v117
    v_cmp_eq_u32 vcc, -1, v116
    s_cbranch_vccz L_ok_46
    s_add_u32 s63, s63, 1
    s_cmp_lt_u32 s63, 0x80000
    s_cbranch_scc1 L_poll_ag_44
    s_branch L_end_1
L_ok_46:
    s_mov_b64 exec, -1
L_ag_ok_45:
    s_waitcnt lgkmcnt(0)
    s_cmp_eq_u32 s35, 63
    s_cbranch_scc1 L_fin_40
    s_barrier
    v_mov_b32 v117, s98
    v_cmp_eq_u32 vcc, 0x4444, v0
    ds_read_b128 v[52:55], v14 offset:0
    ds_read_b128 v[56:59], v15 offset:128
    ds_read_b128 v[60:63], v14 offset:256
    ds_read_b128 v[64:67], v15 offset:384
    ds_read_b128 v[68:71], v14 offset:512
    ds_read_b128 v[72:75], v15 offset:640
    ds_read_b128 v[76:79], v14 offset:768
    ds_read_b128 v[80:83], v15 offset:896
    s_waitcnt lgkmcnt(7)
    v_smfmac_f32_16x16x64_bf16 v[84:87], v[52:55], a[0:7], v0
    v_smfmac_f32_16x16x64_bf16 v[88:91], v[52:55], a[64:71], v0
    s_waitcnt lgkmcnt(6)
    v_smfmac_f32_16x16x64_bf16 v[84:87], v[56:59], a[8:15], v0
    v_smfmac_f32_16x16x64_bf16 v[88:91], v[56:59], a[72:79], v0
    s_waitcnt lgkmcnt(5)
    v_smfmac_f32_16x16x64_bf16 v[84:87], v[60:63], a[16:23], v0
    buffer_load_dwordx4 v1, s[8:11], s43 offen sc1 lds
    v_smfmac_f32_16x16x64_bf16 v[88:91], v[60:63], a[80:87], v0
    s_waitcnt lgkmcnt(4)
    v_smfmac_f32_16x16x64_bf16 v[84:87], v[64:67], a[24:31], v0
    v_smfmac_f32_16x16x64_bf16 v[88:91], v[64:67], a[88:95], v0
    s_waitcnt lgkmcnt(3)
    v_smfmac_f32_16x16x64_bf16 v[84:87], v[68:71], a[32:39], v0
    v_smfmac_f32_16x16x64_bf16 v[88:91], v[68:71], a[96:103], v0
    s_waitcnt lgkmcnt(2)
    v_smfmac_f32_16x16x64_bf16 v[84:87], v[72:75], a[40:47], v0
    buffer_load_dwordx4 v1, s[8:11], s43 offen offset:1024 sc1 lds
    v_smfmac_f32_16x16x64_bf16 v[88:91], v[72:75], a[104:111], v0
    s_waitcnt lgkmcnt(1)
    v_smfmac_f32_16x16x64_bf16 v[84:87], v[76:79], a[48:55], v0
    v_smfmac_f32_16x16x64_bf16 v[88:91], v[76:79], a[112:119], v0
    s_waitcnt lgkmcnt(0)
    v_smfmac_f32_16x16x64_bf16 v[84:87], v[80:83], a[56:63], v0
    v_smfmac_f32_16x16x64_bf16 v[88:91], v[80:83], a[120:127], v0
    v_smfmac_f32_16x16x64_bf16 v[92:95], v[52:55], a[128:135], v0
    buffer_load_dwordx4 v[44:47], v1, s[8:11], s54 offen sc1
    v_smfmac_f32_16x16x64_bf16 v[92:95], v[56:59], a[136:143], v0
    v_add_f32 v84, v84, v86
    v_smfmac_f32_16x16x64_bf16 v[92:95], v[60:63], a[144:151], v0
    v_add_f32 v85, v85, v87
    v_smfmac_f32_16x16x64_bf16 v[92:95], v[64:67], a[152:159], v0
    v_cvt_pk_bf16_f32 v122, v84, v85
    v_smfmac_f32_16x16x64_bf16 v[92:95], v[68:71], a[160:167], v0
    v_add_f32 v88, v88, v90
    v_smfmac_f32_16x16x64_bf16 v[92:95], v[72:75], a[168:175], v0
    v_add_f32 v89, v89, v91
    v_smfmac_f32_16x16x64_bf16 v[92:95], v[76:79], a[176:183], v0
    ds_write2_b32 v16, v122, v122 offset0:0 offset1:1
    v_smfmac_f32_16x16x64_bf16 v[92:95], v[80:83], a[184:191], v0
    v_cvt_pk_bf16_f32 v123, v88, v89
    v_smfmac_f32_16x16x64_bf16 v[96:99], v[52:55], a[192:199], v0
    ds_write2_b32 v16, v123, v123 offset0:128 offset1:129
    v_smfmac_f32_16x16x64_bf16 v[96:99], v[56:59], a[200:207], v0
    v_add_f32 v92, v92, v94
    v_smfmac_f32_16x16x64_bf16 v[96:99], v[60:63], a[208:215], v0
    v_add_f32 v93, v93, v95
    v_smfmac_f32_16x16x64_bf16 v[96:99], v[64:67], a[216:223], v0
    v_cvt_pk_bf16_f32 v29, v92, v93
    v_smfmac_f32_16x16x64_bf16 v[96:99], v[68:71], a[224:231], v0
    ds_write_b32 v16, v29 offset:4096
    v_smfmac_f32_16x16x64_bf16 v[96:99], v[72:75], a[232:239], v0
    buffer_load_dwordx4 v[48:51], v1, s[8:11], s54 offen offset:1024 sc1
    v_smfmac_f32_16x16x64_bf16 v[96:99], v[76:79], a[240:247], v0
    v_smfmac_f32_16x16x64_bf16 v[96:99], v[80:83], a[248:255], v0
    v_smfmac_f32_16x16x64_bf16 v[100:103], v[52:55], v[128:135], v0
    v_smfmac_f32_16x16x64_bf16 v[104:107], v[52:55], v[192:199], v0
    v_add_f32 v96, v96, v98
    v_smfmac_f32_16x16x64_bf16 v[100:103], v[56:59], v[136:143], v0
    v_add_f32 v97, v97, v99
    v_smfmac_f32_16x16x64_bf16 v[104:107], v[56:59], v[200:207], v0
    v_cvt_pk_bf16_f32 v31, v96, v97
    v_smfmac_f32_16x16x64_bf16 v[100:103], v[60:63], v[144:151], v0
    ds_write_b32 v16, v31 offset:4608
    v_smfmac_f32_16x16x64_bf16 v[104:107], v[60:63], v[208:215], v0
    ds_read_b128 v[108:111], v20 offset:0
    v_smfmac_f32_16x16x64_bf16 v[100:103], v[64:67], v[152:159], v0
    ds_read_b128 v[112:115], v20 offset:4096
    v_smfmac_f32_16x16x64_bf16 v[104:107], v[64:67], v[216:223], v0
    ds_read_b128 v[52:55], v21 offset:0
    v_smfmac_f32_16x16x64_bf16 v[100:103], v[68:71], v[160:167], v0
    ds_read_b128 v[56:59], v21 offset:4096
    v_smfmac_f32_16x16x64_bf16 v[104:107], v[68:71], v[224:231], v0
    ds_read_b128 v[60:63], v22 offset:0
    v_smfmac_f32_16x16x64_bf16 v[100:103], v[72:75], v[168:175], v0
    ds_read_b128 v[64:67], v22 offset:4096
    v_smfmac_f32_16x16x64_bf16 v[104:107], v[72:75], v[232:239], v0
    s_waitcnt lgkmcnt(6)
    s_barrier
    buffer_store_dword v117, off, s[8:11], s99 sc1
    v_smfmac_f32_16x16x64_bf16 v[100:103], v[76:79], v[176:183], v0
    v_xor_b32 v20, 0x2000, v20
    ds_read_b64_tr_b16 v[116:117], v17 offset:0
    ds_read_b64_tr_b16 v[118:119], v18 offset:0
    v_smfmac_f32_16x16x64_bf16 v[104:107], v[76:79], v[240:247], v0
    ds_read_b64_tr_b16 v[120:121], v17 offset:4096
    v_smfmac_f32_16x16x64_bf16 v[100:103], v[80:83], v[184:191], v0
    ds_read_b64_tr_b16 v[122:123], v18 offset:4096
    ds_read_b64_tr_b16 v[92:93], v17 offset:1024
    ds_read_b64_tr_b16 v[94:95], v18 offset:1024
    v_smfmac_f32_16x16x64_bf16 v[104:107], v[80:83], v[248:255], v0
    s_waitcnt lgkmcnt(4)
    ds_read_b64_tr_b16 v[96:97], v17 offset:5120
    ds_read_b64_tr_b16 v[98:99], v18 offset:5120
    ds_read_b64_tr_b16 v[68:69], v17 offset:2048
    ds_read_b64_tr_b16 v[70:71], v18 offset:2048
    ds_read_b64_tr_b16 v[72:73], v17 offset:6144
    v_mfma_f32_16x16x32_bf16 v[84:87], v[108:111], v[116:119], 0
    ds_read_b64_tr_b16 v[74:75], v18 offset:6144
    ds_read_b64_tr_b16 v[76:77], v17 offset:3072
    v_mfma_f32_16x16x32_bf16 v[88:91], v[112:115], v[116:119], 0
    s_waitcnt lgkmcnt(9)
    ds_read_b64_tr_b16 v[78:79], v18 offset:3072
    ds_read_b64_tr_b16 v[80:81], v17 offset:7168
    v_mfma_f32_16x16x32_bf16 v[124:127], v[120:123], v[116:119], 0
    s_waitcnt lgkmcnt(9)
    ds_read_b64_tr_b16 v[82:83], v18 offset:7168
    ds_read_b128 v[108:111], v23 offset:0
    v_mfma_f32_16x16x32_bf16 v[84:87], v[52:55], v[92:95], v[84:87]
    ds_read_b128 v[112:115], v23 offset:4096
    v_add_f32 v104, v104, v106
    v_mfma_f32_16x16x32_bf16 v[88:91], v[56:59], v[92:95], v[88:91]
    v_add_f32 v105, v105, v107
    v_cvt_pk_bf16_f32 v30, v104, v105
    s_waitcnt lgkmcnt(10)
    v_mfma_f32_16x16x32_bf16 v[124:127], v[96:99], v[92:95], v[124:127]
    v_add_f32 v100, v100, v102
    v_add_f32 v101, v101, v103
    s_waitcnt lgkmcnt(8)
    v_mfma_f32_16x16x32_bf16 v[84:87], v[60:63], v[68:71], v[84:87]
    v_cvt_pk_bf16_f32 v28, v100, v101
    ds_read_b128 v[52:55], v25 offset:0
    v_mfma_f32_16x16x32_bf16 v[88:91], v[64:67], v[68:71], v[88:91]
    s_waitcnt lgkmcnt(7)
    ds_read_b128 v[56:59], v25 offset:1024
    ds_read_b128 v[60:63], v25 offset:2048
    v_mfma_f32_16x16x32_bf16 v[124:127], v[72:75], v[68:71], v[124:127]
    s_waitcnt lgkmcnt(4)
    ds_read_b128 v[64:67], v25 offset:3072
    ds_read_b128 v[68:71], v26 offset:0
    v_mfma_f32_16x16x32_bf16 v[84:87], v[108:111], v[76:79], v[84:87]
    ds_read_b128 v[72:75], v26 offset:1024
    buffer_store_dwordx4 v[28:31], v1, s[8:11], s55 offen sc1
    s_waitcnt lgkmcnt(6)
    v_mfma_f32_16x16x32_bf16 v[88:91], v[112:115], v[76:79], v[88:91]
    v_xor_b32 v21, 0x2000, v21
    v_xor_b32 v22, 0x2000, v22
    v_mfma_f32_16x16x32_bf16 v[124:127], v[80:83], v[76:79], v[124:127]
    v_max3_f32 v104, v84, v85, v86
    ds_read_b128 v[76:79], v26 offset:2048
    ds_read_b128 v[80:83], v26 offset:3072
    v_max3_f32 v105, v87, v88, v89
    v_max3_f32 v104, v104, v90, v91
    ds_read_b128 v[92:95], v25 offset:4096
    ds_read_b128 v[96:99], v25 offset:5120
    v_max3_f32 v105, v105, v124, v125
    v_max_f32 v104, v104, v105
    v_mov_b32 v105, v104
    ds_read_b128 v[108:111], v25 offset:6144
    ds_read_b128 v[112:115], v25 offset:7168
    v_permlane16_swap_b32 v104, v105
    v_max_f32 v104, v104, v105
    v_mov_b32 v105, v104
    ds_read_b128 v[116:119], v26 offset:4096
    ds_read_b128 v[120:123], v26 offset:5120
    v_permlane32_swap_b32 v104, v105
    v_max_f32 v104, v104, v105
    v_mul_f32 v104, s62, v104
    v_fma_f32 v84, v84, s62, -v104
    v_fma_f32 v85, v85, s62, -v104
    v_fma_f32 v86, v86, s62, -v104
    v_fma_f32 v87, v87, s62, -v104
    v_fma_f32 v88, v88, s62, -v104
    v_fma_f32 v89, v89, s62, -v104
    v_fma_f32 v90, v90, s62, -v104
    v_fma_f32 v91, v91, s62, -v104
    v_fma_f32 v124, v124, s62, -v104
    v_fma_f32 v125, v125, s62, -v104
    v_exp_f32 v84, v84
    v_exp_f32 v85, v85
    v_exp_f32 v86, v86
    v_exp_f32 v87, v87
    v_exp_f32 v88, v88
    v_exp_f32 v89, v89
    v_exp_f32 v90, v90
    v_exp_f32 v91, v91
    v_exp_f32 v124, v124
    v_exp_f32 v125, v125
    v_cvt_pk_bf16_f32 v100, v84, v85
    v_cvt_pk_bf16_f32 v101, v86, v87
    v_cvt_pk_bf16_f32 v102, v88, v89
    v_cvt_pk_bf16_f32 v103, v90, v91
    v_cvt_pk_bf16_f32 v32, v124, v125
    v_xor_b32 v23, 0x2000, v23
    v_mfma_f32_16x16x32_bf16 v[124:127], v[4:7], v[100:103], 0
    v_mfma_f32_16x16x32_bf16 v[84:87], v[36:39], v[100:103], 0
    v_mfma_f32_16x16x32_bf16 v[88:91], v[40:43], v[100:103], 0
    v_mfma_f32_16x16x32_bf16 v[124:127], v[4:7], v[32:35], v[124:127]
    v_mfma_f32_16x16x32_bf16 v[84:87], v[28:31], v[32:35], v[84:87]
    v_mfma_f32_16x16x32_bf16 v[88:91], v[30:33], v[32:35], v[88:91]
    v_add_f32 v124, v124, v125
    v_rcp_f32 v124, v124
    v_cndmask_b32 v84, v86, v84, vcc
    v_cndmask_b32 v85, v87, v85, vcc
    v_mul_f32 v84, v84, v124
    v_mul_f32 v85, v85, v124
    v_cndmask_b32 v88, v90, v88, vcc
    v_cndmask_b32 v89, v91, v89, vcc
    v_cvt_pk_bf16_f32 v84, v84, v85
    v_mul_f32 v88, v88, v124
    v_mul_f32 v89, v89, v124
    ds_write_b32 v19, v84 offset:0
    v_cvt_pk_bf16_f32 v88, v88, v89
    ds_write_b32 v19, v88 offset:32
    v_mov_b64 v[124:125], 0
    v_mov_b64 v[126:127], 0
    v_mov_b64 v[88:89], 0
    v_mov_b64 v[90:91], 0
    s_waitcnt lgkmcnt(0)
    s_barrier
    ds_read_b128 v[36:39], v24 offset:0
    ds_read_b128 v[40:43], v24 offset:64
    ds_read_b128 v[100:103], v24 offset:128
    ds_read_b128 v[104:107], v24 offset:192
    s_waitcnt lgkmcnt(3)
    v_smfmac_f32_16x16x64_bf16 v[124:127], v[36:39], v[52:59], v0
    s_waitcnt lgkmcnt(2)
    ds_read_b128 v[52:55], v26 offset:6144
    v_smfmac_f32_16x16x64_bf16 v[124:127], v[40:43], v[60:67], v0
    s_waitcnt lgkmcnt(2)
    ds_read_b128 v[56:59], v26 offset:7168
    v_smfmac_f32_16x16x64_bf16 v[124:127], v[100:103], v[68:75], v0
    s_waitcnt lgkmcnt(2)
    ds_read_b128 v[60:63], v25 offset:8192
    v_smfmac_f32_16x16x64_bf16 v[124:127], v[104:107], v[76:83], v0
    ds_read_b128 v[64:67], v25 offset:9216
    v_smfmac_f32_16x16x64_bf16 v[88:91], v[36:39], v[92:99], v0
    ds_read_b128 v[68:71], v25 offset:10240
    v_smfmac_f32_16x16x64_bf16 v[88:91], v[40:43], v[108:115], v0
    ds_read_b128 v[72:75], v25 offset:11264
    ds_read_b128 v[76:79], v26 offset:8192
    v_smfmac_f32_16x16x64_bf16 v[88:91], v[100:103], v[116:123], v0
    s_waitcnt lgkmcnt(5)
    ds_read_b128 v[80:83], v26 offset:9216
    ds_read_b128 v[92:95], v26 offset:10240
    v_smfmac_f32_16x16x64_bf16 v[88:91], v[104:107], v[52:59], v0
    v_cvt_pk_bf16_f32 v84, v124, v125
    v_cvt_pk_bf16_f32 v85, v126, v127
    ds_read_b128 v[96:99], v26 offset:11264
    v_mov_b64 v[124:125], 0
    v_mov_b64 v[126:127], 0
    ds_read_b128 v[108:111], v25 offset:12288
    ds_read_b128 v[112:115], v25 offset:13312
    s_waitcnt lgkmcnt(8)
    v_smfmac_f32_16x16x64_bf16 v[124:127], v[36:39], v[60:67], v0
    s_waitcnt lgkmcnt(6)
    ds_read_b128 v[116:119], v25 offset:14336
    v_smfmac_f32_16x16x64_bf16 v[124:127], v[40:43], v[68:75], v0
    s_waitcnt lgkmcnt(5)
    ds_read_b128 v[120:123], v25 offset:15360
    ds_read_b128 v[52:55], v26 offset:12288
    v_smfmac_f32_16x16x64_bf16 v[124:127], v[100:103], v[76:83], v0
    s_waitcnt lgkmcnt(5)
    ds_read_b128 v[56:59], v26 offset:13312
    ds_read_b128 v[60:63], v26 offset:14336
    v_smfmac_f32_16x16x64_bf16 v[124:127], v[104:107], v[92:99], v0
    v_cvt_pk_bf16_f32 v86, v88, v89
    v_cvt_pk_bf16_f32 v87, v90, v91
    ds_read_b128 v[64:67], v26 offset:15360
    v_mov_b64 v[88:89], 0
    v_mov_b64 v[90:91], 0
    v_and_or_b32 v84, v84, -2, s56
    buffer_store_dwordx4 v[84:87], v3, s[8:11], s12 offen
    s_waitcnt lgkmcnt(6)
    v_smfmac_f32_16x16x64_bf16 v[88:91], v[36:39], v[108:115], v0
    v_cvt_pk_bf16_f32 v84, v124, v125
    s_waitcnt lgkmcnt(4)
    v_smfmac_f32_16x16x64_bf16 v[88:91], v[40:43], v[116:123], v0
    v_cvt_pk_bf16_f32 v85, v126, v127
    v_and_or_b32 v84, v84, -2, s56
    s_waitcnt lgkmcnt(2)
    v_smfmac_f32_16x16x64_bf16 v[88:91], v[100:103], v[52:59], v0
    s_waitcnt lgkmcnt(0)
    v_smfmac_f32_16x16x64_bf16 v[88:91], v[104:107], v[60:67], v0
    s_nop 7
    v_cvt_pk_bf16_f32 v86, v88, v89
    v_cvt_pk_bf16_f32 v87, v90, v91
    buffer_store_dwordx4 v[84:87], v3, s[8:11], s13 offen
    s_waitcnt vmcnt(1)
    s_nop 1
    v_mov_b64 v[84:85], 0
    v_mov_b64 v[86:87], 0
    v_mov_b64 v[88:89], 0
    v_mov_b64 v[90:91], 0
    v_mov_b64 v[92:93], 0
    v_mov_b64 v[94:95], 0
    v_mov_b64 v[96:97], 0
    v_mov_b64 v[98:99], 0
    v_mov_b64 v[100:101], 0
    v_mov_b64 v[102:103], 0
    v_mov_b64 v[104:105], 0
    v_mov_b64 v[106:107], 0
    v_mov_b64 v[36:37], v[44:45]
    v_mov_b64 v[38:39], v[46:47]
    v_mov_b64 v[40:41], v[48:49]
    v_mov_b64 v[42:43], v[50:51]
    buffer_load_dwordx4 v[52:55], v2, s[8:11], s40 offen sc1
    buffer_load_dwordx4 v[56:59], v2, s[8:11], s41 offen sc1
    s_waitcnt vmcnt(0)
    v_mfma_f32_16x16x32_bf16 v[64:67], v[8:11], v[52:55], 0
    v_mfma_f32_16x16x32_bf16 v[64:67], v[8:11], v[56:59], v[64:67]
    v_xor_b32 v60, s56, v52
    v_xor_b32 v61, s56, v56
    v_or_b32 v60, v60, v61
    v_and_b32 v60, 1, v60
    v_cmp_eq_u32 vcc, 1, v60
    s_cbranch_vccz L_rs_ok_47
L_poll_rs_39:
    s_mov_b64 exec, vcc
    buffer_load_dwordx4 v[52:55], v2, s[8:11], s40 offen sc1
    buffer_load_dwordx4 v[56:59], v2, s[8:11], s41 offen sc1
    s_waitcnt vmcnt(0)
    v_xor_b32 v60, s56, v52
    v_xor_b32 v61, s56, v56
    v_or_b32 v60, v60, v61
    v_and_b32 v60, 1, v60
    v_cmp_eq_u32 vcc, 1, v60
    s_cbranch_vccz L_ok_48
    s_add_u32 s63, s63, 1
    s_cmp_lt_u32 s63, 0x80000
    s_cbranch_scc1 L_poll_rs_39
    s_branch L_end_1
L_ok_48:
    s_mov_b64 exec, -1
    s_nop 1
    v_mfma_f32_16x16x32_bf16 v[64:67], v[8:11], v[52:55], 0
    v_mfma_f32_16x16x32_bf16 v[64:67], v[8:11], v[56:59], v[64:67]
    s_nop 5
L_rs_ok_47:
    s_nop 2
    v_add_f32_dpp v64, v64, v64 row_ror:4 row_mask:0xf bank_mask:0xf
    v_add_f32_dpp v65, v65, v65 row_ror:4 row_mask:0xf bank_mask:0xf
    v_add_f32_dpp v66, v66, v66 row_ror:4 row_mask:0xf bank_mask:0xf
    v_add_f32_dpp v67, v67, v67 row_ror:4 row_mask:0xf bank_mask:0xf
    v_add_f32_dpp v64, v64, v64 row_ror:8 row_mask:0xf bank_mask:0xf
    v_add_f32_dpp v65, v65, v65 row_ror:8 row_mask:0xf bank_mask:0xf
    v_add_f32_dpp v66, v66, v66 row_ror:8 row_mask:0xf bank_mask:0xf
    v_add_f32_dpp v67, v67, v67 row_ror:8 row_mask:0xf bank_mask:0xf
    v_cvt_pk_bf16_f32 v64, v64, v65
    v_cvt_pk_bf16_f32 v65, v66, v67
    v_min_u32 v64, -2, v64
    v_min_u32 v65, -2, v65
    buffer_store_dwordx2 v[64:65], v27, s[8:11], s37 offen
    v_mov_b32 v118, -1
    v_mov_b32 v119, -1
    buffer_store_dwordx2 v[118:119], v27, s[8:11], s36 offen
    s_mov_b32 s58, s36
    s_mov_b32 s36, s37
    s_mov_b32 s37, s38
    s_mov_b32 s38, s58
    s_add_u32 s55, s55, 0x40000
    s_xor_b32 s56, s56, 1
    s_add_u32 s43, s43, 0x40000
    s_add_u32 s54, s54, 0x40000
    s_xor_b32 s57, s57, 0x2000
    s_mov_b32 m0, s57
    s_add_u32 s59, s35, 2
    s_lshr_b32 s59, s59, 2
    s_min_u32 s59, s59, 15
    s_cmp_lt_u32 s59, s95
    s_cbranch_scc1 L_kv_ok_49
L_kv_again_50:
    v_mbcnt_lo_u32_b32 v80, -1, 0
    v_mbcnt_hi_u32_b32 v80, -1, v80
    v_and_b32 v80, 15, v80
    v_lshlrev_b32 v80, 2, v80
    global_load_dword v81, v80, s[4:5] offset:128 sc1
    s_waitcnt vmcnt(0)
    v_and_b32 v81, 0xffff, v81
    v_cmp_le_u32 vcc, 64, v81
    s_nop 3
    s_not_b32 s58, vcc_lo
    s_or_b32 s58, s58, 0x10000
    s_ff1_i32_b32 s95, s58
    s_cmp_lt_u32 s59, s95
    s_cbranch_scc1 L_kv_ok_49_t
    s_add_u32 s63, s63, 1
    s_cmp_lt_u32 s63, 0x80000
    s_cbranch_scc0 L_end_1
    s_sleep 32
    s_branch L_kv_again_50
L_kv_ok_49_t:
L_kv_ok_49:
    s_waitcnt vmcnt(0)
    s_add_u32 s35, s35, 1
    s_mov_b32 s98, s35
    s_branch L_step_38
L_fin_40:
    s_barrier
    v_mov_b32 v117, s98
    ds_read_b128 v[52:55], v14 offset:0
    ds_read_b128 v[56:59], v15 offset:128
    ds_read_b128 v[60:63], v14 offset:256
    ds_read_b128 v[64:67], v15 offset:384
    ds_read_b128 v[68:71], v14 offset:512
    ds_read_b128 v[72:75], v15 offset:640
    ds_read_b128 v[76:79], v14 offset:768
    ds_read_b128 v[80:83], v15 offset:896
    s_waitcnt lgkmcnt(7)
    v_smfmac_f32_16x16x64_bf16 v[92:95], v[52:55], a[128:135], v0
    v_smfmac_f32_16x16x64_bf16 v[96:99], v[52:55], a[192:199], v0
    s_waitcnt lgkmcnt(6)
    v_smfmac_f32_16x16x64_bf16 v[92:95], v[56:59], a[136:143], v0
    v_smfmac_f32_16x16x64_bf16 v[96:99], v[56:59], a[200:207], v0
    s_waitcnt lgkmcnt(5)
    v_smfmac_f32_16x16x64_bf16 v[92:95], v[60:63], a[144:151], v0
    buffer_store_dword v117, off, s[8:11], s99 sc1
    v_smfmac_f32_16x16x64_bf16 v[96:99], v[60:63], a[208:215], v0
    s_waitcnt lgkmcnt(4)
    v_smfmac_f32_16x16x64_bf16 v[92:95], v[64:67], a[152:159], v0
    v_smfmac_f32_16x16x64_bf16 v[96:99], v[64:67], a[216:223], v0
    s_waitcnt lgkmcnt(3)
    v_smfmac_f32_16x16x64_bf16 v[92:95], v[68:71], a[160:167], v0
    v_smfmac_f32_16x16x64_bf16 v[96:99], v[68:71], a[224:231], v0
    s_waitcnt lgkmcnt(2)
    v_smfmac_f32_16x16x64_bf16 v[92:95], v[72:75], a[168:175], v0
    v_smfmac_f32_16x16x64_bf16 v[96:99], v[72:75], a[232:239], v0
    s_waitcnt lgkmcnt(1)
    v_smfmac_f32_16x16x64_bf16 v[92:95], v[76:79], a[176:183], v0
    v_smfmac_f32_16x16x64_bf16 v[96:99], v[76:79], a[240:247], v0
    s_waitcnt lgkmcnt(0)
    v_smfmac_f32_16x16x64_bf16 v[92:95], v[80:83], a[184:191], v0
    v_smfmac_f32_16x16x64_bf16 v[96:99], v[80:83], a[248:255], v0
    v_smfmac_f32_16x16x64_bf16 v[100:103], v[52:55], v[128:135], v0
    v_add_f32 v92, v92, v94
    v_smfmac_f32_16x16x64_bf16 v[104:107], v[52:55], v[192:199], v0
    v_add_f32 v93, v93, v95
    v_smfmac_f32_16x16x64_bf16 v[100:103], v[56:59], v[136:143], v0
    v_add_f32 v96, v96, v98
    v_smfmac_f32_16x16x64_bf16 v[104:107], v[56:59], v[200:207], v0
    v_add_f32 v97, v97, v99
    v_smfmac_f32_16x16x64_bf16 v[100:103], v[60:63], v[144:151], v0
    v_cvt_pk_bf16_f32 v29, v92, v93
    v_smfmac_f32_16x16x64_bf16 v[104:107], v[60:63], v[208:215], v0
    v_cvt_pk_bf16_f32 v31, v96, v97
    v_smfmac_f32_16x16x64_bf16 v[100:103], v[64:67], v[152:159], v0
    v_smfmac_f32_16x16x64_bf16 v[104:107], v[64:67], v[216:223], v0
    v_smfmac_f32_16x16x64_bf16 v[100:103], v[68:71], v[160:167], v0
    v_smfmac_f32_16x16x64_bf16 v[104:107], v[68:71], v[224:231], v0
    v_smfmac_f32_16x16x64_bf16 v[100:103], v[72:75], v[168:175], v0
    v_smfmac_f32_16x16x64_bf16 v[104:107], v[72:75], v[232:239], v0
    v_smfmac_f32_16x16x64_bf16 v[100:103], v[76:79], v[176:183], v0
    v_smfmac_f32_16x16x64_bf16 v[104:107], v[76:79], v[240:247], v0
    v_smfmac_f32_16x16x64_bf16 v[100:103], v[80:83], v[184:191], v0
    v_smfmac_f32_16x16x64_bf16 v[104:107], v[80:83], v[248:255], v0
    s_nop 3
    v_add_f32 v100, v100, v102
    v_add_f32 v101, v101, v103
    v_cvt_pk_bf16_f32 v28, v100, v101
    s_nop 0
    v_add_f32 v104, v104, v106
    v_add_f32 v105, v105, v107
    v_cvt_pk_bf16_f32 v30, v104, v105
    buffer_store_dwordx4 v[28:31], v1, s[8:11], s55 offen sc1
    s_waitcnt vmcnt(0)
    s_barrier
    v_mov_b32 v127, 1
    buffer_store_dword v127, off, s[8:11], s94 sc1
    s_branch L_end_1
L_slowpath_18:
    s_mov_b32 s59, 0
    s_cmp_lt_u32 s59, s95
    s_cbranch_scc1 L_kv_ok_55
L_kv_again_56:
    v_mbcnt_lo_u32_b32 v80, -1, 0
    v_mbcnt_hi_u32_b32 v80, -1, v80
    v_and_b32 v80, 15, v80
    v_lshlrev_b32 v80, 2, v80
    global_load_dword v81, v80, s[4:5] offset:128 sc1
    s_waitcnt vmcnt(0)
    v_and_b32 v81, 0xffff, v81
    v_cmp_le_u32 vcc, 64, v81
    s_nop 3
    s_not_b32 s58, vcc_lo
    s_or_b32 s58, s58, 0x10000
    s_ff1_i32_b32 s95, s58
    s_cmp_lt_u32 s59, s95
    s_cbranch_scc1 L_kv_ok_55_t
    s_add_u32 s63, s63, 1
    s_cmp_lt_u32 s63, 0x80000
    s_cbranch_scc0 L_end_1
    s_sleep 32
    s_branch L_kv_again_56
L_kv_ok_55_t:
L_kv_ok_55:
    s_cmp_eq_u32 s69, 1
    s_cbranch_scc1 L_pf0_57
    s_lshl_b32 s58, s33, 13
    s_add_u32 s43, s58, 0x1000000
    s_add_u32 s54, s58, 0x2000000
    s_add_u32 s55, s58, 0x3000000
    s_lshl_b32 s57, s32, 11
    s_add_u32 s57, s57, 131072
    s_mov_b32 m0, s57
    s_nop 0
    buffer_load_dwordx4 v1, s[8:11], s43 offen sc1 lds
    buffer_load_dwordx4 v1, s[8:11], s43 offen offset:1024 sc1 lds
    buffer_load_dwordx4 v[36:39], v1, s[8:11], s54 offen sc1
    buffer_load_dwordx4 v[40:43], v1, s[8:11], s54 offen offset:1024 sc1
L_pf0_57:
    s_mov_b32 s56, 0
    s_mov_b32 s98, 0
    s_mov_b32 s35, 0
    s_mov_b32 s36, 0x4100000
    s_mov_b32 s37, 0x4102000
    s_mov_b32 s38, 0x4104000
    s_mul_i32 s58, s33, 8192
    s_add_u32 s40, s58, 0x4000000
    s_add_u32 s41, s40, 1024
    s_mov_b32 s12, 0x4000000
    s_mov_b32 s13, 0x4008000
    s_waitcnt vmcnt(0)
    v_mov_b64 v[84:85], 0
    v_mov_b64 v[86:87], 0
    v_mov_b64 v[88:89], 0
    v_mov_b64 v[90:91], 0
    v_mov_b64 v[92:93], 0
    v_mov_b64 v[94:95], 0
    v_mov_b64 v[96:97], 0
    v_mov_b64 v[98:99], 0
    v_mov_b64 v[100:101], 0
    v_mov_b64 v[102:103], 0
    v_mov_b64 v[104:105], 0
    v_mov_b64 v[106:107], 0
    s_add_u32 s43, s43, 0x40000
    s_add_u32 s54, s54, 0x40000
    s_xor_b32 s57, s57, 0x2000
    s_mov_b32 m0, s57
L_step_52:
    buffer_load_dwordx4 v[108:111], v1, s[8:11], s36 offen sc1
    buffer_load_dwordx4 v[112:115], v1, s[8:11], s36 offen offset:1024 sc1
    s_waitcnt vmcnt(0)
    ds_write_b128 v12, v[108:111]
    ds_write_b128 v13, v[112:115]
    v_max3_u32 v116, v108, v109, v110
    v_max3_u32 v117, v111, v112, v113
    v_max3_u32 v116, v116, v114, v115
    v_max_u32 v116, v116, v117
    v_cmp_eq_u32 vcc, -1, v116
    s_cbranch_vccz L_ag_ok_59
L_poll_ag_58:
    s_mov_b64 exec, vcc
    buffer_load_dwordx4 v[108:111], v1, s[8:11], s36 offen sc1
    buffer_load_dwordx4 v[112:115], v1, s[8:11], s36 offen offset:1024 sc1
    s_waitcnt vmcnt(0)
    ds_write_b128 v12, v[108:111]
    ds_write_b128 v13, v[112:115]
    v_max3_u32 v116, v108, v109, v110
    v_max3_u32 v117, v111, v112, v113
    v_max3_u32 v116, v116, v114, v115
    v_max_u32 v116, v116, v117
    v_cmp_eq_u32 vcc, -1, v116
    s_cbranch_vccz L_ok_60
    s_add_u32 s63, s63, 1
    s_cmp_lt_u32 s63, 0x80000
    s_cbranch_scc1 L_poll_ag_58
    s_branch L_end_1
L_ok_60:
    s_mov_b64 exec, -1
L_ag_ok_59:
    s_waitcnt lgkmcnt(0)
    s_cmp_eq_u32 s35, 63
    s_cbranch_scc1 L_fin_54
    s_barrier
    v_mov_b32 v117, s98
    v_cmp_eq_u32 vcc, 0x4444, v0
    ds_read_b128 v[52:55], v14 offset:0
    ds_read_b128 v[56:59], v15 offset:128
    ds_read_b128 v[60:63], v14 offset:256
    ds_read_b128 v[64:67], v15 offset:384
    ds_read_b128 v[68:71], v14 offset:512
    ds_read_b128 v[72:75], v15 offset:640
    ds_read_b128 v[76:79], v14 offset:768
    ds_read_b128 v[80:83], v15 offset:896
    s_waitcnt lgkmcnt(7)
    v_smfmac_f32_16x16x64_bf16 v[84:87], v[52:55], a[0:7], v0
    v_smfmac_f32_16x16x64_bf16 v[88:91], v[52:55], a[64:71], v0
    s_waitcnt lgkmcnt(6)
    v_smfmac_f32_16x16x64_bf16 v[84:87], v[56:59], a[8:15], v0
    v_smfmac_f32_16x16x64_bf16 v[88:91], v[56:59], a[72:79], v0
    s_waitcnt lgkmcnt(5)
    v_smfmac_f32_16x16x64_bf16 v[84:87], v[60:63], a[16:23], v0
    buffer_load_dwordx4 v1, s[8:11], s43 offen sc1 lds
    v_smfmac_f32_16x16x64_bf16 v[88:91], v[60:63], a[80:87], v0
    s_waitcnt lgkmcnt(4)
    v_smfmac_f32_16x16x64_bf16 v[84:87], v[64:67], a[24:31], v0
    v_smfmac_f32_16x16x64_bf16 v[88:91], v[64:67], a[88:95], v0
    s_waitcnt lgkmcnt(3)
    v_smfmac_f32_16x16x64_bf16 v[84:87], v[68:71], a[32:39], v0
    v_smfmac_f32_16x16x64_bf16 v[88:91], v[68:71], a[96:103], v0
    s_waitcnt lgkmcnt(2)
    v_smfmac_f32_16x16x64_bf16 v[84:87], v[72:75], a[40:47], v0
    buffer_load_dwordx4 v1, s[8:11], s43 offen offset:1024 sc1 lds
    v_smfmac_f32_16x16x64_bf16 v[88:91], v[72:75], a[104:111], v0
    s_waitcnt lgkmcnt(1)
    v_smfmac_f32_16x16x64_bf16 v[84:87], v[76:79], a[48:55], v0
    v_smfmac_f32_16x16x64_bf16 v[88:91], v[76:79], a[112:119], v0
    s_waitcnt lgkmcnt(0)
    v_smfmac_f32_16x16x64_bf16 v[84:87], v[80:83], a[56:63], v0
    v_smfmac_f32_16x16x64_bf16 v[88:91], v[80:83], a[120:127], v0
    v_smfmac_f32_16x16x64_bf16 v[92:95], v[52:55], a[128:135], v0
    buffer_load_dwordx4 v[44:47], v1, s[8:11], s54 offen sc1
    v_smfmac_f32_16x16x64_bf16 v[92:95], v[56:59], a[136:143], v0
    v_add_f32 v84, v84, v86
    v_smfmac_f32_16x16x64_bf16 v[92:95], v[60:63], a[144:151], v0
    v_add_f32 v85, v85, v87
    v_smfmac_f32_16x16x64_bf16 v[92:95], v[64:67], a[152:159], v0
    v_cvt_pk_bf16_f32 v122, v84, v85
    v_smfmac_f32_16x16x64_bf16 v[92:95], v[68:71], a[160:167], v0
    v_add_f32 v88, v88, v90
    v_smfmac_f32_16x16x64_bf16 v[92:95], v[72:75], a[168:175], v0
    v_add_f32 v89, v89, v91
    v_smfmac_f32_16x16x64_bf16 v[92:95], v[76:79], a[176:183], v0
    ds_write2_b32 v16, v122, v122 offset0:0 offset1:1
    v_smfmac_f32_16x16x64_bf16 v[92:95], v[80:83], a[184:191], v0
    v_cvt_pk_bf16_f32 v123, v88, v89
    v_smfmac_f32_16x16x64_bf16 v[96:99], v[52:55], a[192:199], v0
    ds_write2_b32 v16, v123, v123 offset0:128 offset1:129
    v_smfmac_f32_16x16x64_bf16 v[96:99], v[56:59], a[200:207], v0
    v_add_f32 v92, v92, v94
    v_smfmac_f32_16x16x64_bf16 v[96:99], v[60:63], a[208:215], v0
    v_add_f32 v93, v93, v95
    v_smfmac_f32_16x16x64_bf16 v[96:99], v[64:67], a[216:223], v0
    v_cvt_pk_bf16_f32 v29, v92, v93
    v_smfmac_f32_16x16x64_bf16 v[96:99], v[68:71], a[224:231], v0
    ds_write_b32 v16, v29 offset:4096
    v_smfmac_f32_16x16x64_bf16 v[96:99], v[72:75], a[232:239], v0
    buffer_load_dwordx4 v[48:51], v1, s[8:11], s54 offen offset:1024 sc1
    v_smfmac_f32_16x16x64_bf16 v[96:99], v[76:79], a[240:247], v0
    v_smfmac_f32_16x16x64_bf16 v[96:99], v[80:83], a[248:255], v0
    v_smfmac_f32_16x16x64_bf16 v[100:103], v[52:55], v[128:135], v0
    v_smfmac_f32_16x16x64_bf16 v[104:107], v[52:55], v[192:199], v0
    v_add_f32 v96, v96, v98
    v_smfmac_f32_16x16x64_bf16 v[100:103], v[56:59], v[136:143], v0
    v_add_f32 v97, v97, v99
    v_smfmac_f32_16x16x64_bf16 v[104:107], v[56:59], v[200:207], v0
    v_cvt_pk_bf16_f32 v31, v96, v97
    v_smfmac_f32_16x16x64_bf16 v[100:103], v[60:63], v[144:151], v0
    ds_write_b32 v16, v31 offset:4608
    v_smfmac_f32_16x16x64_bf16 v[104:107], v[60:63], v[208:215], v0
    ds_read_b128 v[108:111], v20 offset:0
    v_smfmac_f32_16x16x64_bf16 v[100:103], v[64:67], v[152:159], v0
    ds_read_b128 v[112:115], v20 offset:4096
    v_smfmac_f32_16x16x64_bf16 v[104:107], v[64:67], v[216:223], v0
    ds_read_b128 v[52:55], v21 offset:0
    v_smfmac_f32_16x16x64_bf16 v[100:103], v[68:71], v[160:167], v0
    ds_read_b128 v[56:59], v21 offset:4096
    v_smfmac_f32_16x16x64_bf16 v[104:107], v[68:71], v[224:231], v0
    ds_read_b128 v[60:63], v22 offset:0
    v_smfmac_f32_16x16x64_bf16 v[100:103], v[72:75], v[168:175], v0
    ds_read_b128 v[64:67], v22 offset:4096
    v_smfmac_f32_16x16x64_bf16 v[104:107], v[72:75], v[232:239], v0
    s_waitcnt lgkmcnt(6)
    s_barrier
    buffer_store_dword v117, off, s[8:11], s99 sc1
    v_smfmac_f32_16x16x64_bf16 v[100:103], v[76:79], v[176:183], v0
    v_xor_b32 v20, 0x2000, v20
    ds_read_b64_tr_b16 v[116:117], v17 offset:0
    ds_read_b64_tr_b16 v[118:119], v18 offset:0
    v_smfmac_f32_16x16x64_bf16 v[104:107], v[76:79], v[240:247], v0
    ds_read_b64_tr_b16 v[120:121], v17 offset:4096
    v_smfmac_f32_16x16x64_bf16 v[100:103], v[80:83], v[184:191], v0
    ds_read_b64_tr_b16 v[122:123], v18 offset:4096
    ds_read_b64_tr_b16 v[92:93], v17 offset:1024
    ds_read_b64_tr_b16 v[94:95], v18 offset:1024
    v_smfmac_f32_16x16x64_bf16 v[104:107], v[80:83], v[248:255], v0
    s_waitcnt lgkmcnt(4)
    ds_read_b64_tr_b16 v[96:97], v17 offset:5120
    ds_read_b64_tr_b16 v[98:99], v18 offset:5120
    ds_read_b64_tr_b16 v[68:69], v17 offset:2048
    ds_read_b64_tr_b16 v[70:71], v18 offset:2048
    ds_read_b64_tr_b16 v[72:73], v17 offset:6144
    v_mfma_f32_16x16x32_bf16 v[84:87], v[108:111], v[116:119], 0
    ds_read_b64_tr_b16 v[74:75], v18 offset:6144
    ds_read_b64_tr_b16 v[76:77], v17 offset:3072
    v_mfma_f32_16x16x32_bf16 v[88:91], v[112:115], v[116:119], 0
    s_waitcnt lgkmcnt(9)
    ds_read_b64_tr_b16 v[78:79], v18 offset:3072
    ds_read_b64_tr_b16 v[80:81], v17 offset:7168
    v_mfma_f32_16x16x32_bf16 v[124:127], v[120:123], v[116:119], 0
    s_waitcnt lgkmcnt(9)
    ds_read_b64_tr_b16 v[82:83], v18 offset:7168
    ds_read_b128 v[108:111], v23 offset:0
    v_mfma_f32_16x16x32_bf16 v[84:87], v[52:55], v[92:95], v[84:87]
    ds_read_b128 v[112:115], v23 offset:4096
    v_add_f32 v104, v104, v106
    v_mfma_f32_16x16x32_bf16 v[88:91], v[56:59], v[92:95], v[88:91]
    v_add_f32 v105, v105, v107
    v_cvt_pk_bf16_f32 v30, v104, v105
    s_waitcnt lgkmcnt(10)
    v_mfma_f32_16x16x32_bf16 v[124:127], v[96:99], v[92:95], v[124:127]
    v_add_f32 v100, v100, v102
    v_add_f32 v101, v101, v103
    s_waitcnt lgkmcnt(8)
    v_mfma_f32_16x16x32_bf16 v[84:87], v[60:63], v[68:71], v[84:87]
    v_cvt_pk_bf16_f32 v28, v100, v101
    ds_read_b128 v[52:55], v25 offset:0
    v_mfma_f32_16x16x32_bf16 v[88:91], v[64:67], v[68:71], v[88:91]
    s_waitcnt lgkmcnt(7)
    ds_read_b128 v[56:59], v25 offset:1024
    ds_read_b128 v[60:63], v25 offset:2048
    v_mfma_f32_16x16x32_bf16 v[124:127], v[72:75], v[68:71], v[124:127]
    s_waitcnt lgkmcnt(4)
    ds_read_b128 v[64:67], v25 offset:3072
    ds_read_b128 v[68:71], v26 offset:0
    v_mfma_f32_16x16x32_bf16 v[84:87], v[108:111], v[76:79], v[84:87]
    ds_read_b128 v[72:75], v26 offset:1024
    buffer_store_dwordx4 v[28:31], v1, s[8:11], s55 offen sc1
    s_waitcnt lgkmcnt(6)
    v_mfma_f32_16x16x32_bf16 v[88:91], v[112:115], v[76:79], v[88:91]
    v_xor_b32 v21, 0x2000, v21
    v_xor_b32 v22, 0x2000, v22
    v_mfma_f32_16x16x32_bf16 v[124:127], v[80:83], v[76:79], v[124:127]
    v_max3_f32 v104, v84, v85, v86
    ds_read_b128 v[76:79], v26 offset:2048
    ds_read_b128 v[80:83], v26 offset:3072
    v_max3_f32 v105, v87, v88, v89
    v_max3_f32 v104, v104, v90, v91
    ds_read_b128 v[92:95], v25 offset:4096
    ds_read_b128 v[96:99], v25 offset:5120
    v_max3_f32 v105, v105, v124, v125
    v_max_f32 v104, v104, v105
    v_mov_b32 v105, v104
    ds_read_b128 v[108:111], v25 offset:6144
    ds_read_b128 v[112:115], v25 offset:7168
    v_permlane16_swap_b32 v104, v105
    v_max_f32 v104, v104, v105
    v_mov_b32 v105, v104
    ds_read_b128 v[116:119], v26 offset:4096
    ds_read_b128 v[120:123], v26 offset:5120
    v_permlane32_swap_b32 v104, v105
    v_max_f32 v104, v104, v105
    v_mul_f32 v104, s62, v104
    v_fma_f32 v84, v84, s62, -v104
    v_fma_f32 v85, v85, s62, -v104
    v_fma_f32 v86, v86, s62, -v104
    v_fma_f32 v87, v87, s62, -v104
    v_fma_f32 v88, v88, s62, -v104
    v_fma_f32 v89, v89, s62, -v104
    v_fma_f32 v90, v90, s62, -v104
    v_fma_f32 v91, v91, s62, -v104
    v_fma_f32 v124, v124, s62, -v104
    v_fma_f32 v125, v125, s62, -v104
    v_exp_f32 v84, v84
    v_exp_f32 v85, v85
    v_exp_f32 v86, v86
    v_exp_f32 v87, v87
    v_exp_f32 v88, v88
    v_exp_f32 v89, v89
    v_exp_f32 v90, v90
    v_exp_f32 v91, v91
    v_exp_f32 v124, v124
    v_exp_f32 v125, v125
    v_cvt_pk_bf16_f32 v100, v84, v85
    v_cvt_pk_bf16_f32 v101, v86, v87
    v_cvt_pk_bf16_f32 v102, v88, v89
    v_cvt_pk_bf16_f32 v103, v90, v91
    v_cvt_pk_bf16_f32 v32, v124, v125
    v_xor_b32 v23, 0x2000, v23
    v_mfma_f32_16x16x32_bf16 v[124:127], v[4:7], v[100:103], 0
    v_mfma_f32_16x16x32_bf16 v[84:87], v[36:39], v[100:103], 0
    v_mfma_f32_16x16x32_bf16 v[88:91], v[40:43], v[100:103], 0
    v_mfma_f32_16x16x32_bf16 v[124:127], v[4:7], v[32:35], v[124:127]
    v_mfma_f32_16x16x32_bf16 v[84:87], v[28:31], v[32:35], v[84:87]
    v_mfma_f32_16x16x32_bf16 v[88:91], v[30:33], v[32:35], v[88:91]
    v_add_f32 v124, v124, v125
    v_rcp_f32 v124, v124
    v_cndmask_b32 v84, v86, v84, vcc
    v_cndmask_b32 v85, v87, v85, vcc
    v_mul_f32 v84, v84, v124
    v_mul_f32 v85, v85, v124
    v_cndmask_b32 v88, v90, v88, vcc
    v_cndmask_b32 v89, v91, v89, vcc
    v_cvt_pk_bf16_f32 v84, v84, v85
    v_mul_f32 v88, v88, v124
    v_mul_f32 v89, v89, v124
    ds_write_b32 v19, v84 offset:0
    v_cvt_pk_bf16_f32 v88, v88, v89
    ds_write_b32 v19, v88 offset:32
    v_mov_b64 v[124:125], 0
    v_mov_b64 v[126:127], 0
    v_mov_b64 v[88:89], 0
    v_mov_b64 v[90:91], 0
    s_waitcnt lgkmcnt(0)
    s_barrier
    ds_read_b128 v[36:39], v24 offset:0
    ds_read_b128 v[40:43], v24 offset:64
    ds_read_b128 v[100:103], v24 offset:128
    ds_read_b128 v[104:107], v24 offset:192
    s_waitcnt lgkmcnt(3)
    v_smfmac_f32_16x16x64_bf16 v[124:127], v[36:39], v[52:59], v0
    s_waitcnt lgkmcnt(2)
    ds_read_b128 v[52:55], v26 offset:6144
    v_smfmac_f32_16x16x64_bf16 v[124:127], v[40:43], v[60:67], v0
    s_waitcnt lgkmcnt(2)
    ds_read_b128 v[56:59], v26 offset:7168
    v_smfmac_f32_16x16x64_bf16 v[124:127], v[100:103], v[68:75], v0
    s_waitcnt lgkmcnt(2)
    ds_read_b128 v[60:63], v25 offset:8192
    v_smfmac_f32_16x16x64_bf16 v[124:127], v[104:107], v[76:83], v0
    ds_read_b128 v[64:67], v25 offset:9216
    v_smfmac_f32_16x16x64_bf16 v[88:91], v[36:39], v[92:99], v0
    ds_read_b128 v[68:71], v25 offset:10240
    v_smfmac_f32_16x16x64_bf16 v[88:91], v[40:43], v[108:115], v0
    ds_read_b128 v[72:75], v25 offset:11264
    ds_read_b128 v[76:79], v26 offset:8192
    v_smfmac_f32_16x16x64_bf16 v[88:91], v[100:103], v[116:123], v0
    s_waitcnt lgkmcnt(5)
    ds_read_b128 v[80:83], v26 offset:9216
    ds_read_b128 v[92:95], v26 offset:10240
    v_smfmac_f32_16x16x64_bf16 v[88:91], v[104:107], v[52:59], v0
    v_cvt_pk_bf16_f32 v84, v124, v125
    v_cvt_pk_bf16_f32 v85, v126, v127
    ds_read_b128 v[96:99], v26 offset:11264
    v_mov_b64 v[124:125], 0
    v_mov_b64 v[126:127], 0
    ds_read_b128 v[108:111], v25 offset:12288
    ds_read_b128 v[112:115], v25 offset:13312
    s_waitcnt lgkmcnt(8)
    v_smfmac_f32_16x16x64_bf16 v[124:127], v[36:39], v[60:67], v0
    s_waitcnt lgkmcnt(6)
    ds_read_b128 v[116:119], v25 offset:14336
    v_smfmac_f32_16x16x64_bf16 v[124:127], v[40:43], v[68:75], v0
    s_waitcnt lgkmcnt(5)
    ds_read_b128 v[120:123], v25 offset:15360
    ds_read_b128 v[52:55], v26 offset:12288
    v_smfmac_f32_16x16x64_bf16 v[124:127], v[100:103], v[76:83], v0
    s_waitcnt lgkmcnt(5)
    ds_read_b128 v[56:59], v26 offset:13312
    ds_read_b128 v[60:63], v26 offset:14336
    v_smfmac_f32_16x16x64_bf16 v[124:127], v[104:107], v[92:99], v0
    v_cvt_pk_bf16_f32 v86, v88, v89
    v_cvt_pk_bf16_f32 v87, v90, v91
    ds_read_b128 v[64:67], v26 offset:15360
    v_mov_b64 v[88:89], 0
    v_mov_b64 v[90:91], 0
    v_and_or_b32 v84, v84, -2, s56
    buffer_store_dwordx4 v[84:87], v3, s[8:11], s12 offen sc1
    s_waitcnt lgkmcnt(6)
    v_smfmac_f32_16x16x64_bf16 v[88:91], v[36:39], v[108:115], v0
    v_cvt_pk_bf16_f32 v84, v124, v125
    s_waitcnt lgkmcnt(4)
    v_smfmac_f32_16x16x64_bf16 v[88:91], v[40:43], v[116:123], v0
    v_cvt_pk_bf16_f32 v85, v126, v127
    v_and_or_b32 v84, v84, -2, s56
    s_waitcnt lgkmcnt(2)
    v_smfmac_f32_16x16x64_bf16 v[88:91], v[100:103], v[52:59], v0
    s_waitcnt lgkmcnt(0)
    v_smfmac_f32_16x16x64_bf16 v[88:91], v[104:107], v[60:67], v0
    s_nop 7
    v_cvt_pk_bf16_f32 v86, v88, v89
    v_cvt_pk_bf16_f32 v87, v90, v91
    buffer_store_dwordx4 v[84:87], v3, s[8:11], s13 offen sc1
    s_waitcnt vmcnt(1)
    s_nop 1
    v_mov_b64 v[84:85], 0
    v_mov_b64 v[86:87], 0
    v_mov_b64 v[88:89], 0
    v_mov_b64 v[90:91], 0
    v_mov_b64 v[92:93], 0
    v_mov_b64 v[94:95], 0
    v_mov_b64 v[96:97], 0
    v_mov_b64 v[98:99], 0
    v_mov_b64 v[100:101], 0
    v_mov_b64 v[102:103], 0
    v_mov_b64 v[104:105], 0
    v_mov_b64 v[106:107], 0
    v_mov_b64 v[36:37], v[44:45]
    v_mov_b64 v[38:39], v[46:47]
    v_mov_b64 v[40:41], v[48:49]
    v_mov_b64 v[42:43], v[50:51]
    buffer_load_dwordx4 v[52:55], v2, s[8:11], s40 offen sc1
    buffer_load_dwordx4 v[56:59], v2, s[8:11], s41 offen sc1
    s_waitcnt vmcnt(0)
    v_mfma_f32_16x16x32_bf16 v[64:67], v[8:11], v[52:55], 0
    v_mfma_f32_16x16x32_bf16 v[64:67], v[8:11], v[56:59], v[64:67]
    v_xor_b32 v60, s56, v52
    v_xor_b32 v61, s56, v56
    v_or_b32 v60, v60, v61
    v_and_b32 v60, 1, v60
    v_cmp_eq_u32 vcc, 1, v60
    s_cbranch_vccz L_rs_ok_61
L_poll_rs_53:
    s_mov_b64 exec, vcc
    buffer_load_dwordx4 v[52:55], v2, s[8:11], s40 offen sc1
    buffer_load_dwordx4 v[56:59], v2, s[8:11], s41 offen sc1
    s_waitcnt vmcnt(0)
    v_xor_b32 v60, s56, v52
    v_xor_b32 v61, s56, v56
    v_or_b32 v60, v60, v61
    v_and_b32 v60, 1, v60
    v_cmp_eq_u32 vcc, 1, v60
    s_cbranch_vccz L_ok_62
    s_add_u32 s63, s63, 1
    s_cmp_lt_u32 s63, 0x80000
    s_cbranch_scc1 L_poll_rs_53
    s_branch L_end_1
L_ok_62:
    s_mov_b64 exec, -1
    s_nop 1
    v_mfma_f32_16x16x32_bf16 v[64:67], v[8:11], v[52:55], 0
    v_mfma_f32_16x16x32_bf16 v[64:67], v[8:11], v[56:59], v[64:67]
    s_nop 5
L_rs_ok_61:
    s_nop 2
    v_add_f32_dpp v64, v64, v64 row_ror:4 row_mask:0xf bank_mask:0xf
    v_add_f32_dpp v65, v65, v65 row_ror:4 row_mask:0xf bank_mask:0xf
    v_add_f32_dpp v66, v66, v66 row_ror:4 row_mask:0xf bank_mask:0xf
    v_add_f32_dpp v67, v67, v67 row_ror:4 row_mask:0xf bank_mask:0xf
    v_add_f32_dpp v64, v64, v64 row_ror:8 row_mask:0xf bank_mask:0xf
    v_add_f32_dpp v65, v65, v65 row_ror:8 row_mask:0xf bank_mask:0xf
    v_add_f32_dpp v66, v66, v66 row_ror:8 row_mask:0xf bank_mask:0xf
    v_add_f32_dpp v67, v67, v67 row_ror:8 row_mask:0xf bank_mask:0xf
    v_cvt_pk_bf16_f32 v64, v64, v65
    v_cvt_pk_bf16_f32 v65, v66, v67
    v_min_u32 v64, -2, v64
    v_min_u32 v65, -2, v65
    buffer_store_dwordx2 v[64:65], v27, s[8:11], s37 offen sc1
    v_mov_b32 v118, -1
    v_mov_b32 v119, -1
    buffer_store_dwordx2 v[118:119], v27, s[8:11], s36 offen sc1
    s_mov_b32 s58, s36
    s_mov_b32 s36, s37
    s_mov_b32 s37, s38
    s_mov_b32 s38, s58
    s_add_u32 s55, s55, 0x40000
    s_xor_b32 s56, s56, 1
    s_add_u32 s43, s43, 0x40000
    s_add_u32 s54, s54, 0x40000
    s_xor_b32 s57, s57, 0x2000
    s_mov_b32 m0, s57
    s_add_u32 s59, s35, 2
    s_lshr_b32 s59, s59, 2
    s_min_u32 s59, s59, 15
    s_cmp_lt_u32 s59, s95
    s_cbranch_scc1 L_kv_ok_63
L_kv_again_64:
    v_mbcnt_lo_u32_b32 v80, -1, 0
    v_mbcnt_hi_u32_b32 v80, -1, v80
    v_and_b32 v80, 15, v80
    v_lshlrev_b32 v80, 2, v80
    global_load_dword v81, v80, s[4:5] offset:128 sc1
    s_waitcnt vmcnt(0)
    v_and_b32 v81, 0xffff, v81
    v_cmp_le_u32 vcc, 64, v81
    s_nop 3
    s_not_b32 s58, vcc_lo
    s_or_b32 s58, s58, 0x10000
    s_ff1_i32_b32 s95, s58
    s_cmp_lt_u32 s59, s95
    s_cbranch_scc1 L_kv_ok_63_t
    s_add_u32 s63, s63, 1
    s_cmp_lt_u32 s63, 0x80000
    s_cbranch_scc0 L_end_1
    s_sleep 32
    s_branch L_kv_again_64
L_kv_ok_63_t:
L_kv_ok_63:
    s_waitcnt vmcnt(0)
    s_add_u32 s35, s35, 1
    s_mov_b32 s98, s35
    s_branch L_step_52
L_fin_54:
    s_barrier
    v_mov_b32 v117, s98
    ds_read_b128 v[52:55], v14 offset:0
    ds_read_b128 v[56:59], v15 offset:128
    ds_read_b128 v[60:63], v14 offset:256
    ds_read_b128 v[64:67], v15 offset:384
    ds_read_b128 v[68:71], v14 offset:512
    ds_read_b128 v[72:75], v15 offset:640
    ds_read_b128 v[76:79], v14 offset:768
    ds_read_b128 v[80:83], v15 offset:896
    s_waitcnt lgkmcnt(7)
    v_smfmac_f32_16x16x64_bf16 v[92:95], v[52:55], a[128:135], v0
    v_smfmac_f32_16x16x64_bf16 v[96:99], v[52:55], a[192:199], v0
    s_waitcnt lgkmcnt(6)
    v_smfmac_f32_16x16x64_bf16 v[92:95], v[56:59], a[136:143], v0
    v_smfmac_f32_16x16x64_bf16 v[96:99], v[56:59], a[200:207], v0
    s_waitcnt lgkmcnt(5)
    v_smfmac_f32_16x16x64_bf16 v[92:95], v[60:63], a[144:151], v0
    buffer_store_dword v117, off, s[8:11], s99 sc1
    v_smfmac_f32_16x16x64_bf16 v[96:99], v[60:63], a[208:215], v0
    s_waitcnt lgkmcnt(4)
    v_smfmac_f32_16x16x64_bf16 v[92:95], v[64:67], a[152:159], v0
    v_smfmac_f32_16x16x64_bf16 v[96:99], v[64:67], a[216:223], v0
    s_waitcnt lgkmcnt(3)
    v_smfmac_f32_16x16x64_bf16 v[92:95], v[68:71], a[160:167], v0
    v_smfmac_f32_16x16x64_bf16 v[96:99], v[68:71], a[224:231], v0
    s_waitcnt lgkmcnt(2)
    v_smfmac_f32_16x16x64_bf16 v[92:95], v[72:75], a[168:175], v0
    v_smfmac_f32_16x16x64_bf16 v[96:99], v[72:75], a[232:239], v0
    s_waitcnt lgkmcnt(1)
    v_smfmac_f32_16x16x64_bf16 v[92:95], v[76:79], a[176:183], v0
    v_smfmac_f32_16x16x64_bf16 v[96:99], v[76:79], a[240:247], v0
    s_waitcnt lgkmcnt(0)
    v_smfmac_f32_16x16x64_bf16 v[92:95], v[80:83], a[184:191], v0
    v_smfmac_f32_16x16x64_bf16 v[96:99], v[80:83], a[248:255], v0
    v_smfmac_f32_16x16x64_bf16 v[100:103], v[52:55], v[128:135], v0
    v_add_f32 v92, v92, v94
    v_smfmac_f32_16x16x64_bf16 v[104:107], v[52:55], v[192:199], v0
    v_add_f32 v93, v93, v95
    v_smfmac_f32_16x16x64_bf16 v[100:103], v[56:59], v[136:143], v0
    v_add_f32 v96, v96, v98
    v_smfmac_f32_16x16x64_bf16 v[104:107], v[56:59], v[200:207], v0
    v_add_f32 v97, v97, v99
    v_smfmac_f32_16x16x64_bf16 v[100:103], v[60:63], v[144:151], v0
    v_cvt_pk_bf16_f32 v29, v92, v93
    v_smfmac_f32_16x16x64_bf16 v[104:107], v[60:63], v[208:215], v0
    v_cvt_pk_bf16_f32 v31, v96, v97
    v_smfmac_f32_16x16x64_bf16 v[100:103], v[64:67], v[152:159], v0
    v_smfmac_f32_16x16x64_bf16 v[104:107], v[64:67], v[216:223], v0
    v_smfmac_f32_16x16x64_bf16 v[100:103], v[68:71], v[160:167], v0
    v_smfmac_f32_16x16x64_bf16 v[104:107], v[68:71], v[224:231], v0
    v_smfmac_f32_16x16x64_bf16 v[100:103], v[72:75], v[168:175], v0
    v_smfmac_f32_16x16x64_bf16 v[104:107], v[72:75], v[232:239], v0
    v_smfmac_f32_16x16x64_bf16 v[100:103], v[76:79], v[176:183], v0
    v_smfmac_f32_16x16x64_bf16 v[104:107], v[76:79], v[240:247], v0
    v_smfmac_f32_16x16x64_bf16 v[100:103], v[80:83], v[184:191], v0
    v_smfmac_f32_16x16x64_bf16 v[104:107], v[80:83], v[248:255], v0
    s_nop 3
    v_add_f32 v100, v100, v102
    v_add_f32 v101, v101, v103
    v_cvt_pk_bf16_f32 v28, v100, v101
    s_nop 0
    v_add_f32 v104, v104, v106
    v_add_f32 v105, v105, v107
    v_cvt_pk_bf16_f32 v30, v104, v105
    buffer_store_dwordx4 v[28:31], v1, s[8:11], s55 offen sc1
    s_waitcnt vmcnt(0)
    s_barrier
    v_mov_b32 v127, 1
    buffer_store_dword v127, off, s[8:11], s94 sc1
    s_branch L_end_1
L_worker_2:
    s_cmp_eq_u32 s35, -1
    s_cbranch_scc1 L_end_1
    s_load_dwordx2 s[22:23], s[0:1], 0
    s_load_dwordx4 s[24:27], s[0:1], 16
    s_load_dwordx2 s[28:29], s[0:1], 32
    s_waitcnt lgkmcnt(0)
    s_mov_b32 s46, s24
    s_mov_b32 s47, s25
    s_mov_b32 s48, s26
    s_mov_b32 s49, s27
    s_mov_b32 s50, s28
    s_mov_b32 s51, s29
    s_mov_b32 s8, s6
    s_and_b32 s9, s7, 0xffff
    s_mov_b32 s10, 0x10000000
    s_mov_b32 s11, 0x20000
    s_mov_b32 s20, s22
    s_and_b32 s21, s23, 0xffff
    s_mov_b32 s22, 0x200000
    s_mov_b32 s23, 0x20000
    s_lshr_b32 s80, s36, 4
    s_mul_i32 s80, s80, 7
    s_add_u32 s80, s80, s35
    s_and_b32 s81, s36, 15
    s_lshl_b32 s84, s35, 5
    s_add_u32 s84, s84, s36
    s_mov_b32 s82, 1
    s_cmp_lt_u32 s81, 6
    s_cbranch_scc1 L_wk_reg_67
    s_sub_u32 s83, s81, 6
    s_mul_i32 s83, s83, 14
    s_add_u32 s83, s83, s80
    s_cmp_ge_u32 s83, 128
    s_cbranch_scc1 L_wk_reg_67
    s_mov_b32 s82, 0
    s_and_b32 s33, s83, 1
    s_lshr_b32 s34, s83, 1
    s_mov_b32 s55, 96
    s_branch L_wk_start_66
L_wk_reg_67:
    s_mov_b32 s82, 1
    s_mov_b32 s33, s81
    s_mov_b32 s34, s80
    s_mov_b32 s55, 14
    s_cmp_ge_u32 s81, 2
    s_cbranch_scc1 L_wk_start_66
L_wk_skip_69:
    s_cmp_ge_u32 s34, 64
    s_cbranch_scc1 L_wk_start_66
    s_add_u32 s34, s34, 14
    s_branch L_wk_skip_69
L_wk_start_66:
    v_mbcnt_lo_u32_b32 v0, -1, 0
    v_mbcnt_hi_u32_b32 v0, -1, v0
    s_mov_b32 s54, 0
    v_and_b32 v11, 63, v0
    v_lshrrev_b32 v12, 4, v11
    v_and_b32 v13, 15, v11
    v_lshlrev_b32 v14, 2, v12
    v_xor_b32 v13, v13, v14
    v_lshlrev_b32 v13, 4, v13
    v_mul_u32_u24 v12, 8192, v12
    v_add_u32 v1, v12, v13
    v_lshrrev_b32 v12, 4, v11
    v_and_b32 v13, 15, v11
    v_lshrrev_b32 v13, 2, v13
    v_and_b32 v14, 3, v11
    v_lshrrev_b32 v15, 1, v12
    v_lshlrev_b32 v15, 3, v15
    v_add_u32 v15, v15, v13
    v_lshlrev_b32 v15, 8, v15
    v_and_b32 v16, 1, v12
    v_lshlrev_b32 v16, 1, v16
    v_lshrrev_b32 v17, 1, v14
    v_add_u32 v16, v16, v17
    v_and_b32 v17, 1, v14
    v_lshl_add_u32 v15, v17, 3, v15
    v_lshl_add_u32 v15, v16, 4, v15
    v_xor_b32 v16, 0, v13
    v_lshl_add_u32 v2, v16, 6, v15
    v_add_u32 v6, 0x10000, v2
    v_xor_b32 v16, 1, v13
    v_lshl_add_u32 v3, v16, 6, v15
    v_add_u32 v7, 0x10000, v3
    v_xor_b32 v16, 2, v13
    v_lshl_add_u32 v4, v16, 6, v15
    v_add_u32 v8, 0x10000, v4
    v_xor_b32 v16, 3, v13
    v_lshl_add_u32 v5, v16, 6, v15
    v_add_u32 v9, 0x10000, v5
    s_lshl_b32 s38, s33, 17
    v_lshrrev_b32 v12, 4, v11
    v_mul_u32_u24 v12, 1024, v12
    v_and_b32 v13, 15, v11
    v_lshl_add_u32 v12, v13, 4, v12
    s_mul_i32 s39, s32, 32768
    s_add_u32 s38, s38, s39
    buffer_load_dwordx4 v[128:131], v12, s[20:23], s38 offen offset:0
    s_add_u32 s38, s38, 4096
    buffer_load_dwordx4 v[132:135], v12, s[20:23], s38 offen offset:0
    s_add_u32 s38, s38, 4096
    buffer_load_dwordx4 v[136:139], v12, s[20:23], s38 offen offset:0
    s_add_u32 s38, s38, 4096
    buffer_load_dwordx4 v[140:143], v12, s[20:23], s38 offen offset:0
    s_add_u32 s38, s38, 4096
    buffer_load_dwordx4 v[144:147], v12, s[20:23], s38 offen offset:0
    s_add_u32 s38, s38, 4096
    buffer_load_dwordx4 v[148:151], v12, s[20:23], s38 offen offset:0
    s_add_u32 s38, s38, 4096
    buffer_load_dwordx4 v[152:155], v12, s[20:23], s38 offen offset:0
    s_add_u32 s38, s38, 4096
    buffer_load_dwordx4 v[156:159], v12, s[20:23], s38 offen offset:0
    s_sub_u32 s38, s38, 28672
    buffer_load_dwordx4 v[160:163], v12, s[20:23], s38 offen offset:256
    s_add_u32 s38, s38, 4096
    buffer_load_dwordx4 v[164:167], v12, s[20:23], s38 offen offset:256
    s_add_u32 s38, s38, 4096
    buffer_load_dwordx4 v[168:171], v12, s[20:23], s38 offen offset:256
    s_add_u32 s38, s38, 4096
    buffer_load_dwordx4 v[172:175], v12, s[20:23], s38 offen offset:256
    s_add_u32 s38, s38, 4096
    buffer_load_dwordx4 v[176:179], v12, s[20:23], s38 offen offset:256
    s_add_u32 s38, s38, 4096
    buffer_load_dwordx4 v[180:183], v12, s[20:23], s38 offen offset:256
    s_add_u32 s38, s38, 4096
    buffer_load_dwordx4 v[184:187], v12, s[20:23], s38 offen offset:256
    s_add_u32 s38, s38, 4096
    buffer_load_dwordx4 v[188:191], v12, s[20:23], s38 offen offset:256
    s_sub_u32 s38, s38, 28672
    buffer_load_dwordx4 v[192:195], v12, s[20:23], s38 offen offset:512
    s_add_u32 s38, s38, 4096
    buffer_load_dwordx4 v[196:199], v12, s[20:23], s38 offen offset:512
    s_add_u32 s38, s38, 4096
    buffer_load_dwordx4 v[200:203], v12, s[20:23], s38 offen offset:512
    s_add_u32 s38, s38, 4096
    buffer_load_dwordx4 v[204:207], v12, s[20:23], s38 offen offset:512
    s_add_u32 s38, s38, 4096
    buffer_load_dwordx4 v[208:211], v12, s[20:23], s38 offen offset:512
    s_add_u32 s38, s38, 4096
    buffer_load_dwordx4 v[212:215], v12, s[20:23], s38 offen offset:512
    s_add_u32 s38, s38, 4096
    buffer_load_dwordx4 v[216:219], v12, s[20:23], s38 offen offset:512
    s_add_u32 s38, s38, 4096
    buffer_load_dwordx4 v[220:223], v12, s[20:23], s38 offen offset:512
    s_sub_u32 s38, s38, 28672
    buffer_load_dwordx4 v[224:227], v12, s[20:23], s38 offen offset:768
    s_add_u32 s38, s38, 4096
    buffer_load_dwordx4 v[228:231], v12, s[20:23], s38 offen offset:768
    s_add_u32 s38, s38, 4096
    buffer_load_dwordx4 v[232:235], v12, s[20:23], s38 offen offset:768
    s_add_u32 s38, s38, 4096
    buffer_load_dwordx4 v[236:239], v12, s[20:23], s38 offen offset:768
    s_add_u32 s38, s38, 4096
    buffer_load_dwordx4 v[240:243], v12, s[20:23], s38 offen offset:768
    s_add_u32 s38, s38, 4096
    buffer_load_dwordx4 v[244:247], v12, s[20:23], s38 offen offset:768
    s_add_u32 s38, s38, 4096
    buffer_load_dwordx4 v[248:251], v12, s[20:23], s38 offen offset:768
    s_add_u32 s38, s38, 4096
    buffer_load_dwordx4 v[252:255], v12, s[20:23], s38 offen offset:768
    s_sub_u32 s38, s38, 28672
    s_lshr_b32 s38, s34, 5
    s_and_b32 s36, s34, 31
    s_lshl_b32 s36, s36, 8
    s_cmp_eq_u32 s38, 0
    s_cselect_b32 s12, s48, s50
    s_cselect_b32 s13, s49, s51
    s_cmp_eq_u32 s38, 2
    s_cselect_b32 s12, s46, s12
    s_cselect_b32 s13, s47, s13
    s_and_b32 s13, s13, 0xffff
    s_cmp_lt_u32 s34, 96
    s_cselect_b32 s14, 0x400000, 0
    s_mov_b32 s15, 0x20000
    s_mov_b32 s40, 0
L_ring0_70:
    s_lshl_b32 s42, s32, 5
    s_lshl_b32 s41, s40, 7
    s_add_u32 s42, s42, s41
    s_mul_i32 s42, s42, 8192
    s_add_u32 s42, s42, s36
    s_lshl_b32 s43, s32, 13
    s_lshl_b32 s41, s40, 15
    s_add_u32 s43, s43, s41
    s_mov_b32 s41, 0
L_ring0i_71:
    s_mov_b32 m0, s43
    s_add_u32 s41, s41, 1
    buffer_load_dwordx4 v1, s[12:15], s42 offen lds
    s_add_u32 s42, s42, 32768
    s_add_u32 s43, s43, 1024
    s_cmp_lt_u32 s41, 8
    s_cbranch_scc1 L_ring0i_71
    s_add_u32 s40, s40, 1
    s_cmp_lt_u32 s40, 3
    s_cbranch_scc1 L_ring0_70
    s_lshl_b32 s39, s32, 13
    s_add_u32 s39, s39, 131072
    v_lshrrev_b32 v12, 4, v11
    v_and_b32 v13, 15, v11
    v_xor_b32 v13, v13, v12
    v_lshlrev_b32 v13, 4, v13
    v_lshl_add_u32 v13, v12, 8, v13
    v_add_u32 v20, s39, v13
    v_xor_b32 v21, 64, v20
    v_xor_b32 v22, 128, v20
    v_xor_b32 v23, 192, v20
    v_and_b32 v12, 31, v11
    v_and_b32 v13, 15, v11
    v_lshrrev_b32 v14, 5, v11
    v_xor_b32 v13, v13, v14
    v_lshlrev_b32 v13, 4, v13
    v_lshl_add_u32 v13, v12, 8, v13
    v_add_u32 v24, s39, v13
    v_mov_b32 v13, 0x3f803f80
    v_mov_b32 v16, 0
    v_mov_b32 v17, 0
    v_mov_b32 v18, 0
    v_mov_b32 v19, 0
    s_waitcnt vmcnt(48)
    ds_write_b128 v20, v[128:131] offset:0
    ds_write_b128 v21, v[132:135] offset:1024
    ds_write_b128 v22, v[136:139] offset:2048
    ds_write_b128 v23, v[140:143] offset:3072
    ds_write_b128 v20, v[144:147] offset:4096
    ds_write_b128 v21, v[148:151] offset:5120
    ds_write_b128 v22, v[152:155] offset:6144
    ds_write_b128 v23, v[156:159] offset:7168
    s_waitcnt lgkmcnt(0)
    v_xor_b32 v25, 0, v24
    ds_read_b128 v[128:131], v25
    v_xor_b32 v26, 32, v24
    ds_read_b128 v[132:135], v26
    v_xor_b32 v25, 64, v24
    ds_read_b128 v[136:139], v25
    v_xor_b32 v26, 96, v24
    ds_read_b128 v[140:143], v26
    v_xor_b32 v25, 128, v24
    ds_read_b128 v[144:147], v25
    v_xor_b32 v26, 160, v24
    ds_read_b128 v[148:151], v26
    v_xor_b32 v25, 192, v24
    ds_read_b128 v[152:155], v25
    v_xor_b32 v26, 224, v24
    ds_read_b128 v[156:159], v26
    s_waitcnt lgkmcnt(7)
    v_mfma_f32_32x32x16_bf16 v[64:79], v[128:131], v[128:131], 0
    v_dot2_f32_bf16 v16, v128, v13, v16
    v_dot2_f32_bf16 v17, v129, v13, v17
    v_dot2_f32_bf16 v18, v130, v13, v18
    v_dot2_f32_bf16 v19, v131, v13, v19
    s_waitcnt lgkmcnt(6)
    v_mfma_f32_32x32x16_bf16 v[64:79], v[132:135], v[132:135], v[64:79]
    v_dot2_f32_bf16 v16, v132, v13, v16
    v_dot2_f32_bf16 v17, v133, v13, v17
    v_dot2_f32_bf16 v18, v134, v13, v18
    v_dot2_f32_bf16 v19, v135, v13, v19
    s_waitcnt lgkmcnt(5)
    v_mfma_f32_32x32x16_bf16 v[64:79], v[136:139], v[136:139], v[64:79]
    v_dot2_f32_bf16 v16, v136, v13, v16
    v_dot2_f32_bf16 v17, v137, v13, v17
    v_dot2_f32_bf16 v18, v138, v13, v18
    v_dot2_f32_bf16 v19, v139, v13, v19
    s_waitcnt lgkmcnt(4)
    v_mfma_f32_32x32x16_bf16 v[64:79], v[140:143], v[140:143], v[64:79]
    v_dot2_f32_bf16 v16, v140, v13, v16
    v_dot2_f32_bf16 v17, v141, v13, v17
    v_dot2_f32_bf16 v18, v142, v13, v18
    v_dot2_f32_bf16 v19, v143, v13, v19
    s_waitcnt lgkmcnt(3)
    v_mfma_f32_32x32x16_bf16 v[64:79], v[144:147], v[144:147], v[64:79]
    v_dot2_f32_bf16 v16, v144, v13, v16
    v_dot2_f32_bf16 v17, v145, v13, v17
    v_dot2_f32_bf16 v18, v146, v13, v18
    v_dot2_f32_bf16 v19, v147, v13, v19
    s_waitcnt lgkmcnt(2)
    v_mfma_f32_32x32x16_bf16 v[64:79], v[148:151], v[148:151], v[64:79]
    v_dot2_f32_bf16 v16, v148, v13, v16
    v_dot2_f32_bf16 v17, v149, v13, v17
    v_dot2_f32_bf16 v18, v150, v13, v18
    v_dot2_f32_bf16 v19, v151, v13, v19
    s_waitcnt lgkmcnt(1)
    v_mfma_f32_32x32x16_bf16 v[64:79], v[152:155], v[152:155], v[64:79]
    v_dot2_f32_bf16 v16, v152, v13, v16
    v_dot2_f32_bf16 v17, v153, v13, v17
    v_dot2_f32_bf16 v18, v154, v13, v18
    v_dot2_f32_bf16 v19, v155, v13, v19
    s_waitcnt lgkmcnt(0)
    v_mfma_f32_32x32x16_bf16 v[64:79], v[156:159], v[156:159], v[64:79]
    v_dot2_f32_bf16 v16, v156, v13, v16
    v_dot2_f32_bf16 v17, v157, v13, v17
    v_dot2_f32_bf16 v18, v158, v13, v18
    v_dot2_f32_bf16 v19, v159, v13, v19
    s_waitcnt vmcnt(40)
    ds_write_b128 v20, v[160:163] offset:0
    ds_write_b128 v21, v[164:167] offset:1024
    ds_write_b128 v22, v[168:171] offset:2048
    ds_write_b128 v23, v[172:175] offset:3072
    ds_write_b128 v20, v[176:179] offset:4096
    ds_write_b128 v21, v[180:183] offset:5120
    ds_write_b128 v22, v[184:187] offset:6144
    ds_write_b128 v23, v[188:191] offset:7168
    s_waitcnt lgkmcnt(0)
    v_xor_b32 v25, 0, v24
    ds_read_b128 v[160:163], v25
    v_xor_b32 v26, 32, v24
    ds_read_b128 v[164:167], v26
    v_xor_b32 v25, 64, v24
    ds_read_b128 v[168:171], v25
    v_xor_b32 v26, 96, v24
    ds_read_b128 v[172:175], v26
    v_xor_b32 v25, 128, v24
    ds_read_b128 v[176:179], v25
    v_xor_b32 v26, 160, v24
    ds_read_b128 v[180:183], v26
    v_xor_b32 v25, 192, v24
    ds_read_b128 v[184:187], v25
    v_xor_b32 v26, 224, v24
    ds_read_b128 v[188:191], v26
    s_waitcnt lgkmcnt(7)
    v_mfma_f32_32x32x16_bf16 v[64:79], v[160:163], v[160:163], v[64:79]
    v_dot2_f32_bf16 v16, v160, v13, v16
    v_dot2_f32_bf16 v17, v161, v13, v17
    v_dot2_f32_bf16 v18, v162, v13, v18
    v_dot2_f32_bf16 v19, v163, v13, v19
    s_waitcnt lgkmcnt(6)
    v_mfma_f32_32x32x16_bf16 v[64:79], v[164:167], v[164:167], v[64:79]
    v_dot2_f32_bf16 v16, v164, v13, v16
    v_dot2_f32_bf16 v17, v165, v13, v17
    v_dot2_f32_bf16 v18, v166, v13, v18
    v_dot2_f32_bf16 v19, v167, v13, v19
    s_waitcnt lgkmcnt(5)
    v_mfma_f32_32x32x16_bf16 v[64:79], v[168:171], v[168:171], v[64:79]
    v_dot2_f32_bf16 v16, v168, v13, v16
    v_dot2_f32_bf16 v17, v169, v13, v17
    v_dot2_f32_bf16 v18, v170, v13, v18
    v_dot2_f32_bf16 v19, v171, v13, v19
    s_waitcnt lgkmcnt(4)
    v_mfma_f32_32x32x16_bf16 v[64:79], v[172:175], v[172:175], v[64:79]
    v_dot2_f32_bf16 v16, v172, v13, v16
    v_dot2_f32_bf16 v17, v173, v13, v17
    v_dot2_f32_bf16 v18, v174, v13, v18
    v_dot2_f32_bf16 v19, v175, v13, v19
    s_waitcnt lgkmcnt(3)
    v_mfma_f32_32x32x16_bf16 v[64:79], v[176:179], v[176:179], v[64:79]
    v_dot2_f32_bf16 v16, v176, v13, v16
    v_dot2_f32_bf16 v17, v177, v13, v17
    v_dot2_f32_bf16 v18, v178, v13, v18
    v_dot2_f32_bf16 v19, v179, v13, v19
    s_waitcnt lgkmcnt(2)
    v_mfma_f32_32x32x16_bf16 v[64:79], v[180:183], v[180:183], v[64:79]
    v_dot2_f32_bf16 v16, v180, v13, v16
    v_dot2_f32_bf16 v17, v181, v13, v17
    v_dot2_f32_bf16 v18, v182, v13, v18
    v_dot2_f32_bf16 v19, v183, v13, v19
    s_waitcnt lgkmcnt(1)
    v_mfma_f32_32x32x16_bf16 v[64:79], v[184:187], v[184:187], v[64:79]
    v_dot2_f32_bf16 v16, v184, v13, v16
    v_dot2_f32_bf16 v17, v185, v13, v17
    v_dot2_f32_bf16 v18, v186, v13, v18
    v_dot2_f32_bf16 v19, v187, v13, v19
    s_waitcnt lgkmcnt(0)
    v_mfma_f32_32x32x16_bf16 v[64:79], v[188:191], v[188:191], v[64:79]
    v_dot2_f32_bf16 v16, v188, v13, v16
    v_dot2_f32_bf16 v17, v189, v13, v17
    v_dot2_f32_bf16 v18, v190, v13, v18
    v_dot2_f32_bf16 v19, v191, v13, v19
    s_waitcnt vmcnt(32)
    ds_write_b128 v20, v[192:195] offset:0
    ds_write_b128 v21, v[196:199] offset:1024
    ds_write_b128 v22, v[200:203] offset:2048
    ds_write_b128 v23, v[204:207] offset:3072
    ds_write_b128 v20, v[208:211] offset:4096
    ds_write_b128 v21, v[212:215] offset:5120
    ds_write_b128 v22, v[216:219] offset:6144
    ds_write_b128 v23, v[220:223] offset:7168
    s_waitcnt lgkmcnt(0)
    v_xor_b32 v25, 0, v24
    ds_read_b128 v[192:195], v25
    v_xor_b32 v26, 32, v24
    ds_read_b128 v[196:199], v26
    v_xor_b32 v25, 64, v24
    ds_read_b128 v[200:203], v25
    v_xor_b32 v26, 96, v24
    ds_read_b128 v[204:207], v26
    v_xor_b32 v25, 128, v24
    ds_read_b128 v[208:211], v25
    v_xor_b32 v26, 160, v24
    ds_read_b128 v[212:215], v26
    v_xor_b32 v25, 192, v24
    ds_read_b128 v[216:219], v25
    v_xor_b32 v26, 224, v24
    ds_read_b128 v[220:223], v26
    s_waitcnt lgkmcnt(7)
    v_mfma_f32_32x32x16_bf16 v[64:79], v[192:195], v[192:195], v[64:79]
    v_dot2_f32_bf16 v16, v192, v13, v16
    v_dot2_f32_bf16 v17, v193, v13, v17
    v_dot2_f32_bf16 v18, v194, v13, v18
    v_dot2_f32_bf16 v19, v195, v13, v19
    s_waitcnt lgkmcnt(6)
    v_mfma_f32_32x32x16_bf16 v[64:79], v[196:199], v[196:199], v[64:79]
    v_dot2_f32_bf16 v16, v196, v13, v16
    v_dot2_f32_bf16 v17, v197, v13, v17
    v_dot2_f32_bf16 v18, v198, v13, v18
    v_dot2_f32_bf16 v19, v199, v13, v19
    s_waitcnt lgkmcnt(5)
    v_mfma_f32_32x32x16_bf16 v[64:79], v[200:203], v[200:203], v[64:79]
    v_dot2_f32_bf16 v16, v200, v13, v16
    v_dot2_f32_bf16 v17, v201, v13, v17
    v_dot2_f32_bf16 v18, v202, v13, v18
    v_dot2_f32_bf16 v19, v203, v13, v19
    s_waitcnt lgkmcnt(4)
    v_mfma_f32_32x32x16_bf16 v[64:79], v[204:207], v[204:207], v[64:79]
    v_dot2_f32_bf16 v16, v204, v13, v16
    v_dot2_f32_bf16 v17, v205, v13, v17
    v_dot2_f32_bf16 v18, v206, v13, v18
    v_dot2_f32_bf16 v19, v207, v13, v19
    s_waitcnt lgkmcnt(3)
    v_mfma_f32_32x32x16_bf16 v[64:79], v[208:211], v[208:211], v[64:79]
    v_dot2_f32_bf16 v16, v208, v13, v16
    v_dot2_f32_bf16 v17, v209, v13, v17
    v_dot2_f32_bf16 v18, v210, v13, v18
    v_dot2_f32_bf16 v19, v211, v13, v19
    s_waitcnt lgkmcnt(2)
    v_mfma_f32_32x32x16_bf16 v[64:79], v[212:215], v[212:215], v[64:79]
    v_dot2_f32_bf16 v16, v212, v13, v16
    v_dot2_f32_bf16 v17, v213, v13, v17
    v_dot2_f32_bf16 v18, v214, v13, v18
    v_dot2_f32_bf16 v19, v215, v13, v19
    s_waitcnt lgkmcnt(1)
    v_mfma_f32_32x32x16_bf16 v[64:79], v[216:219], v[216:219], v[64:79]
    v_dot2_f32_bf16 v16, v216, v13, v16
    v_dot2_f32_bf16 v17, v217, v13, v17
    v_dot2_f32_bf16 v18, v218, v13, v18
    v_dot2_f32_bf16 v19, v219, v13, v19
    s_waitcnt lgkmcnt(0)
    v_mfma_f32_32x32x16_bf16 v[64:79], v[220:223], v[220:223], v[64:79]
    v_dot2_f32_bf16 v16, v220, v13, v16
    v_dot2_f32_bf16 v17, v221, v13, v17
    v_dot2_f32_bf16 v18, v222, v13, v18
    v_dot2_f32_bf16 v19, v223, v13, v19
    s_waitcnt vmcnt(24)
    ds_write_b128 v20, v[224:227] offset:0
    ds_write_b128 v21, v[228:231] offset:1024
    ds_write_b128 v22, v[232:235] offset:2048
    ds_write_b128 v23, v[236:239] offset:3072
    ds_write_b128 v20, v[240:243] offset:4096
    ds_write_b128 v21, v[244:247] offset:5120
    ds_write_b128 v22, v[248:251] offset:6144
    ds_write_b128 v23, v[252:255] offset:7168
    s_waitcnt lgkmcnt(0)
    v_xor_b32 v25, 0, v24
    ds_read_b128 v[224:227], v25
    v_xor_b32 v26, 32, v24
    ds_read_b128 v[228:231], v26
    v_xor_b32 v25, 64, v24
    ds_read_b128 v[232:235], v25
    v_xor_b32 v26, 96, v24
    ds_read_b128 v[236:239], v26
    v_xor_b32 v25, 128, v24
    ds_read_b128 v[240:243], v25
    v_xor_b32 v26, 160, v24
    ds_read_b128 v[244:247], v26
    v_xor_b32 v25, 192, v24
    ds_read_b128 v[248:251], v25
    v_xor_b32 v26, 224, v24
    ds_read_b128 v[252:255], v26
    s_waitcnt lgkmcnt(7)
    v_mfma_f32_32x32x16_bf16 v[64:79], v[224:227], v[224:227], v[64:79]
    v_dot2_f32_bf16 v16, v224, v13, v16
    v_dot2_f32_bf16 v17, v225, v13, v17
    v_dot2_f32_bf16 v18, v226, v13, v18
    v_dot2_f32_bf16 v19, v227, v13, v19
    s_waitcnt lgkmcnt(6)
    v_mfma_f32_32x32x16_bf16 v[64:79], v[228:231], v[228:231], v[64:79]
    v_dot2_f32_bf16 v16, v228, v13, v16
    v_dot2_f32_bf16 v17, v229, v13, v17
    v_dot2_f32_bf16 v18, v230, v13, v18
    v_dot2_f32_bf16 v19, v231, v13, v19
    s_waitcnt lgkmcnt(5)
    v_mfma_f32_32x32x16_bf16 v[64:79], v[232:235], v[232:235], v[64:79]
    v_dot2_f32_bf16 v16, v232, v13, v16
    v_dot2_f32_bf16 v17, v233, v13, v17
    v_dot2_f32_bf16 v18, v234, v13, v18
    v_dot2_f32_bf16 v19, v235, v13, v19
    s_waitcnt lgkmcnt(4)
    v_mfma_f32_32x32x16_bf16 v[64:79], v[236:239], v[236:239], v[64:79]
    v_dot2_f32_bf16 v16, v236, v13, v16
    v_dot2_f32_bf16 v17, v237, v13, v17
    v_dot2_f32_bf16 v18, v238, v13, v18
    v_dot2_f32_bf16 v19, v239, v13, v19
    s_waitcnt lgkmcnt(3)
    v_mfma_f32_32x32x16_bf16 v[64:79], v[240:243], v[240:243], v[64:79]
    v_dot2_f32_bf16 v16, v240, v13, v16
    v_dot2_f32_bf16 v17, v241, v13, v17
    v_dot2_f32_bf16 v18, v242, v13, v18
    v_dot2_f32_bf16 v19, v243, v13, v19
    s_waitcnt lgkmcnt(2)
    v_mfma_f32_32x32x16_bf16 v[64:79], v[244:247], v[244:247], v[64:79]
    v_dot2_f32_bf16 v16, v244, v13, v16
    v_dot2_f32_bf16 v17, v245, v13, v17
    v_dot2_f32_bf16 v18, v246, v13, v18
    v_dot2_f32_bf16 v19, v247, v13, v19
    s_waitcnt lgkmcnt(1)
    v_mfma_f32_32x32x16_bf16 v[64:79], v[248:251], v[248:251], v[64:79]
    v_dot2_f32_bf16 v16, v248, v13, v16
    v_dot2_f32_bf16 v17, v249, v13, v17
    v_dot2_f32_bf16 v18, v250, v13, v18
    v_dot2_f32_bf16 v19, v251, v13, v19
    s_waitcnt lgkmcnt(0)
    v_mfma_f32_32x32x16_bf16 v[64:79], v[252:255], v[252:255], v[64:79]
    v_dot2_f32_bf16 v16, v252, v13, v16
    v_dot2_f32_bf16 v17, v253, v13, v17
    v_dot2_f32_bf16 v18, v254, v13, v18
    v_dot2_f32_bf16 v19, v255, v13, v19
    s_cmp_eq_u32 s55, 96
    s_cbranch_scc1 L_nopf_72
    v_lshrrev_b32 v12, 4, v11
    v_mul_u32_u24 v12, 8192, v12
    v_and_b32 v13, 15, v11
    v_lshl_add_u32 v12, v13, 4, v12
    s_mov_b32 s41, s34
    s_lshr_b32 s38, s41, 5
    s_and_b32 s37, s41, 31
    s_lshl_b32 s37, s37, 8
    s_cmp_eq_u32 s38, 0
    s_cselect_b32 s16, s48, s50
    s_cselect_b32 s17, s49, s51
    s_cmp_eq_u32 s38, 2
    s_cselect_b32 s16, s46, s16
    s_cselect_b32 s17, s47, s17
    s_and_b32 s17, s17, 0xffff
    s_cmp_lt_u32 s41, 96
    s_cselect_b32 s18, 0x400000, 0
    s_mov_b32 s19, 0x20000
    s_lshl_b32 s39, s33, 5
    s_lshl_b32 s40, s32, 3
    s_add_u32 s39, s39, s40
    s_lshl_b32 s39, s39, 13
    s_add_u32 s39, s39, s37
    buffer_load_dwordx4 v[32:35], v12, s[16:19], s39 offen
    s_add_u32 s39, s39, 0x8000
    buffer_load_dwordx4 v[32:35], v12, s[16:19], s39 offen
    s_add_u32 s41, s41, s55
    s_lshr_b32 s38, s41, 5
    s_and_b32 s37, s41, 31
    s_lshl_b32 s37, s37, 8
    s_cmp_eq_u32 s38, 0
    s_cselect_b32 s16, s48, s50
    s_cselect_b32 s17, s49, s51
    s_cmp_eq_u32 s38, 2
    s_cselect_b32 s16, s46, s16
    s_cselect_b32 s17, s47, s17
    s_and_b32 s17, s17, 0xffff
    s_cmp_lt_u32 s41, 96
    s_cselect_b32 s18, 0x400000, 0
    s_mov_b32 s19, 0x20000
    s_lshl_b32 s39, s33, 5
    s_lshl_b32 s40, s32, 3
    s_add_u32 s39, s39, s40
    s_lshl_b32 s39, s39, 13
    s_add_u32 s39, s39, s37
    buffer_load_dwordx4 v[32:35], v12, s[16:19], s39 offen
    s_add_u32 s39, s39, 0x8000
    buffer_load_dwordx4 v[32:35], v12, s[16:19], s39 offen
    s_add_u32 s41, s41, s55
    s_lshr_b32 s38, s41, 5
    s_and_b32 s37, s41, 31
    s_lshl_b32 s37, s37, 8
    s_cmp_eq_u32 s38, 0
    s_cselect_b32 s16, s48, s50
    s_cselect_b32 s17, s49, s51
    s_cmp_eq_u32 s38, 2
    s_cselect_b32 s16, s46, s16
    s_cselect_b32 s17, s47, s17
    s_and_b32 s17, s17, 0xffff
    s_cmp_lt_u32 s41, 96
    s_cselect_b32 s18, 0x400000, 0
    s_mov_b32 s19, 0x20000
    s_lshl_b32 s39, s33, 5
    s_lshl_b32 s40, s32, 3
    s_add_u32 s39, s39, s40
    s_lshl_b32 s39, s39, 13
    s_add_u32 s39, s39, s37
    buffer_load_dwordx4 v[32:35], v12, s[16:19], s39 offen
    s_add_u32 s39, s39, 0x8000
    buffer_load_dwordx4 v[32:35], v12, s[16:19], s39 offen
    s_add_u32 s41, s41, s55
    s_lshr_b32 s38, s41, 5
    s_and_b32 s37, s41, 31
    s_lshl_b32 s37, s37, 8
    s_cmp_eq_u32 s38, 0
    s_cselect_b32 s16, s48, s50
    s_cselect_b32 s17, s49, s51
    s_cmp_eq_u32 s38, 2
    s_cselect_b32 s16, s46, s16
    s_cselect_b32 s17, s47, s17
    s_and_b32 s17, s17, 0xffff
    s_cmp_lt_u32 s41, 96
    s_cselect_b32 s18, 0x400000, 0
    s_mov_b32 s19, 0x20000
    s_lshl_b32 s39, s33, 5
    s_lshl_b32 s40, s32, 3
    s_add_u32 s39, s39, s40
    s_lshl_b32 s39, s39, 13
    s_add_u32 s39, s39, s37
    buffer_load_dwordx4 v[32:35], v12, s[16:19], s39 offen
    s_add_u32 s39, s39, 0x8000
    buffer_load_dwordx4 v[32:35], v12, s[16:19], s39 offen
    s_add_u32 s41, s41, s55
    s_lshr_b32 s38, s41, 5
    s_and_b32 s37, s41, 31
    s_lshl_b32 s37, s37, 8
    s_cmp_eq_u32 s38, 0
    s_cselect_b32 s16, s48, s50
    s_cselect_b32 s17, s49, s51
    s_cmp_eq_u32 s38, 2
    s_cselect_b32 s16, s46, s16
    s_cselect_b32 s17, s47, s17
    s_and_b32 s17, s17, 0xffff
    s_cmp_lt_u32 s41, 96
    s_cselect_b32 s18, 0x400000, 0
    s_mov_b32 s19, 0x20000
    s_lshl_b32 s39, s33, 5
    s_lshl_b32 s40, s32, 3
    s_add_u32 s39, s39, s40
    s_lshl_b32 s39, s39, 13
    s_add_u32 s39, s39, s37
    buffer_load_dwordx4 v[32:35], v12, s[16:19], s39 offen
    s_add_u32 s39, s39, 0x8000
    buffer_load_dwordx4 v[32:35], v12, s[16:19], s39 offen
    s_add_u32 s41, s41, s55
    s_lshr_b32 s38, s41, 5
    s_and_b32 s37, s41, 31
    s_lshl_b32 s37, s37, 8
    s_cmp_eq_u32 s38, 0
    s_cselect_b32 s16, s48, s50
    s_cselect_b32 s17, s49, s51
    s_cmp_eq_u32 s38, 2
    s_cselect_b32 s16, s46, s16
    s_cselect_b32 s17, s47, s17
    s_and_b32 s17, s17, 0xffff
    s_cmp_lt_u32 s41, 96
    s_cselect_b32 s18, 0x400000, 0
    s_mov_b32 s19, 0x20000
    s_lshl_b32 s39, s33, 5
    s_lshl_b32 s40, s32, 3
    s_add_u32 s39, s39, s40
    s_lshl_b32 s39, s39, 13
    s_add_u32 s39, s39, s37
    buffer_load_dwordx4 v[32:35], v12, s[16:19], s39 offen
    s_add_u32 s39, s39, 0x8000
    buffer_load_dwordx4 v[32:35], v12, s[16:19], s39 offen
    s_add_u32 s41, s41, s55
    s_lshr_b32 s38, s41, 5
    s_and_b32 s37, s41, 31
    s_lshl_b32 s37, s37, 8
    s_cmp_eq_u32 s38, 0
    s_cselect_b32 s16, s48, s50
    s_cselect_b32 s17, s49, s51
    s_cmp_eq_u32 s38, 2
    s_cselect_b32 s16, s46, s16
    s_cselect_b32 s17, s47, s17
    s_and_b32 s17, s17, 0xffff
    s_cmp_lt_u32 s41, 96
    s_cselect_b32 s18, 0x400000, 0
    s_mov_b32 s19, 0x20000
    s_lshl_b32 s39, s33, 5
    s_lshl_b32 s40, s32, 3
    s_add_u32 s39, s39, s40
    s_lshl_b32 s39, s39, 13
    s_add_u32 s39, s39, s37
    buffer_load_dwordx4 v[32:35], v12, s[16:19], s39 offen
    s_add_u32 s39, s39, 0x8000
    buffer_load_dwordx4 v[32:35], v12, s[16:19], s39 offen
    s_add_u32 s41, s41, s55
L_nopf_72:
    s_nop 11
    v_lshrrev_b32 v12, 0, v11
    v_and_b32 v12, 1, v12
    v_cmp_eq_u32 s[64:65], 1, v12
    v_lshrrev_b32 v12, 1, v11
    v_and_b32 v12, 1, v12
    v_cmp_eq_u32 s[66:67], 1, v12
    v_lshrrev_b32 v12, 3, v11
    v_and_b32 v12, 1, v12
    v_cmp_eq_u32 s[68:69], 1, v12
    v_lshrrev_b32 v12, 4, v11
    v_and_b32 v12, 1, v12
    v_cmp_eq_u32 s[70:71], 1, v12
    v_lshrrev_b32 v12, 2, v11
    v_and_b32 v12, 1, v12
    v_cmp_eq_u32 s[72:73], 1, v12
    s_nop 1
    v_cndmask_b32 v64, v64, v65, s[64:65]
    v_cndmask_b32 v65, v66, v67, s[64:65]
    v_cndmask_b32 v66, v68, v69, s[64:65]
    v_cndmask_b32 v67, v70, v71, s[64:65]
    v_cndmask_b32 v68, v72, v73, s[64:65]
    v_cndmask_b32 v69, v74, v75, s[64:65]
    v_cndmask_b32 v70, v76, v77, s[64:65]
    v_cndmask_b32 v71, v78, v79, s[64:65]
    v_cndmask_b32 v64, v64, v65, s[66:67]
    v_cndmask_b32 v65, v66, v67, s[66:67]
    v_cndmask_b32 v66, v68, v69, s[66:67]
    v_cndmask_b32 v67, v70, v71, s[66:67]
    v_cndmask_b32 v64, v64, v65, s[68:69]
    v_cndmask_b32 v65, v66, v67, s[68:69]
    v_cndmask_b32 v64, v64, v65, s[70:71]
    v_mov_b32 v65, v64
    s_nop 1
    v_permlane32_swap_b32 v64, v65
    s_nop 1
    v_cndmask_b32 v20, v64, v65, s[72:73]
    v_add_f32 v16, v16, v17
    v_add_f32 v18, v18, v19
    v_add_f32 v16, v16, v18
    v_mov_b32 v17, v16
    s_nop 1
    v_permlane32_swap_b32 v16, v17
    s_nop 1
    v_add_f32 v16, v16, v17
    v_mul_f32 v16, 0x3b000000, v16
    v_mul_f32 v20, 0x3b000000, v20
    v_fma_f32 v20, -v16, v16, v20
    v_max_f32 v20, 0, v20
    v_add_f32 v20, 0x3727c5ac, v20
    v_rsq_f32 v20, v20
    s_nop 0
    v_mul_f32 v16, v16, v20
    v_mov_b32 v28, v20
    v_mov_b32 v14, v16
    s_mov_b32 s64, 0xffff0000
    v_lshlrev_b32 v24, 16, v128
    v_and_b32 v25, s64, v128
    v_pk_fma_f32 v[24:25], v[24:25], v[28:29], v[14:15] op_sel_hi:[1,0,0] neg_lo:[0,0,1] neg_hi:[0,0,1]
    v_cvt_pk_bf16_f32 v128, v24, v25
    v_lshlrev_b32 v26, 16, v129
    v_and_b32 v27, s64, v129
    v_pk_fma_f32 v[26:27], v[26:27], v[28:29], v[14:15] op_sel_hi:[1,0,0] neg_lo:[0,0,1] neg_hi:[0,0,1]
    v_cvt_pk_bf16_f32 v129, v26, v27
    v_lshlrev_b32 v24, 16, v130
    v_and_b32 v25, s64, v130
    v_pk_fma_f32 v[24:25], v[24:25], v[28:29], v[14:15] op_sel_hi:[1,0,0] neg_lo:[0,0,1] neg_hi:[0,0,1]
    v_cvt_pk_bf16_f32 v130, v24, v25
    v_lshlrev_b32 v26, 16, v131
    v_and_b32 v27, s64, v131
    v_pk_fma_f32 v[26:27], v[26:27], v[28:29], v[14:15] op_sel_hi:[1,0,0] neg_lo:[0,0,1] neg_hi:[0,0,1]
    v_cvt_pk_bf16_f32 v131, v26, v27
    v_lshlrev_b32 v24, 16, v132
    v_and_b32 v25, s64, v132
    v_pk_fma_f32 v[24:25], v[24:25], v[28:29], v[14:15] op_sel_hi:[1,0,0] neg_lo:[0,0,1] neg_hi:[0,0,1]
    v_cvt_pk_bf16_f32 v132, v24, v25
    v_lshlrev_b32 v26, 16, v133
    v_and_b32 v27, s64, v133
    v_pk_fma_f32 v[26:27], v[26:27], v[28:29], v[14:15] op_sel_hi:[1,0,0] neg_lo:[0,0,1] neg_hi:[0,0,1]
    v_cvt_pk_bf16_f32 v133, v26, v27
    v_lshlrev_b32 v24, 16, v134
    v_and_b32 v25, s64, v134
    v_pk_fma_f32 v[24:25], v[24:25], v[28:29], v[14:15] op_sel_hi:[1,0,0] neg_lo:[0,0,1] neg_hi:[0,0,1]
    v_cvt_pk_bf16_f32 v134, v24, v25
    v_lshlrev_b32 v26, 16, v135
    v_and_b32 v27, s64, v135
    v_pk_fma_f32 v[26:27], v[26:27], v[28:29], v[14:15] op_sel_hi:[1,0,0] neg_lo:[0,0,1] neg_hi:[0,0,1]
    v_cvt_pk_bf16_f32 v135, v26, v27
    v_lshlrev_b32 v24, 16, v136
    v_and_b32 v25, s64, v136
    v_pk_fma_f32 v[24:25], v[24:25], v[28:29], v[14:15] op_sel_hi:[1,0,0] neg_lo:[0,0,1] neg_hi:[0,0,1]
    v_cvt_pk_bf16_f32 v136, v24, v25
    v_lshlrev_b32 v26, 16, v137
    v_and_b32 v27, s64, v137
    v_pk_fma_f32 v[26:27], v[26:27], v[28:29], v[14:15] op_sel_hi:[1,0,0] neg_lo:[0,0,1] neg_hi:[0,0,1]
    v_cvt_pk_bf16_f32 v137, v26, v27
    v_lshlrev_b32 v24, 16, v138
    v_and_b32 v25, s64, v138
    v_pk_fma_f32 v[24:25], v[24:25], v[28:29], v[14:15] op_sel_hi:[1,0,0] neg_lo:[0,0,1] neg_hi:[0,0,1]
    v_cvt_pk_bf16_f32 v138, v24, v25
    v_lshlrev_b32 v26, 16, v139
    v_and_b32 v27, s64, v139
    v_pk_fma_f32 v[26:27], v[26:27], v[28:29], v[14:15] op_sel_hi:[1,0,0] neg_lo:[0,0,1] neg_hi:[0,0,1]
    v_cvt_pk_bf16_f32 v139, v26, v27
    v_lshlrev_b32 v24, 16, v140
    v_and_b32 v25, s64, v140
    v_pk_fma_f32 v[24:25], v[24:25], v[28:29], v[14:15] op_sel_hi:[1,0,0] neg_lo:[0,0,1] neg_hi:[0,0,1]
    v_cvt_pk_bf16_f32 v140, v24, v25
    v_lshlrev_b32 v26, 16, v141
    v_and_b32 v27, s64, v141
    v_pk_fma_f32 v[26:27], v[26:27], v[28:29], v[14:15] op_sel_hi:[1,0,0] neg_lo:[0,0,1] neg_hi:[0,0,1]
    v_cvt_pk_bf16_f32 v141, v26, v27
    v_lshlrev_b32 v24, 16, v142
    v_and_b32 v25, s64, v142
    v_pk_fma_f32 v[24:25], v[24:25], v[28:29], v[14:15] op_sel_hi:[1,0,0] neg_lo:[0,0,1] neg_hi:[0,0,1]
    v_cvt_pk_bf16_f32 v142, v24, v25
    v_lshlrev_b32 v26, 16, v143
    v_and_b32 v27, s64, v143
    v_pk_fma_f32 v[26:27], v[26:27], v[28:29], v[14:15] op_sel_hi:[1,0,0] neg_lo:[0,0,1] neg_hi:[0,0,1]
    v_cvt_pk_bf16_f32 v143, v26, v27
    v_lshlrev_b32 v24, 16, v144
    v_and_b32 v25, s64, v144
    v_pk_fma_f32 v[24:25], v[24:25], v[28:29], v[14:15] op_sel_hi:[1,0,0] neg_lo:[0,0,1] neg_hi:[0,0,1]
    v_cvt_pk_bf16_f32 v144, v24, v25
    v_lshlrev_b32 v26, 16, v145
    v_and_b32 v27, s64, v145
    v_pk_fma_f32 v[26:27], v[26:27], v[28:29], v[14:15] op_sel_hi:[1,0,0] neg_lo:[0,0,1] neg_hi:[0,0,1]
    v_cvt_pk_bf16_f32 v145, v26, v27
    v_lshlrev_b32 v24, 16, v146
    v_and_b32 v25, s64, v146
    v_pk_fma_f32 v[24:25], v[24:25], v[28:29], v[14:15] op_sel_hi:[1,0,0] neg_lo:[0,0,1] neg_hi:[0,0,1]
    v_cvt_pk_bf16_f32 v146, v24, v25
    v_lshlrev_b32 v26, 16, v147
    v_and_b32 v27, s64, v147
    v_pk_fma_f32 v[26:27], v[26:27], v[28:29], v[14:15] op_sel_hi:[1,0,0] neg_lo:[0,0,1] neg_hi:[0,0,1]
    v_cvt_pk_bf16_f32 v147, v26, v27
    v_lshlrev_b32 v24, 16, v148
    v_and_b32 v25, s64, v148
    v_pk_fma_f32 v[24:25], v[24:25], v[28:29], v[14:15] op_sel_hi:[1,0,0] neg_lo:[0,0,1] neg_hi:[0,0,1]
    v_cvt_pk_bf16_f32 v148, v24, v25
    v_lshlrev_b32 v26, 16, v149
    v_and_b32 v27, s64, v149
    v_pk_fma_f32 v[26:27], v[26:27], v[28:29], v[14:15] op_sel_hi:[1,0,0] neg_lo:[0,0,1] neg_hi:[0,0,1]
    v_cvt_pk_bf16_f32 v149, v26, v27
    v_lshlrev_b32 v24, 16, v150
    v_and_b32 v25, s64, v150
    v_pk_fma_f32 v[24:25], v[24:25], v[28:29], v[14:15] op_sel_hi:[1,0,0] neg_lo:[0,0,1] neg_hi:[0,0,1]
    v_cvt_pk_bf16_f32 v150, v24, v25
    v_lshlrev_b32 v26, 16, v151
    v_and_b32 v27, s64, v151
    v_pk_fma_f32 v[26:27], v[26:27], v[28:29], v[14:15] op_sel_hi:[1,0,0] neg_lo:[0,0,1] neg_hi:[0,0,1]
    v_cvt_pk_bf16_f32 v151, v26, v27
    v_lshlrev_b32 v24, 16, v152
    v_and_b32 v25, s64, v152
    v_pk_fma_f32 v[24:25], v[24:25], v[28:29], v[14:15] op_sel_hi:[1,0,0] neg_lo:[0,0,1] neg_hi:[0,0,1]
    v_cvt_pk_bf16_f32 v152, v24, v25
    v_lshlrev_b32 v26, 16, v153
    v_and_b32 v27, s64, v153
    v_pk_fma_f32 v[26:27], v[26:27], v[28:29], v[14:15] op_sel_hi:[1,0,0] neg_lo:[0,0,1] neg_hi:[0,0,1]
    v_cvt_pk_bf16_f32 v153, v26, v27
    v_lshlrev_b32 v24, 16, v154
    v_and_b32 v25, s64, v154
    v_pk_fma_f32 v[24:25], v[24:25], v[28:29], v[14:15] op_sel_hi:[1,0,0] neg_lo:[0,0,1] neg_hi:[0,0,1]
    v_cvt_pk_bf16_f32 v154, v24, v25
    v_lshlrev_b32 v26, 16, v155
    v_and_b32 v27, s64, v155
    v_pk_fma_f32 v[26:27], v[26:27], v[28:29], v[14:15] op_sel_hi:[1,0,0] neg_lo:[0,0,1] neg_hi:[0,0,1]
    v_cvt_pk_bf16_f32 v155, v26, v27
    v_lshlrev_b32 v24, 16, v156
    v_and_b32 v25, s64, v156
    v_pk_fma_f32 v[24:25], v[24:25], v[28:29], v[14:15] op_sel_hi:[1,0,0] neg_lo:[0,0,1] neg_hi:[0,0,1]
    v_cvt_pk_bf16_f32 v156, v24, v25
    v_lshlrev_b32 v26, 16, v157
    v_and_b32 v27, s64, v157
    v_pk_fma_f32 v[26:27], v[26:27], v[28:29], v[14:15] op_sel_hi:[1,0,0] neg_lo:[0,0,1] neg_hi:[0,0,1]
    v_cvt_pk_bf16_f32 v157, v26, v27
    v_lshlrev_b32 v24, 16, v158
    v_and_b32 v25, s64, v158
    v_pk_fma_f32 v[24:25], v[24:25], v[28:29], v[14:15] op_sel_hi:[1,0,0] neg_lo:[0,0,1] neg_hi:[0,0,1]
    v_cvt_pk_bf16_f32 v158, v24, v25
    v_lshlrev_b32 v26, 16, v159
    v_and_b32 v27, s64, v159
    v_pk_fma_f32 v[26:27], v[26:27], v[28:29], v[14:15] op_sel_hi:[1,0,0] neg_lo:[0,0,1] neg_hi:[0,0,1]
    v_cvt_pk_bf16_f32 v159, v26, v27
    v_lshlrev_b32 v24, 16, v160
    v_and_b32 v25, s64, v160
    v_pk_fma_f32 v[24:25], v[24:25], v[28:29], v[14:15] op_sel_hi:[1,0,0] neg_lo:[0,0,1] neg_hi:[0,0,1]
    v_cvt_pk_bf16_f32 v160, v24, v25
    v_lshlrev_b32 v26, 16, v161
    v_and_b32 v27, s64, v161
    v_pk_fma_f32 v[26:27], v[26:27], v[28:29], v[14:15] op_sel_hi:[1,0,0] neg_lo:[0,0,1] neg_hi:[0,0,1]
    v_cvt_pk_bf16_f32 v161, v26, v27
    v_lshlrev_b32 v24, 16, v162
    v_and_b32 v25, s64, v162
    v_pk_fma_f32 v[24:25], v[24:25], v[28:29], v[14:15] op_sel_hi:[1,0,0] neg_lo:[0,0,1] neg_hi:[0,0,1]
    v_cvt_pk_bf16_f32 v162, v24, v25
    v_lshlrev_b32 v26, 16, v163
    v_and_b32 v27, s64, v163
    v_pk_fma_f32 v[26:27], v[26:27], v[28:29], v[14:15] op_sel_hi:[1,0,0] neg_lo:[0,0,1] neg_hi:[0,0,1]
    v_cvt_pk_bf16_f32 v163, v26, v27
    v_lshlrev_b32 v24, 16, v164
    v_and_b32 v25, s64, v164
    v_pk_fma_f32 v[24:25], v[24:25], v[28:29], v[14:15] op_sel_hi:[1,0,0] neg_lo:[0,0,1] neg_hi:[0,0,1]
    v_cvt_pk_bf16_f32 v164, v24, v25
    v_lshlrev_b32 v26, 16, v165
    v_and_b32 v27, s64, v165
    v_pk_fma_f32 v[26:27], v[26:27], v[28:29], v[14:15] op_sel_hi:[1,0,0] neg_lo:[0,0,1] neg_hi:[0,0,1]
    v_cvt_pk_bf16_f32 v165, v26, v27
    v_lshlrev_b32 v24, 16, v166
    v_and_b32 v25, s64, v166
    v_pk_fma_f32 v[24:25], v[24:25], v[28:29], v[14:15] op_sel_hi:[1,0,0] neg_lo:[0,0,1] neg_hi:[0,0,1]
    v_cvt_pk_bf16_f32 v166, v24, v25
    v_lshlrev_b32 v26, 16, v167
    v_and_b32 v27, s64, v167
    v_pk_fma_f32 v[26:27], v[26:27], v[28:29], v[14:15] op_sel_hi:[1,0,0] neg_lo:[0,0,1] neg_hi:[0,0,1]
    v_cvt_pk_bf16_f32 v167, v26, v27
    v_lshlrev_b32 v24, 16, v168
    v_and_b32 v25, s64, v168
    v_pk_fma_f32 v[24:25], v[24:25], v[28:29], v[14:15] op_sel_hi:[1,0,0] neg_lo:[0,0,1] neg_hi:[0,0,1]
    v_cvt_pk_bf16_f32 v168, v24, v25
    v_lshlrev_b32 v26, 16, v169
    v_and_b32 v27, s64, v169
    v_pk_fma_f32 v[26:27], v[26:27], v[28:29], v[14:15] op_sel_hi:[1,0,0] neg_lo:[0,0,1] neg_hi:[0,0,1]
    v_cvt_pk_bf16_f32 v169, v26, v27
    v_lshlrev_b32 v24, 16, v170
    v_and_b32 v25, s64, v170
    v_pk_fma_f32 v[24:25], v[24:25], v[28:29], v[14:15] op_sel_hi:[1,0,0] neg_lo:[0,0,1] neg_hi:[0,0,1]
    v_cvt_pk_bf16_f32 v170, v24, v25
    v_lshlrev_b32 v26, 16, v171
    v_and_b32 v27, s64, v171
    v_pk_fma_f32 v[26:27], v[26:27], v[28:29], v[14:15] op_sel_hi:[1,0,0] neg_lo:[0,0,1] neg_hi:[0,0,1]
    v_cvt_pk_bf16_f32 v171, v26, v27
    v_lshlrev_b32 v24, 16, v172
    v_and_b32 v25, s64, v172
    v_pk_fma_f32 v[24:25], v[24:25], v[28:29], v[14:15] op_sel_hi:[1,0,0] neg_lo:[0,0,1] neg_hi:[0,0,1]
    v_cvt_pk_bf16_f32 v172, v24, v25
    v_lshlrev_b32 v26, 16, v173
    v_and_b32 v27, s64, v173
    v_pk_fma_f32 v[26:27], v[26:27], v[28:29], v[14:15] op_sel_hi:[1,0,0] neg_lo:[0,0,1] neg_hi:[0,0,1]
    v_cvt_pk_bf16_f32 v173, v26, v27
    v_lshlrev_b32 v24, 16, v174
    v_and_b32 v25, s64, v174
    v_pk_fma_f32 v[24:25], v[24:25], v[28:29], v[14:15] op_sel_hi:[1,0,0] neg_lo:[0,0,1] neg_hi:[0,0,1]
    v_cvt_pk_bf16_f32 v174, v24, v25
    v_lshlrev_b32 v26, 16, v175
    v_and_b32 v27, s64, v175
    v_pk_fma_f32 v[26:27], v[26:27], v[28:29], v[14:15] op_sel_hi:[1,0,0] neg_lo:[0,0,1] neg_hi:[0,0,1]
    v_cvt_pk_bf16_f32 v175, v26, v27
    v_lshlrev_b32 v24, 16, v176
    v_and_b32 v25, s64, v176
    v_pk_fma_f32 v[24:25], v[24:25], v[28:29], v[14:15] op_sel_hi:[1,0,0] neg_lo:[0,0,1] neg_hi:[0,0,1]
    v_cvt_pk_bf16_f32 v176, v24, v25
    v_lshlrev_b32 v26, 16, v177
    v_and_b32 v27, s64, v177
    v_pk_fma_f32 v[26:27], v[26:27], v[28:29], v[14:15] op_sel_hi:[1,0,0] neg_lo:[0,0,1] neg_hi:[0,0,1]
    v_cvt_pk_bf16_f32 v177, v26, v27
    v_lshlrev_b32 v24, 16, v178
    v_and_b32 v25, s64, v178
    v_pk_fma_f32 v[24:25], v[24:25], v[28:29], v[14:15] op_sel_hi:[1,0,0] neg_lo:[0,0,1] neg_hi:[0,0,1]
    v_cvt_pk_bf16_f32 v178, v24, v25
    v_lshlrev_b32 v26, 16, v179
    v_and_b32 v27, s64, v179
    v_pk_fma_f32 v[26:27], v[26:27], v[28:29], v[14:15] op_sel_hi:[1,0,0] neg_lo:[0,0,1] neg_hi:[0,0,1]
    v_cvt_pk_bf16_f32 v179, v26, v27
    v_lshlrev_b32 v24, 16, v180
    v_and_b32 v25, s64, v180
    v_pk_fma_f32 v[24:25], v[24:25], v[28:29], v[14:15] op_sel_hi:[1,0,0] neg_lo:[0,0,1] neg_hi:[0,0,1]
    v_cvt_pk_bf16_f32 v180, v24, v25
    v_lshlrev_b32 v26, 16, v181
    v_and_b32 v27, s64, v181
    v_pk_fma_f32 v[26:27], v[26:27], v[28:29], v[14:15] op_sel_hi:[1,0,0] neg_lo:[0,0,1] neg_hi:[0,0,1]
    v_cvt_pk_bf16_f32 v181, v26, v27
    v_lshlrev_b32 v24, 16, v182
    v_and_b32 v25, s64, v182
    v_pk_fma_f32 v[24:25], v[24:25], v[28:29], v[14:15] op_sel_hi:[1,0,0] neg_lo:[0,0,1] neg_hi:[0,0,1]
    v_cvt_pk_bf16_f32 v182, v24, v25
    v_lshlrev_b32 v26, 16, v183
    v_and_b32 v27, s64, v183
    v_pk_fma_f32 v[26:27], v[26:27], v[28:29], v[14:15] op_sel_hi:[1,0,0] neg_lo:[0,0,1] neg_hi:[0,0,1]
    v_cvt_pk_bf16_f32 v183, v26, v27
    v_lshlrev_b32 v24, 16, v184
    v_and_b32 v25, s64, v184
    v_pk_fma_f32 v[24:25], v[24:25], v[28:29], v[14:15] op_sel_hi:[1,0,0] neg_lo:[0,0,1] neg_hi:[0,0,1]
    v_cvt_pk_bf16_f32 v184, v24, v25
    v_lshlrev_b32 v26, 16, v185
    v_and_b32 v27, s64, v185
    v_pk_fma_f32 v[26:27], v[26:27], v[28:29], v[14:15] op_sel_hi:[1,0,0] neg_lo:[0,0,1] neg_hi:[0,0,1]
    v_cvt_pk_bf16_f32 v185, v26, v27
    v_lshlrev_b32 v24, 16, v186
    v_and_b32 v25, s64, v186
    v_pk_fma_f32 v[24:25], v[24:25], v[28:29], v[14:15] op_sel_hi:[1,0,0] neg_lo:[0,0,1] neg_hi:[0,0,1]
    v_cvt_pk_bf16_f32 v186, v24, v25
    v_lshlrev_b32 v26, 16, v187
    v_and_b32 v27, s64, v187
    v_pk_fma_f32 v[26:27], v[26:27], v[28:29], v[14:15] op_sel_hi:[1,0,0] neg_lo:[0,0,1] neg_hi:[0,0,1]
    v_cvt_pk_bf16_f32 v187, v26, v27
    v_lshlrev_b32 v24, 16, v188
    v_and_b32 v25, s64, v188
    v_pk_fma_f32 v[24:25], v[24:25], v[28:29], v[14:15] op_sel_hi:[1,0,0] neg_lo:[0,0,1] neg_hi:[0,0,1]
    v_cvt_pk_bf16_f32 v188, v24, v25
    v_lshlrev_b32 v26, 16, v189
    v_and_b32 v27, s64, v189
    v_pk_fma_f32 v[26:27], v[26:27], v[28:29], v[14:15] op_sel_hi:[1,0,0] neg_lo:[0,0,1] neg_hi:[0,0,1]
    v_cvt_pk_bf16_f32 v189, v26, v27
    v_lshlrev_b32 v24, 16, v190
    v_and_b32 v25, s64, v190
    v_pk_fma_f32 v[24:25], v[24:25], v[28:29], v[14:15] op_sel_hi:[1,0,0] neg_lo:[0,0,1] neg_hi:[0,0,1]
    v_cvt_pk_bf16_f32 v190, v24, v25
    v_lshlrev_b32 v26, 16, v191
    v_and_b32 v27, s64, v191
    v_pk_fma_f32 v[26:27], v[26:27], v[28:29], v[14:15] op_sel_hi:[1,0,0] neg_lo:[0,0,1] neg_hi:[0,0,1]
    v_cvt_pk_bf16_f32 v191, v26, v27
    v_lshlrev_b32 v24, 16, v192
    v_and_b32 v25, s64, v192
    v_pk_fma_f32 v[24:25], v[24:25], v[28:29], v[14:15] op_sel_hi:[1,0,0] neg_lo:[0,0,1] neg_hi:[0,0,1]
    v_cvt_pk_bf16_f32 v192, v24, v25
    v_lshlrev_b32 v26, 16, v193
    v_and_b32 v27, s64, v193
    v_pk_fma_f32 v[26:27], v[26:27], v[28:29], v[14:15] op_sel_hi:[1,0,0] neg_lo:[0,0,1] neg_hi:[0,0,1]
    v_cvt_pk_bf16_f32 v193, v26, v27
    v_lshlrev_b32 v24, 16, v194
    v_and_b32 v25, s64, v194
    v_pk_fma_f32 v[24:25], v[24:25], v[28:29], v[14:15] op_sel_hi:[1,0,0] neg_lo:[0,0,1] neg_hi:[0,0,1]
    v_cvt_pk_bf16_f32 v194, v24, v25
    v_lshlrev_b32 v26, 16, v195
    v_and_b32 v27, s64, v195
    v_pk_fma_f32 v[26:27], v[26:27], v[28:29], v[14:15] op_sel_hi:[1,0,0] neg_lo:[0,0,1] neg_hi:[0,0,1]
    v_cvt_pk_bf16_f32 v195, v26, v27
    v_lshlrev_b32 v24, 16, v196
    v_and_b32 v25, s64, v196
    v_pk_fma_f32 v[24:25], v[24:25], v[28:29], v[14:15] op_sel_hi:[1,0,0] neg_lo:[0,0,1] neg_hi:[0,0,1]
    v_cvt_pk_bf16_f32 v196, v24, v25
    v_lshlrev_b32 v26, 16, v197
    v_and_b32 v27, s64, v197
    v_pk_fma_f32 v[26:27], v[26:27], v[28:29], v[14:15] op_sel_hi:[1,0,0] neg_lo:[0,0,1] neg_hi:[0,0,1]
    v_cvt_pk_bf16_f32 v197, v26, v27
    v_lshlrev_b32 v24, 16, v198
    v_and_b32 v25, s64, v198
    v_pk_fma_f32 v[24:25], v[24:25], v[28:29], v[14:15] op_sel_hi:[1,0,0] neg_lo:[0,0,1] neg_hi:[0,0,1]
    v_cvt_pk_bf16_f32 v198, v24, v25
    v_lshlrev_b32 v26, 16, v199
    v_and_b32 v27, s64, v199
    v_pk_fma_f32 v[26:27], v[26:27], v[28:29], v[14:15] op_sel_hi:[1,0,0] neg_lo:[0,0,1] neg_hi:[0,0,1]
    v_cvt_pk_bf16_f32 v199, v26, v27
    v_lshlrev_b32 v24, 16, v200
    v_and_b32 v25, s64, v200
    v_pk_fma_f32 v[24:25], v[24:25], v[28:29], v[14:15] op_sel_hi:[1,0,0] neg_lo:[0,0,1] neg_hi:[0,0,1]
    v_cvt_pk_bf16_f32 v200, v24, v25
    v_lshlrev_b32 v26, 16, v201
    v_and_b32 v27, s64, v201
    v_pk_fma_f32 v[26:27], v[26:27], v[28:29], v[14:15] op_sel_hi:[1,0,0] neg_lo:[0,0,1] neg_hi:[0,0,1]
    v_cvt_pk_bf16_f32 v201, v26, v27
    v_lshlrev_b32 v24, 16, v202
    v_and_b32 v25, s64, v202
    v_pk_fma_f32 v[24:25], v[24:25], v[28:29], v[14:15] op_sel_hi:[1,0,0] neg_lo:[0,0,1] neg_hi:[0,0,1]
    v_cvt_pk_bf16_f32 v202, v24, v25
    v_lshlrev_b32 v26, 16, v203
    v_and_b32 v27, s64, v203
    v_pk_fma_f32 v[26:27], v[26:27], v[28:29], v[14:15] op_sel_hi:[1,0,0] neg_lo:[0,0,1] neg_hi:[0,0,1]
    v_cvt_pk_bf16_f32 v203, v26, v27
    v_lshlrev_b32 v24, 16, v204
    v_and_b32 v25, s64, v204
    v_pk_fma_f32 v[24:25], v[24:25], v[28:29], v[14:15] op_sel_hi:[1,0,0] neg_lo:[0,0,1] neg_hi:[0,0,1]
    v_cvt_pk_bf16_f32 v204, v24, v25
    v_lshlrev_b32 v26, 16, v205
    v_and_b32 v27, s64, v205
    v_pk_fma_f32 v[26:27], v[26:27], v[28:29], v[14:15] op_sel_hi:[1,0,0] neg_lo:[0,0,1] neg_hi:[0,0,1]
    v_cvt_pk_bf16_f32 v205, v26, v27
    v_lshlrev_b32 v24, 16, v206
    v_and_b32 v25, s64, v206
    v_pk_fma_f32 v[24:25], v[24:25], v[28:29], v[14:15] op_sel_hi:[1,0,0] neg_lo:[0,0,1] neg_hi:[0,0,1]
    v_cvt_pk_bf16_f32 v206, v24, v25
    v_lshlrev_b32 v26, 16, v207
    v_and_b32 v27, s64, v207
    v_pk_fma_f32 v[26:27], v[26:27], v[28:29], v[14:15] op_sel_hi:[1,0,0] neg_lo:[0,0,1] neg_hi:[0,0,1]
    v_cvt_pk_bf16_f32 v207, v26, v27
    v_lshlrev_b32 v24, 16, v208
    v_and_b32 v25, s64, v208
    v_pk_fma_f32 v[24:25], v[24:25], v[28:29], v[14:15] op_sel_hi:[1,0,0] neg_lo:[0,0,1] neg_hi:[0,0,1]
    v_cvt_pk_bf16_f32 v208, v24, v25
    v_lshlrev_b32 v26, 16, v209
    v_and_b32 v27, s64, v209
    v_pk_fma_f32 v[26:27], v[26:27], v[28:29], v[14:15] op_sel_hi:[1,0,0] neg_lo:[0,0,1] neg_hi:[0,0,1]
    v_cvt_pk_bf16_f32 v209, v26, v27
    v_lshlrev_b32 v24, 16, v210
    v_and_b32 v25, s64, v210
    v_pk_fma_f32 v[24:25], v[24:25], v[28:29], v[14:15] op_sel_hi:[1,0,0] neg_lo:[0,0,1] neg_hi:[0,0,1]
    v_cvt_pk_bf16_f32 v210, v24, v25
    v_lshlrev_b32 v26, 16, v211
    v_and_b32 v27, s64, v211
    v_pk_fma_f32 v[26:27], v[26:27], v[28:29], v[14:15] op_sel_hi:[1,0,0] neg_lo:[0,0,1] neg_hi:[0,0,1]
    v_cvt_pk_bf16_f32 v211, v26, v27
    v_lshlrev_b32 v24, 16, v212
    v_and_b32 v25, s64, v212
    v_pk_fma_f32 v[24:25], v[24:25], v[28:29], v[14:15] op_sel_hi:[1,0,0] neg_lo:[0,0,1] neg_hi:[0,0,1]
    v_cvt_pk_bf16_f32 v212, v24, v25
    v_lshlrev_b32 v26, 16, v213
    v_and_b32 v27, s64, v213
    v_pk_fma_f32 v[26:27], v[26:27], v[28:29], v[14:15] op_sel_hi:[1,0,0] neg_lo:[0,0,1] neg_hi:[0,0,1]
    v_cvt_pk_bf16_f32 v213, v26, v27
    v_lshlrev_b32 v24, 16, v214
    v_and_b32 v25, s64, v214
    v_pk_fma_f32 v[24:25], v[24:25], v[28:29], v[14:15] op_sel_hi:[1,0,0] neg_lo:[0,0,1] neg_hi:[0,0,1]
    v_cvt_pk_bf16_f32 v214, v24, v25
    v_lshlrev_b32 v26, 16, v215
    v_and_b32 v27, s64, v215
    v_pk_fma_f32 v[26:27], v[26:27], v[28:29], v[14:15] op_sel_hi:[1,0,0] neg_lo:[0,0,1] neg_hi:[0,0,1]
    v_cvt_pk_bf16_f32 v215, v26, v27
    v_lshlrev_b32 v24, 16, v216
    v_and_b32 v25, s64, v216
    v_pk_fma_f32 v[24:25], v[24:25], v[28:29], v[14:15] op_sel_hi:[1,0,0] neg_lo:[0,0,1] neg_hi:[0,0,1]
    v_cvt_pk_bf16_f32 v216, v24, v25
    v_lshlrev_b32 v26, 16, v217
    v_and_b32 v27, s64, v217
    v_pk_fma_f32 v[26:27], v[26:27], v[28:29], v[14:15] op_sel_hi:[1,0,0] neg_lo:[0,0,1] neg_hi:[0,0,1]
    v_cvt_pk_bf16_f32 v217, v26, v27
    v_lshlrev_b32 v24, 16, v218
    v_and_b32 v25, s64, v218
    v_pk_fma_f32 v[24:25], v[24:25], v[28:29], v[14:15] op_sel_hi:[1,0,0] neg_lo:[0,0,1] neg_hi:[0,0,1]
    v_cvt_pk_bf16_f32 v218, v24, v25
    v_lshlrev_b32 v26, 16, v219
    v_and_b32 v27, s64, v219
    v_pk_fma_f32 v[26:27], v[26:27], v[28:29], v[14:15] op_sel_hi:[1,0,0] neg_lo:[0,0,1] neg_hi:[0,0,1]
    v_cvt_pk_bf16_f32 v219, v26, v27
    v_lshlrev_b32 v24, 16, v220
    v_and_b32 v25, s64, v220
    v_pk_fma_f32 v[24:25], v[24:25], v[28:29], v[14:15] op_sel_hi:[1,0,0] neg_lo:[0,0,1] neg_hi:[0,0,1]
    v_cvt_pk_bf16_f32 v220, v24, v25
    v_lshlrev_b32 v26, 16, v221
    v_and_b32 v27, s64, v221
    v_pk_fma_f32 v[26:27], v[26:27], v[28:29], v[14:15] op_sel_hi:[1,0,0] neg_lo:[0,0,1] neg_hi:[0,0,1]
    v_cvt_pk_bf16_f32 v221, v26, v27
    v_lshlrev_b32 v24, 16, v222
    v_and_b32 v25, s64, v222
    v_pk_fma_f32 v[24:25], v[24:25], v[28:29], v[14:15] op_sel_hi:[1,0,0] neg_lo:[0,0,1] neg_hi:[0,0,1]
    v_cvt_pk_bf16_f32 v222, v24, v25
    v_lshlrev_b32 v26, 16, v223
    v_and_b32 v27, s64, v223
    v_pk_fma_f32 v[26:27], v[26:27], v[28:29], v[14:15] op_sel_hi:[1,0,0] neg_lo:[0,0,1] neg_hi:[0,0,1]
    v_cvt_pk_bf16_f32 v223, v26, v27
    v_lshlrev_b32 v24, 16, v224
    v_and_b32 v25, s64, v224
    v_pk_fma_f32 v[24:25], v[24:25], v[28:29], v[14:15] op_sel_hi:[1,0,0] neg_lo:[0,0,1] neg_hi:[0,0,1]
    v_cvt_pk_bf16_f32 v224, v24, v25
    v_lshlrev_b32 v26, 16, v225
    v_and_b32 v27, s64, v225
    v_pk_fma_f32 v[26:27], v[26:27], v[28:29], v[14:15] op_sel_hi:[1,0,0] neg_lo:[0,0,1] neg_hi:[0,0,1]
    v_cvt_pk_bf16_f32 v225, v26, v27
    v_lshlrev_b32 v24, 16, v226
    v_and_b32 v25, s64, v226
    v_pk_fma_f32 v[24:25], v[24:25], v[28:29], v[14:15] op_sel_hi:[1,0,0] neg_lo:[0,0,1] neg_hi:[0,0,1]
    v_cvt_pk_bf16_f32 v226, v24, v25
    v_lshlrev_b32 v26, 16, v227
    v_and_b32 v27, s64, v227
    v_pk_fma_f32 v[26:27], v[26:27], v[28:29], v[14:15] op_sel_hi:[1,0,0] neg_lo:[0,0,1] neg_hi:[0,0,1]
    v_cvt_pk_bf16_f32 v227, v26, v27
    v_lshlrev_b32 v24, 16, v228
    v_and_b32 v25, s64, v228
    v_pk_fma_f32 v[24:25], v[24:25], v[28:29], v[14:15] op_sel_hi:[1,0,0] neg_lo:[0,0,1] neg_hi:[0,0,1]
    v_cvt_pk_bf16_f32 v228, v24, v25
    v_lshlrev_b32 v26, 16, v229
    v_and_b32 v27, s64, v229
    v_pk_fma_f32 v[26:27], v[26:27], v[28:29], v[14:15] op_sel_hi:[1,0,0] neg_lo:[0,0,1] neg_hi:[0,0,1]
    v_cvt_pk_bf16_f32 v229, v26, v27
    v_lshlrev_b32 v24, 16, v230
    v_and_b32 v25, s64, v230
    v_pk_fma_f32 v[24:25], v[24:25], v[28:29], v[14:15] op_sel_hi:[1,0,0] neg_lo:[0,0,1] neg_hi:[0,0,1]
    v_cvt_pk_bf16_f32 v230, v24, v25
    v_lshlrev_b32 v26, 16, v231
    v_and_b32 v27, s64, v231
    v_pk_fma_f32 v[26:27], v[26:27], v[28:29], v[14:15] op_sel_hi:[1,0,0] neg_lo:[0,0,1] neg_hi:[0,0,1]
    v_cvt_pk_bf16_f32 v231, v26, v27
    v_lshlrev_b32 v24, 16, v232
    v_and_b32 v25, s64, v232
    v_pk_fma_f32 v[24:25], v[24:25], v[28:29], v[14:15] op_sel_hi:[1,0,0] neg_lo:[0,0,1] neg_hi:[0,0,1]
    v_cvt_pk_bf16_f32 v232, v24, v25
    v_lshlrev_b32 v26, 16, v233
    v_and_b32 v27, s64, v233
    v_pk_fma_f32 v[26:27], v[26:27], v[28:29], v[14:15] op_sel_hi:[1,0,0] neg_lo:[0,0,1] neg_hi:[0,0,1]
    v_cvt_pk_bf16_f32 v233, v26, v27
    v_lshlrev_b32 v24, 16, v234
    v_and_b32 v25, s64, v234
    v_pk_fma_f32 v[24:25], v[24:25], v[28:29], v[14:15] op_sel_hi:[1,0,0] neg_lo:[0,0,1] neg_hi:[0,0,1]
    v_cvt_pk_bf16_f32 v234, v24, v25
    v_lshlrev_b32 v26, 16, v235
    v_and_b32 v27, s64, v235
    v_pk_fma_f32 v[26:27], v[26:27], v[28:29], v[14:15] op_sel_hi:[1,0,0] neg_lo:[0,0,1] neg_hi:[0,0,1]
    v_cvt_pk_bf16_f32 v235, v26, v27
    v_lshlrev_b32 v24, 16, v236
    v_and_b32 v25, s64, v236
    v_pk_fma_f32 v[24:25], v[24:25], v[28:29], v[14:15] op_sel_hi:[1,0,0] neg_lo:[0,0,1] neg_hi:[0,0,1]
    v_cvt_pk_bf16_f32 v236, v24, v25
    v_lshlrev_b32 v26, 16, v237
    v_and_b32 v27, s64, v237
    v_pk_fma_f32 v[26:27], v[26:27], v[28:29], v[14:15] op_sel_hi:[1,0,0] neg_lo:[0,0,1] neg_hi:[0,0,1]
    v_cvt_pk_bf16_f32 v237, v26, v27
    v_lshlrev_b32 v24, 16, v238
    v_and_b32 v25, s64, v238
    v_pk_fma_f32 v[24:25], v[24:25], v[28:29], v[14:15] op_sel_hi:[1,0,0] neg_lo:[0,0,1] neg_hi:[0,0,1]
    v_cvt_pk_bf16_f32 v238, v24, v25
    v_lshlrev_b32 v26, 16, v239
    v_and_b32 v27, s64, v239
    v_pk_fma_f32 v[26:27], v[26:27], v[28:29], v[14:15] op_sel_hi:[1,0,0] neg_lo:[0,0,1] neg_hi:[0,0,1]
    v_cvt_pk_bf16_f32 v239, v26, v27
    v_lshlrev_b32 v24, 16, v240
    v_and_b32 v25, s64, v240
    v_pk_fma_f32 v[24:25], v[24:25], v[28:29], v[14:15] op_sel_hi:[1,0,0] neg_lo:[0,0,1] neg_hi:[0,0,1]
    v_cvt_pk_bf16_f32 v240, v24, v25
    v_lshlrev_b32 v26, 16, v241
    v_and_b32 v27, s64, v241
    v_pk_fma_f32 v[26:27], v[26:27], v[28:29], v[14:15] op_sel_hi:[1,0,0] neg_lo:[0,0,1] neg_hi:[0,0,1]
    v_cvt_pk_bf16_f32 v241, v26, v27
    v_lshlrev_b32 v24, 16, v242
    v_and_b32 v25, s64, v242
    v_pk_fma_f32 v[24:25], v[24:25], v[28:29], v[14:15] op_sel_hi:[1,0,0] neg_lo:[0,0,1] neg_hi:[0,0,1]
    v_cvt_pk_bf16_f32 v242, v24, v25
    v_lshlrev_b32 v26, 16, v243
    v_and_b32 v27, s64, v243
    v_pk_fma_f32 v[26:27], v[26:27], v[28:29], v[14:15] op_sel_hi:[1,0,0] neg_lo:[0,0,1] neg_hi:[0,0,1]
    v_cvt_pk_bf16_f32 v243, v26, v27
    v_lshlrev_b32 v24, 16, v244
    v_and_b32 v25, s64, v244
    v_pk_fma_f32 v[24:25], v[24:25], v[28:29], v[14:15] op_sel_hi:[1,0,0] neg_lo:[0,0,1] neg_hi:[0,0,1]
    v_cvt_pk_bf16_f32 v244, v24, v25
    v_lshlrev_b32 v26, 16, v245
    v_and_b32 v27, s64, v245
    v_pk_fma_f32 v[26:27], v[26:27], v[28:29], v[14:15] op_sel_hi:[1,0,0] neg_lo:[0,0,1] neg_hi:[0,0,1]
    v_cvt_pk_bf16_f32 v245, v26, v27
    v_lshlrev_b32 v24, 16, v246
    v_and_b32 v25, s64, v246
    v_pk_fma_f32 v[24:25], v[24:25], v[28:29], v[14:15] op_sel_hi:[1,0,0] neg_lo:[0,0,1] neg_hi:[0,0,1]
    v_cvt_pk_bf16_f32 v246, v24, v25
    v_lshlrev_b32 v26, 16, v247
    v_and_b32 v27, s64, v247
    v_pk_fma_f32 v[26:27], v[26:27], v[28:29], v[14:15] op_sel_hi:[1,0,0] neg_lo:[0,0,1] neg_hi:[0,0,1]
    v_cvt_pk_bf16_f32 v247, v26, v27
    v_lshlrev_b32 v24, 16, v248
    v_and_b32 v25, s64, v248
    v_pk_fma_f32 v[24:25], v[24:25], v[28:29], v[14:15] op_sel_hi:[1,0,0] neg_lo:[0,0,1] neg_hi:[0,0,1]
    v_cvt_pk_bf16_f32 v248, v24, v25
    v_lshlrev_b32 v26, 16, v249
    v_and_b32 v27, s64, v249
    v_pk_fma_f32 v[26:27], v[26:27], v[28:29], v[14:15] op_sel_hi:[1,0,0] neg_lo:[0,0,1] neg_hi:[0,0,1]
    v_cvt_pk_bf16_f32 v249, v26, v27
    v_lshlrev_b32 v24, 16, v250
    v_and_b32 v25, s64, v250
    v_pk_fma_f32 v[24:25], v[24:25], v[28:29], v[14:15] op_sel_hi:[1,0,0] neg_lo:[0,0,1] neg_hi:[0,0,1]
    v_cvt_pk_bf16_f32 v250, v24, v25
    v_lshlrev_b32 v26, 16, v251
    v_and_b32 v27, s64, v251
    v_pk_fma_f32 v[26:27], v[26:27], v[28:29], v[14:15] op_sel_hi:[1,0,0] neg_lo:[0,0,1] neg_hi:[0,0,1]
    v_cvt_pk_bf16_f32 v251, v26, v27
    v_lshlrev_b32 v24, 16, v252
    v_and_b32 v25, s64, v252
    v_pk_fma_f32 v[24:25], v[24:25], v[28:29], v[14:15] op_sel_hi:[1,0,0] neg_lo:[0,0,1] neg_hi:[0,0,1]
    v_cvt_pk_bf16_f32 v252, v24, v25
    v_lshlrev_b32 v26, 16, v253
    v_and_b32 v27, s64, v253
    v_pk_fma_f32 v[26:27], v[26:27], v[28:29], v[14:15] op_sel_hi:[1,0,0] neg_lo:[0,0,1] neg_hi:[0,0,1]
    v_cvt_pk_bf16_f32 v253, v26, v27
    v_lshlrev_b32 v24, 16, v254
    v_and_b32 v25, s64, v254
    v_pk_fma_f32 v[24:25], v[24:25], v[28:29], v[14:15] op_sel_hi:[1,0,0] neg_lo:[0,0,1] neg_hi:[0,0,1]
    v_cvt_pk_bf16_f32 v254, v24, v25
    v_lshlrev_b32 v26, 16, v255
    v_and_b32 v27, s64, v255
    v_pk_fma_f32 v[26:27], v[26:27], v[28:29], v[14:15] op_sel_hi:[1,0,0] neg_lo:[0,0,1] neg_hi:[0,0,1]
    v_cvt_pk_bf16_f32 v255, v26, v27
    s_waitcnt vmcnt(0)
    s_add_u32 s35, s34, s55
    s_lshr_b32 s38, s35, 5
    s_and_b32 s37, s35, 31
    s_lshl_b32 s37, s37, 8
    s_cmp_eq_u32 s38, 0
    s_cselect_b32 s16, s48, s50
    s_cselect_b32 s17, s49, s51
    s_cmp_eq_u32 s38, 2
    s_cselect_b32 s16, s46, s16
    s_cselect_b32 s17, s47, s17
    s_and_b32 s17, s17, 0xffff
    s_cmp_lt_u32 s35, 96
    s_cselect_b32 s18, 0x400000, 0
    s_mov_b32 s19, 0x20000
    s_mov_b32 s53, 1
L_t1_loop_73:
    s_lshl_b32 s38, s33, 2
    s_add_u32 s38, s38, s32
    s_lshl_b32 s38, s38, 5
    s_and_b32 s39, s34, 31
    s_add_u32 s38, s38, s39
    s_lshl_b32 s44, s38, 13
    s_lshr_b32 s40, s34, 5
    s_cmp_eq_u32 s53, 1
    s_cbranch_scc1 L_w16_78
    s_waitcnt vmcnt(24)
    s_branch L_wj_79
L_w16_78:
    s_waitcnt vmcnt(16)
L_wj_79:
    s_barrier
    s_lshl_b32 s42, s32, 5
    s_add_u32 s42, s42, 384
    s_mul_i32 s42, s42, 8192
    s_add_u32 s42, s42, s36
    s_lshl_b32 s43, s32, 13
    ds_read_b64_tr_b16 v[32:33], v2 offset:0
    ds_read_b64_tr_b16 v[34:35], v2 offset:1024
    ds_read_b64_tr_b16 v[36:37], v3 offset:0
    ds_read_b64_tr_b16 v[38:39], v3 offset:1024
    ds_read_b64_tr_b16 v[40:41], v4 offset:0
    ds_read_b64_tr_b16 v[42:43], v4 offset:1024
    ds_read_b64_tr_b16 v[44:45], v5 offset:0
    ds_read_b64_tr_b16 v[46:47], v5 offset:1024
    ds_read_b64_tr_b16 v[48:49], v2 offset:4096
    ds_read_b64_tr_b16 v[50:51], v2 offset:5120
    ds_read_b64_tr_b16 v[52:53], v3 offset:4096
    ds_read_b64_tr_b16 v[54:55], v3 offset:5120
    ds_read_b64_tr_b16 v[56:57], v4 offset:4096
    ds_read_b64_tr_b16 v[58:59], v4 offset:5120
    ds_read_b64_tr_b16 v[60:61], v5 offset:4096
    s_add_u32 s43, s43, 98304
    s_mov_b32 m0, s43
    ds_read_b64_tr_b16 v[62:63], v5 offset:5120
    buffer_load_dwordx4 v1, s[12:15], s42 offen lds
    s_add_u32 s42, s42, 32768
    s_add_u32 s43, s43, 1024
    s_mov_b32 m0, s43
    s_waitcnt lgkmcnt(14)
    v_mfma_f32_32x32x16_bf16 v[64:79], v[32:35], v[128:131], 0
    s_waitcnt lgkmcnt(12)
    ds_read_b64_tr_b16 v[32:33], v2 offset:8192
    ds_read_b64_tr_b16 v[34:35], v2 offset:9216
    v_mfma_f32_32x32x16_bf16 v[80:95], v[36:39], v[128:131], 0
    s_waitcnt lgkmcnt(12)
    ds_read_b64_tr_b16 v[36:37], v3 offset:8192
    ds_read_b64_tr_b16 v[38:39], v3 offset:9216
    v_mfma_f32_32x32x16_bf16 v[96:111], v[40:43], v[128:131], 0
    ds_read_b64_tr_b16 v[40:41], v4 offset:8192
    ds_read_b64_tr_b16 v[42:43], v4 offset:9216
    buffer_load_dwordx4 v1, s[12:15], s42 offen lds
    s_add_u32 s42, s42, 32768
    s_add_u32 s43, s43, 1024
    s_mov_b32 m0, s43
    s_waitcnt lgkmcnt(14)
    v_mfma_f32_32x32x16_bf16 v[112:127], v[44:47], v[128:131], 0
    s_waitcnt lgkmcnt(12)
    ds_read_b64_tr_b16 v[44:45], v5 offset:8192
    ds_read_b64_tr_b16 v[46:47], v5 offset:9216
    v_mfma_f32_32x32x16_bf16 v[64:79], v[48:51], v[132:135], v[64:79]
    s_waitcnt lgkmcnt(12)
    ds_read_b64_tr_b16 v[48:49], v2 offset:12288
    ds_read_b64_tr_b16 v[50:51], v2 offset:13312
    v_mfma_f32_32x32x16_bf16 v[80:95], v[52:55], v[132:135], v[80:95]
    ds_read_b64_tr_b16 v[52:53], v3 offset:12288
    ds_read_b64_tr_b16 v[54:55], v3 offset:13312
    buffer_load_dwordx4 v1, s[12:15], s42 offen lds
    s_add_u32 s42, s42, 32768
    s_add_u32 s43, s43, 1024
    s_mov_b32 m0, s43
    s_waitcnt lgkmcnt(14)
    v_mfma_f32_32x32x16_bf16 v[96:111], v[56:59], v[132:135], v[96:111]
    s_waitcnt lgkmcnt(12)
    ds_read_b64_tr_b16 v[56:57], v4 offset:12288
    ds_read_b64_tr_b16 v[58:59], v4 offset:13312
    v_mfma_f32_32x32x16_bf16 v[112:127], v[60:63], v[132:135], v[112:127]
    s_waitcnt lgkmcnt(12)
    ds_read_b64_tr_b16 v[60:61], v5 offset:12288
    ds_read_b64_tr_b16 v[62:63], v5 offset:13312
    v_mfma_f32_32x32x16_bf16 v[64:79], v[32:35], v[136:139], v[64:79]
    ds_read_b64_tr_b16 v[32:33], v2 offset:16384
    ds_read_b64_tr_b16 v[34:35], v2 offset:17408
    buffer_load_dwordx4 v1, s[12:15], s42 offen lds
    s_add_u32 s42, s42, 32768
    s_add_u32 s43, s43, 1024
    s_mov_b32 m0, s43
    s_waitcnt lgkmcnt(14)
    v_mfma_f32_32x32x16_bf16 v[80:95], v[36:39], v[136:139], v[80:95]
    s_waitcnt lgkmcnt(12)
    ds_read_b64_tr_b16 v[36:37], v3 offset:16384
    ds_read_b64_tr_b16 v[38:39], v3 offset:17408
    v_mfma_f32_32x32x16_bf16 v[96:111], v[40:43], v[136:139], v[96:111]
    s_waitcnt lgkmcnt(12)
    ds_read_b64_tr_b16 v[40:41], v4 offset:16384
    ds_read_b64_tr_b16 v[42:43], v4 offset:17408
    v_mfma_f32_32x32x16_bf16 v[112:127], v[44:47], v[136:139], v[112:127]
    ds_read_b64_tr_b16 v[44:45], v5 offset:16384
    ds_read_b64_tr_b16 v[46:47], v5 offset:17408
    buffer_load_dwordx4 v1, s[12:15], s42 offen lds
    s_add_u32 s42, s42, 32768
    s_add_u32 s43, s43, 1024
    s_mov_b32 m0, s43
    s_waitcnt lgkmcnt(14)
    v_mfma_f32_32x32x16_bf16 v[64:79], v[48:51], v[140:143], v[64:79]
    s_waitcnt lgkmcnt(12)
    ds_read_b64_tr_b16 v[48:49], v2 offset:20480
    ds_read_b64_tr_b16 v[50:51], v2 offset:21504
    v_mfma_f32_32x32x16_bf16 v[80:95], v[52:55], v[140:143], v[80:95]
    s_waitcnt lgkmcnt(12)
    ds_read_b64_tr_b16 v[52:53], v3 offset:20480
    ds_read_b64_tr_b16 v[54:55], v3 offset:21504
    v_mfma_f32_32x32x16_bf16 v[96:111], v[56:59], v[140:143], v[96:111]
    ds_read_b64_tr_b16 v[56:57], v4 offset:20480
    ds_read_b64_tr_b16 v[58:59], v4 offset:21504
    buffer_load_dwordx4 v1, s[12:15], s42 offen lds
    s_add_u32 s42, s42, 32768
    s_add_u32 s43, s43, 1024
    s_mov_b32 m0, s43
    s_waitcnt lgkmcnt(14)
    v_mfma_f32_32x32x16_bf16 v[112:127], v[60:63], v[140:143], v[112:127]
    s_waitcnt lgkmcnt(12)
    ds_read_b64_tr_b16 v[60:61], v5 offset:20480
    ds_read_b64_tr_b16 v[62:63], v5 offset:21504
    v_mfma_f32_32x32x16_bf16 v[64:79], v[32:35], v[144:147], v[64:79]
    s_waitcnt lgkmcnt(12)
    ds_read_b64_tr_b16 v[32:33], v2 offset:24576
    ds_read_b64_tr_b16 v[34:35], v2 offset:25600
    v_mfma_f32_32x32x16_bf16 v[80:95], v[36:39], v[144:147], v[80:95]
    ds_read_b64_tr_b16 v[36:37], v3 offset:24576
    ds_read_b64_tr_b16 v[38:39], v3 offset:25600
    buffer_load_dwordx4 v1, s[12:15], s42 offen lds
    s_add_u32 s42, s42, 32768
    s_add_u32 s43, s43, 1024
    s_mov_b32 m0, s43
    s_waitcnt lgkmcnt(14)
    v_mfma_f32_32x32x16_bf16 v[96:111], v[40:43], v[144:147], v[96:111]
    s_waitcnt lgkmcnt(12)
    ds_read_b64_tr_b16 v[40:41], v4 offset:24576
    ds_read_b64_tr_b16 v[42:43], v4 offset:25600
    v_mfma_f32_32x32x16_bf16 v[112:127], v[44:47], v[144:147], v[112:127]
    s_waitcnt lgkmcnt(12)
    ds_read_b64_tr_b16 v[44:45], v5 offset:24576
    ds_read_b64_tr_b16 v[46:47], v5 offset:25600
    v_mfma_f32_32x32x16_bf16 v[64:79], v[48:51], v[148:151], v[64:79]
    ds_read_b64_tr_b16 v[48:49], v2 offset:28672
    ds_read_b64_tr_b16 v[50:51], v2 offset:29696
    buffer_load_dwordx4 v1, s[12:15], s42 offen lds
    s_waitcnt lgkmcnt(14)
    v_mfma_f32_32x32x16_bf16 v[80:95], v[52:55], v[148:151], v[80:95]
    s_waitcnt lgkmcnt(12)
    ds_read_b64_tr_b16 v[52:53], v3 offset:28672
    ds_read_b64_tr_b16 v[54:55], v3 offset:29696
    v_mfma_f32_32x32x16_bf16 v[96:111], v[56:59], v[148:151], v[96:111]
    s_waitcnt lgkmcnt(12)
    ds_read_b64_tr_b16 v[56:57], v4 offset:28672
    ds_read_b64_tr_b16 v[58:59], v4 offset:29696
    v_mfma_f32_32x32x16_bf16 v[112:127], v[60:63], v[148:151], v[112:127]
    s_waitcnt lgkmcnt(12)
    ds_read_b64_tr_b16 v[60:61], v5 offset:28672
    ds_read_b64_tr_b16 v[62:63], v5 offset:29696
    v_mfma_f32_32x32x16_bf16 v[64:79], v[32:35], v[152:155], v[64:79]
    s_waitcnt lgkmcnt(12)
    v_mfma_f32_32x32x16_bf16 v[80:95], v[36:39], v[152:155], v[80:95]
    s_waitcnt lgkmcnt(10)
    v_mfma_f32_32x32x16_bf16 v[96:111], v[40:43], v[152:155], v[96:111]
    s_waitcnt lgkmcnt(8)
    v_mfma_f32_32x32x16_bf16 v[112:127], v[44:47], v[152:155], v[112:127]
    s_waitcnt lgkmcnt(6)
    v_mfma_f32_32x32x16_bf16 v[64:79], v[48:51], v[156:159], v[64:79]
    s_waitcnt lgkmcnt(4)
    v_mfma_f32_32x32x16_bf16 v[80:95], v[52:55], v[156:159], v[80:95]
    s_waitcnt lgkmcnt(2)
    v_mfma_f32_32x32x16_bf16 v[96:111], v[56:59], v[156:159], v[96:111]
    s_waitcnt lgkmcnt(0)
    v_mfma_f32_32x32x16_bf16 v[112:127], v[60:63], v[156:159], v[112:127]
    s_cmp_eq_u32 s53, 1
    s_cbranch_scc1 L_w16_80
    s_waitcnt vmcnt(24)
    s_branch L_wj_81
L_w16_80:
    s_waitcnt vmcnt(16)
L_wj_81:
    s_barrier
    s_lshl_b32 s42, s32, 5
    s_add_u32 s42, s42, 0
    s_mul_i32 s42, s42, 8192
    s_add_u32 s42, s42, s37
    s_lshl_b32 s43, s32, 13
    ds_read_b64_tr_b16 v[32:33], v2 offset:32768
    ds_read_b64_tr_b16 v[34:35], v2 offset:33792
    ds_read_b64_tr_b16 v[36:37], v3 offset:32768
    ds_read_b64_tr_b16 v[38:39], v3 offset:33792
    ds_read_b64_tr_b16 v[40:41], v4 offset:32768
    ds_read_b64_tr_b16 v[42:43], v4 offset:33792
    ds_read_b64_tr_b16 v[44:45], v5 offset:32768
    ds_read_b64_tr_b16 v[46:47], v5 offset:33792
    ds_read_b64_tr_b16 v[48:49], v2 offset:36864
    ds_read_b64_tr_b16 v[50:51], v2 offset:37888
    ds_read_b64_tr_b16 v[52:53], v3 offset:36864
    ds_read_b64_tr_b16 v[54:55], v3 offset:37888
    ds_read_b64_tr_b16 v[56:57], v4 offset:36864
    ds_read_b64_tr_b16 v[58:59], v4 offset:37888
    ds_read_b64_tr_b16 v[60:61], v5 offset:36864
    s_add_u32 s43, s43, 0
    s_mov_b32 m0, s43
    ds_read_b64_tr_b16 v[62:63], v5 offset:37888
    buffer_load_dwordx4 v1, s[16:19], s42 offen lds
    s_add_u32 s42, s42, 32768
    s_add_u32 s43, s43, 1024
    s_mov_b32 m0, s43
    s_waitcnt lgkmcnt(14)
    v_mfma_f32_32x32x16_bf16 v[64:79], v[32:35], v[160:163], v[64:79]
    s_waitcnt lgkmcnt(12)
    ds_read_b64_tr_b16 v[32:33], v2 offset:40960
    ds_read_b64_tr_b16 v[34:35], v2 offset:41984
    v_mfma_f32_32x32x16_bf16 v[80:95], v[36:39], v[160:163], v[80:95]
    s_waitcnt lgkmcnt(12)
    ds_read_b64_tr_b16 v[36:37], v3 offset:40960
    ds_read_b64_tr_b16 v[38:39], v3 offset:41984
    v_mfma_f32_32x32x16_bf16 v[96:111], v[40:43], v[160:163], v[96:111]
    ds_read_b64_tr_b16 v[40:41], v4 offset:40960
    ds_read_b64_tr_b16 v[42:43], v4 offset:41984
    buffer_load_dwordx4 v1, s[16:19], s42 offen lds
    s_add_u32 s42, s42, 32768
    s_add_u32 s43, s43, 1024
    s_mov_b32 m0, s43
    s_waitcnt lgkmcnt(14)
    v_mfma_f32_32x32x16_bf16 v[112:127], v[44:47], v[160:163], v[112:127]
    s_waitcnt lgkmcnt(12)
    ds_read_b64_tr_b16 v[44:45], v5 offset:40960
    ds_read_b64_tr_b16 v[46:47], v5 offset:41984
    v_mfma_f32_32x32x16_bf16 v[64:79], v[48:51], v[164:167], v[64:79]
    s_waitcnt lgkmcnt(12)
    ds_read_b64_tr_b16 v[48:49], v2 offset:45056
    ds_read_b64_tr_b16 v[50:51], v2 offset:46080
    v_mfma_f32_32x32x16_bf16 v[80:95], v[52:55], v[164:167], v[80:95]
    ds_read_b64_tr_b16 v[52:53], v3 offset:45056
    ds_read_b64_tr_b16 v[54:55], v3 offset:46080
    buffer_load_dwordx4 v1, s[16:19], s42 offen lds
    s_add_u32 s42, s42, 32768
    s_add_u32 s43, s43, 1024
    s_mov_b32 m0, s43
    s_waitcnt lgkmcnt(14)
    v_mfma_f32_32x32x16_bf16 v[96:111], v[56:59], v[164:167], v[96:111]
    s_waitcnt lgkmcnt(12)
    ds_read_b64_tr_b16 v[56:57], v4 offset:45056
    ds_read_b64_tr_b16 v[58:59], v4 offset:46080
    v_mfma_f32_32x32x16_bf16 v[112:127], v[60:63], v[164:167], v[112:127]
    s_waitcnt lgkmcnt(12)
    ds_read_b64_tr_b16 v[60:61], v5 offset:45056
    ds_read_b64_tr_b16 v[62:63], v5 offset:46080
    v_mfma_f32_32x32x16_bf16 v[64:79], v[32:35], v[168:171], v[64:79]
    ds_read_b64_tr_b16 v[32:33], v2 offset:49152
    ds_read_b64_tr_b16 v[34:35], v2 offset:50176
    buffer_load_dwordx4 v1, s[16:19], s42 offen lds
    s_add_u32 s42, s42, 32768
    s_add_u32 s43, s43, 1024
    s_mov_b32 m0, s43
    s_waitcnt lgkmcnt(14)
    v_mfma_f32_32x32x16_bf16 v[80:95], v[36:39], v[168:171], v[80:95]
    s_waitcnt lgkmcnt(12)
    ds_read_b64_tr_b16 v[36:37], v3 offset:49152
    ds_read_b64_tr_b16 v[38:39], v3 offset:50176
    v_mfma_f32_32x32x16_bf16 v[96:111], v[40:43], v[168:171], v[96:111]
    s_waitcnt lgkmcnt(12)
    ds_read_b64_tr_b16 v[40:41], v4 offset:49152
    ds_read_b64_tr_b16 v[42:43], v4 offset:50176
    v_mfma_f32_32x32x16_bf16 v[112:127], v[44:47], v[168:171], v[112:127]
    ds_read_b64_tr_b16 v[44:45], v5 offset:49152
    ds_read_b64_tr_b16 v[46:47], v5 offset:50176
    buffer_load_dwordx4 v1, s[16:19], s42 offen lds
    s_add_u32 s42, s42, 32768
    s_add_u32 s43, s43, 1024
    s_mov_b32 m0, s43
    s_waitcnt lgkmcnt(14)
    v_mfma_f32_32x32x16_bf16 v[64:79], v[48:51], v[172:175], v[64:79]
    s_waitcnt lgkmcnt(12)
    ds_read_b64_tr_b16 v[48:49], v2 offset:53248
    ds_read_b64_tr_b16 v[50:51], v2 offset:54272
    v_mfma_f32_32x32x16_bf16 v[80:95], v[52:55], v[172:175], v[80:95]
    s_waitcnt lgkmcnt(12)
    ds_read_b64_tr_b16 v[52:53], v3 offset:53248
    ds_read_b64_tr_b16 v[54:55], v3 offset:54272
    v_mfma_f32_32x32x16_bf16 v[96:111], v[56:59], v[172:175], v[96:111]
    ds_read_b64_tr_b16 v[56:57], v4 offset:53248
    ds_read_b64_tr_b16 v[58:59], v4 offset:54272
    buffer_load_dwordx4 v1, s[16:19], s42 offen lds
    s_add_u32 s42, s42, 32768
    s_add_u32 s43, s43, 1024
    s_mov_b32 m0, s43
    s_waitcnt lgkmcnt(14)
    v_mfma_f32_32x32x16_bf16 v[112:127], v[60:63], v[172:175], v[112:127]
    s_waitcnt lgkmcnt(12)
    ds_read_b64_tr_b16 v[60:61], v5 offset:53248
    ds_read_b64_tr_b16 v[62:63], v5 offset:54272
    v_mfma_f32_32x32x16_bf16 v[64:79], v[32:35], v[176:179], v[64:79]
    s_waitcnt lgkmcnt(12)
    ds_read_b64_tr_b16 v[32:33], v2 offset:57344
    ds_read_b64_tr_b16 v[34:35], v2 offset:58368
    v_mfma_f32_32x32x16_bf16 v[80:95], v[36:39], v[176:179], v[80:95]
    ds_read_b64_tr_b16 v[36:37], v3 offset:57344
    ds_read_b64_tr_b16 v[38:39], v3 offset:58368
    buffer_load_dwordx4 v1, s[16:19], s42 offen lds
    s_add_u32 s42, s42, 32768
    s_add_u32 s43, s43, 1024
    s_mov_b32 m0, s43
    s_waitcnt lgkmcnt(14)
    v_mfma_f32_32x32x16_bf16 v[96:111], v[40:43], v[176:179], v[96:111]
    s_waitcnt lgkmcnt(12)
    ds_read_b64_tr_b16 v[40:41], v4 offset:57344
    ds_read_b64_tr_b16 v[42:43], v4 offset:58368
    v_mfma_f32_32x32x16_bf16 v[112:127], v[44:47], v[176:179], v[112:127]
    s_waitcnt lgkmcnt(12)
    ds_read_b64_tr_b16 v[44:45], v5 offset:57344
    ds_read_b64_tr_b16 v[46:47], v5 offset:58368
    v_mfma_f32_32x32x16_bf16 v[64:79], v[48:51], v[180:183], v[64:79]
    ds_read_b64_tr_b16 v[48:49], v2 offset:61440
    ds_read_b64_tr_b16 v[50:51], v2 offset:62464
    buffer_load_dwordx4 v1, s[16:19], s42 offen lds
    s_waitcnt lgkmcnt(14)
    v_mfma_f32_32x32x16_bf16 v[80:95], v[52:55], v[180:183], v[80:95]
    s_waitcnt lgkmcnt(12)
    ds_read_b64_tr_b16 v[52:53], v3 offset:61440
    ds_read_b64_tr_b16 v[54:55], v3 offset:62464
    v_mfma_f32_32x32x16_bf16 v[96:111], v[56:59], v[180:183], v[96:111]
    s_waitcnt lgkmcnt(12)
    ds_read_b64_tr_b16 v[56:57], v4 offset:61440
    ds_read_b64_tr_b16 v[58:59], v4 offset:62464
    v_mfma_f32_32x32x16_bf16 v[112:127], v[60:63], v[180:183], v[112:127]
    s_waitcnt lgkmcnt(12)
    ds_read_b64_tr_b16 v[60:61], v5 offset:61440
    ds_read_b64_tr_b16 v[62:63], v5 offset:62464
    v_mfma_f32_32x32x16_bf16 v[64:79], v[32:35], v[184:187], v[64:79]
    s_waitcnt lgkmcnt(12)
    v_mfma_f32_32x32x16_bf16 v[80:95], v[36:39], v[184:187], v[80:95]
    s_waitcnt lgkmcnt(10)
    v_mfma_f32_32x32x16_bf16 v[96:111], v[40:43], v[184:187], v[96:111]
    s_waitcnt lgkmcnt(8)
    v_mfma_f32_32x32x16_bf16 v[112:127], v[44:47], v[184:187], v[112:127]
    s_waitcnt lgkmcnt(6)
    v_mfma_f32_32x32x16_bf16 v[64:79], v[48:51], v[188:191], v[64:79]
    s_waitcnt lgkmcnt(4)
    v_mfma_f32_32x32x16_bf16 v[80:95], v[52:55], v[188:191], v[80:95]
    s_waitcnt lgkmcnt(2)
    v_mfma_f32_32x32x16_bf16 v[96:111], v[56:59], v[188:191], v[96:111]
    s_waitcnt lgkmcnt(0)
    v_mfma_f32_32x32x16_bf16 v[112:127], v[60:63], v[188:191], v[112:127]
    s_cmp_eq_u32 s53, 1
    s_cbranch_scc1 L_w16_82
    s_waitcnt vmcnt(24)
    s_branch L_wj_83
L_w16_82:
    s_waitcnt vmcnt(16)
L_wj_83:
    s_barrier
    s_lshl_b32 s42, s32, 5
    s_add_u32 s42, s42, 128
    s_mul_i32 s42, s42, 8192
    s_add_u32 s42, s42, s37
    s_lshl_b32 s43, s32, 13
    ds_read_b64_tr_b16 v[32:33], v6 offset:0
    ds_read_b64_tr_b16 v[34:35], v6 offset:1024
    ds_read_b64_tr_b16 v[36:37], v7 offset:0
    ds_read_b64_tr_b16 v[38:39], v7 offset:1024
    ds_read_b64_tr_b16 v[40:41], v8 offset:0
    ds_read_b64_tr_b16 v[42:43], v8 offset:1024
    ds_read_b64_tr_b16 v[44:45], v9 offset:0
    ds_read_b64_tr_b16 v[46:47], v9 offset:1024
    ds_read_b64_tr_b16 v[48:49], v6 offset:4096
    ds_read_b64_tr_b16 v[50:51], v6 offset:5120
    ds_read_b64_tr_b16 v[52:53], v7 offset:4096
    ds_read_b64_tr_b16 v[54:55], v7 offset:5120
    ds_read_b64_tr_b16 v[56:57], v8 offset:4096
    ds_read_b64_tr_b16 v[58:59], v8 offset:5120
    ds_read_b64_tr_b16 v[60:61], v9 offset:4096
    s_add_u32 s43, s43, 32768
    s_mov_b32 m0, s43
    ds_read_b64_tr_b16 v[62:63], v9 offset:5120
    buffer_load_dwordx4 v1, s[16:19], s42 offen lds
    s_add_u32 s42, s42, 32768
    s_add_u32 s43, s43, 1024
    s_mov_b32 m0, s43
    s_waitcnt lgkmcnt(14)
    v_mfma_f32_32x32x16_bf16 v[64:79], v[32:35], v[192:195], v[64:79]
    s_waitcnt lgkmcnt(12)
    ds_read_b64_tr_b16 v[32:33], v6 offset:8192
    ds_read_b64_tr_b16 v[34:35], v6 offset:9216
    v_mfma_f32_32x32x16_bf16 v[80:95], v[36:39], v[192:195], v[80:95]
    s_waitcnt lgkmcnt(12)
    ds_read_b64_tr_b16 v[36:37], v7 offset:8192
    ds_read_b64_tr_b16 v[38:39], v7 offset:9216
    v_mfma_f32_32x32x16_bf16 v[96:111], v[40:43], v[192:195], v[96:111]
    ds_read_b64_tr_b16 v[40:41], v8 offset:8192
    ds_read_b64_tr_b16 v[42:43], v8 offset:9216
    buffer_load_dwordx4 v1, s[16:19], s42 offen lds
    s_add_u32 s42, s42, 32768
    s_add_u32 s43, s43, 1024
    s_mov_b32 m0, s43
    s_waitcnt lgkmcnt(14)
    v_mfma_f32_32x32x16_bf16 v[112:127], v[44:47], v[192:195], v[112:127]
    s_waitcnt lgkmcnt(12)
    ds_read_b64_tr_b16 v[44:45], v9 offset:8192
    ds_read_b64_tr_b16 v[46:47], v9 offset:9216
    v_mfma_f32_32x32x16_bf16 v[64:79], v[48:51], v[196:199], v[64:79]
    s_waitcnt lgkmcnt(12)
    ds_read_b64_tr_b16 v[48:49], v6 offset:12288
    ds_read_b64_tr_b16 v[50:51], v6 offset:13312
    v_mfma_f32_32x32x16_bf16 v[80:95], v[52:55], v[196:199], v[80:95]
    ds_read_b64_tr_b16 v[52:53], v7 offset:12288
    ds_read_b64_tr_b16 v[54:55], v7 offset:13312
    buffer_load_dwordx4 v1, s[16:19], s42 offen lds
    s_add_u32 s42, s42, 32768
    s_add_u32 s43, s43, 1024
    s_mov_b32 m0, s43
    s_waitcnt lgkmcnt(14)
    v_mfma_f32_32x32x16_bf16 v[96:111], v[56:59], v[196:199], v[96:111]
    s_waitcnt lgkmcnt(12)
    ds_read_b64_tr_b16 v[56:57], v8 offset:12288
    ds_read_b64_tr_b16 v[58:59], v8 offset:13312
    v_mfma_f32_32x32x16_bf16 v[112:127], v[60:63], v[196:199], v[112:127]
    s_waitcnt lgkmcnt(12)
    ds_read_b64_tr_b16 v[60:61], v9 offset:12288
    ds_read_b64_tr_b16 v[62:63], v9 offset:13312
    v_mfma_f32_32x32x16_bf16 v[64:79], v[32:35], v[200:203], v[64:79]
    ds_read_b64_tr_b16 v[32:33], v6 offset:16384
    ds_read_b64_tr_b16 v[34:35], v6 offset:17408
    buffer_load_dwordx4 v1, s[16:19], s42 offen lds
    s_add_u32 s42, s42, 32768
    s_add_u32 s43, s43, 1024
    s_mov_b32 m0, s43
    s_waitcnt lgkmcnt(14)
    v_mfma_f32_32x32x16_bf16 v[80:95], v[36:39], v[200:203], v[80:95]
    s_waitcnt lgkmcnt(12)
    ds_read_b64_tr_b16 v[36:37], v7 offset:16384
    ds_read_b64_tr_b16 v[38:39], v7 offset:17408
    v_mfma_f32_32x32x16_bf16 v[96:111], v[40:43], v[200:203], v[96:111]
    s_waitcnt lgkmcnt(12)
    ds_read_b64_tr_b16 v[40:41], v8 offset:16384
    ds_read_b64_tr_b16 v[42:43], v8 offset:17408
    v_mfma_f32_32x32x16_bf16 v[112:127], v[44:47], v[200:203], v[112:127]
    ds_read_b64_tr_b16 v[44:45], v9 offset:16384
    ds_read_b64_tr_b16 v[46:47], v9 offset:17408
    buffer_load_dwordx4 v1, s[16:19], s42 offen lds
    s_add_u32 s42, s42, 32768
    s_add_u32 s43, s43, 1024
    s_mov_b32 m0, s43
    s_waitcnt lgkmcnt(14)
    v_mfma_f32_32x32x16_bf16 v[64:79], v[48:51], v[204:207], v[64:79]
    s_waitcnt lgkmcnt(12)
    ds_read_b64_tr_b16 v[48:49], v6 offset:20480
    ds_read_b64_tr_b16 v[50:51], v6 offset:21504
    v_mfma_f32_32x32x16_bf16 v[80:95], v[52:55], v[204:207], v[80:95]
    s_waitcnt lgkmcnt(12)
    ds_read_b64_tr_b16 v[52:53], v7 offset:20480
    ds_read_b64_tr_b16 v[54:55], v7 offset:21504
    v_mfma_f32_32x32x16_bf16 v[96:111], v[56:59], v[204:207], v[96:111]
    ds_read_b64_tr_b16 v[56:57], v8 offset:20480
    ds_read_b64_tr_b16 v[58:59], v8 offset:21504
    buffer_load_dwordx4 v1, s[16:19], s42 offen lds
    s_add_u32 s42, s42, 32768
    s_add_u32 s43, s43, 1024
    s_mov_b32 m0, s43
    s_waitcnt lgkmcnt(14)
    v_mfma_f32_32x32x16_bf16 v[112:127], v[60:63], v[204:207], v[112:127]
    s_waitcnt lgkmcnt(12)
    ds_read_b64_tr_b16 v[60:61], v9 offset:20480
    ds_read_b64_tr_b16 v[62:63], v9 offset:21504
    v_mfma_f32_32x32x16_bf16 v[64:79], v[32:35], v[208:211], v[64:79]
    s_waitcnt lgkmcnt(12)
    ds_read_b64_tr_b16 v[32:33], v6 offset:24576
    ds_read_b64_tr_b16 v[34:35], v6 offset:25600
    v_mfma_f32_32x32x16_bf16 v[80:95], v[36:39], v[208:211], v[80:95]
    ds_read_b64_tr_b16 v[36:37], v7 offset:24576
    ds_read_b64_tr_b16 v[38:39], v7 offset:25600
    buffer_load_dwordx4 v1, s[16:19], s42 offen lds
    s_add_u32 s42, s42, 32768
    s_add_u32 s43, s43, 1024
    s_mov_b32 m0, s43
    s_waitcnt lgkmcnt(14)
    v_mfma_f32_32x32x16_bf16 v[96:111], v[40:43], v[208:211], v[96:111]
    s_waitcnt lgkmcnt(12)
    ds_read_b64_tr_b16 v[40:41], v8 offset:24576
    ds_read_b64_tr_b16 v[42:43], v8 offset:25600
    v_mfma_f32_32x32x16_bf16 v[112:127], v[44:47], v[208:211], v[112:127]
    s_waitcnt lgkmcnt(12)
    ds_read_b64_tr_b16 v[44:45], v9 offset:24576
    ds_read_b64_tr_b16 v[46:47], v9 offset:25600
    v_mfma_f32_32x32x16_bf16 v[64:79], v[48:51], v[212:215], v[64:79]
    ds_read_b64_tr_b16 v[48:49], v6 offset:28672
    ds_read_b64_tr_b16 v[50:51], v6 offset:29696
    buffer_load_dwordx4 v1, s[16:19], s42 offen lds
    s_waitcnt lgkmcnt(14)
    v_mfma_f32_32x32x16_bf16 v[80:95], v[52:55], v[212:215], v[80:95]
    s_waitcnt lgkmcnt(12)
    ds_read_b64_tr_b16 v[52:53], v7 offset:28672
    ds_read_b64_tr_b16 v[54:55], v7 offset:29696
    v_mfma_f32_32x32x16_bf16 v[96:111], v[56:59], v[212:215], v[96:111]
    s_waitcnt lgkmcnt(12)
    ds_read_b64_tr_b16 v[56:57], v8 offset:28672
    ds_read_b64_tr_b16 v[58:59], v8 offset:29696
    v_mfma_f32_32x32x16_bf16 v[112:127], v[60:63], v[212:215], v[112:127]
    s_waitcnt lgkmcnt(12)
    ds_read_b64_tr_b16 v[60:61], v9 offset:28672
    ds_read_b64_tr_b16 v[62:63], v9 offset:29696
    v_mfma_f32_32x32x16_bf16 v[64:79], v[32:35], v[216:219], v[64:79]
    s_waitcnt lgkmcnt(12)
    v_mfma_f32_32x32x16_bf16 v[80:95], v[36:39], v[216:219], v[80:95]
    s_waitcnt lgkmcnt(10)
    v_mfma_f32_32x32x16_bf16 v[96:111], v[40:43], v[216:219], v[96:111]
    s_waitcnt lgkmcnt(8)
    v_mfma_f32_32x32x16_bf16 v[112:127], v[44:47], v[216:219], v[112:127]
    s_waitcnt lgkmcnt(6)
    v_mfma_f32_32x32x16_bf16 v[64:79], v[48:51], v[220:223], v[64:79]
    s_waitcnt lgkmcnt(4)
    v_mfma_f32_32x32x16_bf16 v[80:95], v[52:55], v[220:223], v[80:95]
    s_waitcnt lgkmcnt(2)
    v_mfma_f32_32x32x16_bf16 v[96:111], v[56:59], v[220:223], v[96:111]
    s_waitcnt lgkmcnt(0)
    v_mfma_f32_32x32x16_bf16 v[112:127], v[60:63], v[220:223], v[112:127]
    s_waitcnt vmcnt(16)
    s_barrier
    s_lshl_b32 s42, s32, 5
    s_add_u32 s42, s42, 256
    s_mul_i32 s42, s42, 8192
    s_add_u32 s42, s42, s37
    s_lshl_b32 s43, s32, 13
    ds_read_b64_tr_b16 v[32:33], v6 offset:32768
    ds_read_b64_tr_b16 v[34:35], v6 offset:33792
    ds_read_b64_tr_b16 v[36:37], v7 offset:32768
    ds_read_b64_tr_b16 v[38:39], v7 offset:33792
    ds_read_b64_tr_b16 v[40:41], v8 offset:32768
    ds_read_b64_tr_b16 v[42:43], v8 offset:33792
    ds_read_b64_tr_b16 v[44:45], v9 offset:32768
    ds_read_b64_tr_b16 v[46:47], v9 offset:33792
    ds_read_b64_tr_b16 v[48:49], v6 offset:36864
    ds_read_b64_tr_b16 v[50:51], v6 offset:37888
    ds_read_b64_tr_b16 v[52:53], v7 offset:36864
    ds_read_b64_tr_b16 v[54:55], v7 offset:37888
    ds_read_b64_tr_b16 v[56:57], v8 offset:36864
    ds_read_b64_tr_b16 v[58:59], v8 offset:37888
    ds_read_b64_tr_b16 v[60:61], v9 offset:36864
    s_add_u32 s43, s43, 65536
    s_mov_b32 m0, s43
    ds_read_b64_tr_b16 v[62:63], v9 offset:37888
    buffer_load_dwordx4 v1, s[16:19], s42 offen lds
    s_add_u32 s42, s42, 32768
    s_add_u32 s43, s43, 1024
    s_mov_b32 m0, s43
    s_waitcnt lgkmcnt(14)
    v_mfma_f32_32x32x16_bf16 v[64:79], v[32:35], v[224:227], v[64:79]
    s_waitcnt lgkmcnt(12)
    ds_read_b64_tr_b16 v[32:33], v6 offset:40960
    ds_read_b64_tr_b16 v[34:35], v6 offset:41984
    v_mfma_f32_32x32x16_bf16 v[80:95], v[36:39], v[224:227], v[80:95]
    s_waitcnt lgkmcnt(12)
    ds_read_b64_tr_b16 v[36:37], v7 offset:40960
    ds_read_b64_tr_b16 v[38:39], v7 offset:41984
    v_mfma_f32_32x32x16_bf16 v[96:111], v[40:43], v[224:227], v[96:111]
    ds_read_b64_tr_b16 v[40:41], v8 offset:40960
    ds_read_b64_tr_b16 v[42:43], v8 offset:41984
    buffer_load_dwordx4 v1, s[16:19], s42 offen lds
    s_add_u32 s42, s42, 32768
    s_add_u32 s43, s43, 1024
    s_mov_b32 m0, s43
    s_waitcnt lgkmcnt(14)
    v_mfma_f32_32x32x16_bf16 v[112:127], v[44:47], v[224:227], v[112:127]
    s_waitcnt lgkmcnt(12)
    ds_read_b64_tr_b16 v[44:45], v9 offset:40960
    ds_read_b64_tr_b16 v[46:47], v9 offset:41984
    v_mfma_f32_32x32x16_bf16 v[64:79], v[48:51], v[228:231], v[64:79]
    s_waitcnt lgkmcnt(12)
    ds_read_b64_tr_b16 v[48:49], v6 offset:45056
    ds_read_b64_tr_b16 v[50:51], v6 offset:46080
    v_mfma_f32_32x32x16_bf16 v[80:95], v[52:55], v[228:231], v[80:95]
    ds_read_b64_tr_b16 v[52:53], v7 offset:45056
    ds_read_b64_tr_b16 v[54:55], v7 offset:46080
    buffer_load_dwordx4 v1, s[16:19], s42 offen lds
    s_add_u32 s42, s42, 32768
    s_add_u32 s43, s43, 1024
    s_mov_b32 m0, s43
    s_waitcnt lgkmcnt(14)
    v_mfma_f32_32x32x16_bf16 v[96:111], v[56:59], v[228:231], v[96:111]
    s_waitcnt lgkmcnt(12)
    ds_read_b64_tr_b16 v[56:57], v8 offset:45056
    ds_read_b64_tr_b16 v[58:59], v8 offset:46080
    v_mfma_f32_32x32x16_bf16 v[112:127], v[60:63], v[228:231], v[112:127]
    s_waitcnt lgkmcnt(12)
    ds_read_b64_tr_b16 v[60:61], v9 offset:45056
    ds_read_b64_tr_b16 v[62:63], v9 offset:46080
    v_mfma_f32_32x32x16_bf16 v[64:79], v[32:35], v[232:235], v[64:79]
    ds_read_b64_tr_b16 v[32:33], v6 offset:49152
    ds_read_b64_tr_b16 v[34:35], v6 offset:50176
    buffer_load_dwordx4 v1, s[16:19], s42 offen lds
    s_add_u32 s42, s42, 32768
    s_add_u32 s43, s43, 1024
    s_mov_b32 m0, s43
    s_waitcnt lgkmcnt(14)
    v_mfma_f32_32x32x16_bf16 v[80:95], v[36:39], v[232:235], v[80:95]
    s_waitcnt lgkmcnt(12)
    ds_read_b64_tr_b16 v[36:37], v7 offset:49152
    ds_read_b64_tr_b16 v[38:39], v7 offset:50176
    v_mfma_f32_32x32x16_bf16 v[96:111], v[40:43], v[232:235], v[96:111]
    s_waitcnt lgkmcnt(12)
    ds_read_b64_tr_b16 v[40:41], v8 offset:49152
    ds_read_b64_tr_b16 v[42:43], v8 offset:50176
    v_mfma_f32_32x32x16_bf16 v[112:127], v[44:47], v[232:235], v[112:127]
    ds_read_b64_tr_b16 v[44:45], v9 offset:49152
    ds_read_b64_tr_b16 v[46:47], v9 offset:50176
    buffer_load_dwordx4 v1, s[16:19], s42 offen lds
    s_add_u32 s42, s42, 32768
    s_add_u32 s43, s43, 1024
    s_mov_b32 m0, s43
    s_waitcnt lgkmcnt(14)
    v_mfma_f32_32x32x16_bf16 v[64:79], v[48:51], v[236:239], v[64:79]
    s_waitcnt lgkmcnt(12)
    ds_read_b64_tr_b16 v[48:49], v6 offset:53248
    ds_read_b64_tr_b16 v[50:51], v6 offset:54272
    v_mfma_f32_32x32x16_bf16 v[80:95], v[52:55], v[236:239], v[80:95]
    s_waitcnt lgkmcnt(12)
    ds_read_b64_tr_b16 v[52:53], v7 offset:53248
    ds_read_b64_tr_b16 v[54:55], v7 offset:54272
    v_mfma_f32_32x32x16_bf16 v[96:111], v[56:59], v[236:239], v[96:111]
    ds_read_b64_tr_b16 v[56:57], v8 offset:53248
    ds_read_b64_tr_b16 v[58:59], v8 offset:54272
    buffer_load_dwordx4 v1, s[16:19], s42 offen lds
    s_add_u32 s42, s42, 32768
    s_add_u32 s43, s43, 1024
    s_mov_b32 m0, s43
    s_waitcnt lgkmcnt(14)
    v_mfma_f32_32x32x16_bf16 v[112:127], v[60:63], v[236:239], v[112:127]
    s_waitcnt lgkmcnt(12)
    ds_read_b64_tr_b16 v[60:61], v9 offset:53248
    ds_read_b64_tr_b16 v[62:63], v9 offset:54272
    v_mfma_f32_32x32x16_bf16 v[64:79], v[32:35], v[240:243], v[64:79]
    s_waitcnt lgkmcnt(12)
    ds_read_b64_tr_b16 v[32:33], v6 offset:57344
    ds_read_b64_tr_b16 v[34:35], v6 offset:58368
    v_mfma_f32_32x32x16_bf16 v[80:95], v[36:39], v[240:243], v[80:95]
    ds_read_b64_tr_b16 v[36:37], v7 offset:57344
    ds_read_b64_tr_b16 v[38:39], v7 offset:58368
    buffer_load_dwordx4 v1, s[16:19], s42 offen lds
    s_add_u32 s42, s42, 32768
    s_add_u32 s43, s43, 1024
    s_mov_b32 m0, s43
    s_waitcnt lgkmcnt(14)
    v_mfma_f32_32x32x16_bf16 v[96:111], v[40:43], v[240:243], v[96:111]
    s_waitcnt lgkmcnt(12)
    ds_read_b64_tr_b16 v[40:41], v8 offset:57344
    ds_read_b64_tr_b16 v[42:43], v8 offset:58368
    v_mfma_f32_32x32x16_bf16 v[112:127], v[44:47], v[240:243], v[112:127]
    s_waitcnt lgkmcnt(12)
    ds_read_b64_tr_b16 v[44:45], v9 offset:57344
    ds_read_b64_tr_b16 v[46:47], v9 offset:58368
    v_mfma_f32_32x32x16_bf16 v[64:79], v[48:51], v[244:247], v[64:79]
    ds_read_b64_tr_b16 v[48:49], v6 offset:61440
    ds_read_b64_tr_b16 v[50:51], v6 offset:62464
    buffer_load_dwordx4 v1, s[16:19], s42 offen lds
    s_waitcnt lgkmcnt(14)
    v_mfma_f32_32x32x16_bf16 v[80:95], v[52:55], v[244:247], v[80:95]
    s_waitcnt lgkmcnt(12)
    ds_read_b64_tr_b16 v[52:53], v7 offset:61440
    ds_read_b64_tr_b16 v[54:55], v7 offset:62464
    v_mfma_f32_32x32x16_bf16 v[96:111], v[56:59], v[244:247], v[96:111]
    s_waitcnt lgkmcnt(12)
    ds_read_b64_tr_b16 v[56:57], v8 offset:61440
    ds_read_b64_tr_b16 v[58:59], v8 offset:62464
    v_mfma_f32_32x32x16_bf16 v[112:127], v[60:63], v[244:247], v[112:127]
    s_waitcnt lgkmcnt(12)
    ds_read_b64_tr_b16 v[60:61], v9 offset:61440
    ds_read_b64_tr_b16 v[62:63], v9 offset:62464
    v_mfma_f32_32x32x16_bf16 v[64:79], v[32:35], v[248:251], v[64:79]
    s_waitcnt lgkmcnt(12)
    v_mfma_f32_32x32x16_bf16 v[80:95], v[36:39], v[248:251], v[80:95]
    s_waitcnt lgkmcnt(10)
    v_mfma_f32_32x32x16_bf16 v[96:111], v[40:43], v[248:251], v[96:111]
    s_waitcnt lgkmcnt(8)
    v_mfma_f32_32x32x16_bf16 v[112:127], v[44:47], v[248:251], v[112:127]
    s_waitcnt lgkmcnt(6)
    v_mfma_f32_32x32x16_bf16 v[64:79], v[48:51], v[252:255], v[64:79]
    s_waitcnt lgkmcnt(4)
    v_mfma_f32_32x32x16_bf16 v[80:95], v[52:55], v[252:255], v[80:95]
    s_waitcnt lgkmcnt(2)
    v_mfma_f32_32x32x16_bf16 v[96:111], v[56:59], v[252:255], v[96:111]
    s_waitcnt lgkmcnt(0)
    v_mfma_f32_32x32x16_bf16 v[112:127], v[60:63], v[252:255], v[112:127]
    s_nop 11
    s_cmp_eq_u32 s54, 0
    s_cbranch_scc1 L_sig_84
    s_cmp_lg_u32 s32, 0
    s_cbranch_scc1 L_sig_84
    s_lshl_b32 s38, s33, 2
    s_add_u32 s38, s38, 128
    s_mov_b64 exec, 1
    v_mov_b32 v12, s38
    v_mov_b32 v13, s54
    global_atomic_add v12, v13, s[4:5]
    s_mov_b64 exec, -1
L_sig_84:
    s_mov_b32 s54, 0
    s_lshl_b32 s39, s32, 13
    s_add_u32 s39, s39, 131072
    v_lshrrev_b32 v12, 4, v11
    v_and_b32 v13, 15, v11
    v_xor_b32 v13, v13, v12
    v_lshlrev_b32 v13, 4, v13
    v_lshl_add_u32 v13, v12, 8, v13
    v_add_u32 v20, s39, v13
    v_xor_b32 v21, 64, v20
    v_xor_b32 v22, 128, v20
    v_xor_b32 v23, 192, v20
    v_and_b32 v12, 31, v11
    v_and_b32 v13, 15, v11
    v_lshrrev_b32 v14, 5, v11
    v_xor_b32 v13, v13, v14
    v_lshlrev_b32 v13, 4, v13
    v_lshl_add_u32 v13, v12, 8, v13
    v_add_u32 v24, s39, v13
    v_cvt_pk_bf16_f32 v32, v64, v65
    v_cvt_pk_bf16_f32 v33, v66, v67
    v_cvt_pk_bf16_f32 v34, v68, v69
    v_cvt_pk_bf16_f32 v35, v70, v71
    s_nop 1
    v_permlane32_swap_b32 v32, v34
    v_permlane32_swap_b32 v33, v35
    v_xor_b32 v12, 0, v24
    ds_write_b128 v12, v[32:35]
    v_cvt_pk_bf16_f32 v36, v72, v73
    v_cvt_pk_bf16_f32 v37, v74, v75
    v_cvt_pk_bf16_f32 v38, v76, v77
    v_cvt_pk_bf16_f32 v39, v78, v79
    s_nop 1
    v_permlane32_swap_b32 v36, v38
    v_permlane32_swap_b32 v37, v39
    v_xor_b32 v12, 32, v24
    ds_write_b128 v12, v[36:39]
    v_cvt_pk_bf16_f32 v40, v80, v81
    v_cvt_pk_bf16_f32 v41, v82, v83
    v_cvt_pk_bf16_f32 v42, v84, v85
    v_cvt_pk_bf16_f32 v43, v86, v87
    s_nop 1
    v_permlane32_swap_b32 v40, v42
    v_permlane32_swap_b32 v41, v43
    v_xor_b32 v12, 64, v24
    ds_write_b128 v12, v[40:43]
    v_cvt_pk_bf16_f32 v44, v88, v89
    v_cvt_pk_bf16_f32 v45, v90, v91
    v_cvt_pk_bf16_f32 v46, v92, v93
    v_cvt_pk_bf16_f32 v47, v94, v95
    s_nop 1
    v_permlane32_swap_b32 v44, v46
    v_permlane32_swap_b32 v45, v47
    v_xor_b32 v12, 96, v24
    ds_write_b128 v12, v[44:47]
    v_cvt_pk_bf16_f32 v32, v96, v97
    v_cvt_pk_bf16_f32 v33, v98, v99
    v_cvt_pk_bf16_f32 v34, v100, v101
    v_cvt_pk_bf16_f32 v35, v102, v103
    s_nop 1
    v_permlane32_swap_b32 v32, v34
    v_permlane32_swap_b32 v33, v35
    v_xor_b32 v12, 128, v24
    ds_write_b128 v12, v[32:35]
    v_cvt_pk_bf16_f32 v36, v104, v105
    v_cvt_pk_bf16_f32 v37, v106, v107
    v_cvt_pk_bf16_f32 v38, v108, v109
    v_cvt_pk_bf16_f32 v39, v110, v111
    s_nop 1
    v_permlane32_swap_b32 v36, v38
    v_permlane32_swap_b32 v37, v39
    v_xor_b32 v12, 160, v24
    ds_write_b128 v12, v[36:39]
    v_cvt_pk_bf16_f32 v40, v112, v113
    v_cvt_pk_bf16_f32 v41, v114, v115
    v_cvt_pk_bf16_f32 v42, v116, v117
    v_cvt_pk_bf16_f32 v43, v118, v119
    s_nop 1
    v_permlane32_swap_b32 v40, v42
    v_permlane32_swap_b32 v41, v43
    v_xor_b32 v12, 192, v24
    ds_write_b128 v12, v[40:43]
    v_cvt_pk_bf16_f32 v44, v120, v121
    v_cvt_pk_bf16_f32 v45, v122, v123
    v_cvt_pk_bf16_f32 v46, v124, v125
    v_cvt_pk_bf16_f32 v47, v126, v127
    s_nop 1
    v_permlane32_swap_b32 v44, v46
    v_permlane32_swap_b32 v45, v47
    v_xor_b32 v12, 224, v24
    ds_write_b128 v12, v[44:47]
    s_lshr_b32 s40, s34, 5
    s_cmp_eq_u32 s40, 1
    s_cbranch_scc1 L_t1_v_74
    s_cmp_eq_u32 s40, 0
    s_cselect_b32 s40, 0x1000000, 0x0
    s_add_u32 s44, s44, s40
    s_lshl_b32 s39, s32, 13
    s_add_u32 s39, s39, 131072
    v_lshlrev_b32 v13, 4, v11
    v_add_u32 v12, s39, v13
    s_waitcnt lgkmcnt(0)
    ds_read_b128 v[64:67], v12 offset:0
    ds_read_b128 v[68:71], v12 offset:1024
    ds_read_b128 v[72:75], v12 offset:2048
    ds_read_b128 v[76:79], v12 offset:3072
    ds_read_b128 v[80:83], v12 offset:4096
    ds_read_b128 v[84:87], v12 offset:5120
    ds_read_b128 v[88:91], v12 offset:6144
    ds_read_b128 v[92:95], v12 offset:7168
    s_add_u32 s38, s44, 4096
    s_waitcnt lgkmcnt(7)
    buffer_store_dwordx4 v[64:67], v13, s[8:11], s44 offen offset:0 sc1
    s_waitcnt lgkmcnt(6)
    buffer_store_dwordx4 v[68:71], v13, s[8:11], s44 offen offset:1024 sc1
    s_waitcnt lgkmcnt(5)
    buffer_store_dwordx4 v[72:75], v13, s[8:11], s44 offen offset:2048 sc1
    s_waitcnt lgkmcnt(4)
    buffer_store_dwordx4 v[76:79], v13, s[8:11], s44 offen offset:3072 sc1
    s_waitcnt lgkmcnt(3)
    buffer_store_dwordx4 v[80:83], v13, s[8:11], s38 offen offset:0 sc1
    s_waitcnt lgkmcnt(2)
    buffer_store_dwordx4 v[84:87], v13, s[8:11], s38 offen offset:1024 sc1
    s_waitcnt lgkmcnt(1)
    buffer_store_dwordx4 v[88:91], v13, s[8:11], s38 offen offset:2048 sc1
    s_waitcnt lgkmcnt(0)
    buffer_store_dwordx4 v[92:95], v13, s[8:11], s38 offen offset:3072 sc1
    s_branch L_t1_next_76
L_t1_v_74:
    s_add_u32 s44, s44, 0x2000000
    s_lshl_b32 s39, s32, 13
    s_add_u32 s39, s39, 131072
    v_lshrrev_b32 v12, 4, v11
    v_and_b32 v13, 15, v11
    v_lshrrev_b32 v14, 2, v13
    v_lshl_add_u32 v14, v12, 2, v14
    v_and_b32 v13, 3, v11
    v_lshrrev_b32 v15, 1, v13
    v_xor_b32 v15, v15, v14
    v_lshlrev_b32 v15, 4, v15
    v_and_b32 v13, 1, v13
    v_lshl_add_u32 v15, v13, 3, v15
    v_lshl_add_u32 v15, v14, 8, v15
    v_add_u32 v15, s39, v15
    v_lshlrev_b32 v13, 4, v11
    s_waitcnt lgkmcnt(0)
    v_xor_b32 v16, 0, v15
    ds_read_b64_tr_b16 v[64:65], v16
    ds_read_b64_tr_b16 v[66:67], v16 offset:4096
    v_xor_b32 v17, 32, v15
    ds_read_b64_tr_b16 v[68:69], v17
    ds_read_b64_tr_b16 v[70:71], v17 offset:4096
    v_xor_b32 v16, 64, v15
    ds_read_b64_tr_b16 v[72:73], v16
    ds_read_b64_tr_b16 v[74:75], v16 offset:4096
    v_xor_b32 v17, 96, v15
    ds_read_b64_tr_b16 v[76:77], v17
    ds_read_b64_tr_b16 v[78:79], v17 offset:4096
    v_xor_b32 v16, 128, v15
    ds_read_b64_tr_b16 v[80:81], v16
    ds_read_b64_tr_b16 v[82:83], v16 offset:4096
    v_xor_b32 v17, 160, v15
    ds_read_b64_tr_b16 v[84:85], v17
    ds_read_b64_tr_b16 v[86:87], v17 offset:4096
    v_xor_b32 v16, 192, v15
    ds_read_b64_tr_b16 v[88:89], v16
    ds_read_b64_tr_b16 v[90:91], v16 offset:4096
    v_xor_b32 v17, 224, v15
    ds_read_b64_tr_b16 v[92:93], v17
    ds_read_b64_tr_b16 v[94:95], v17 offset:4096
    s_add_u32 s38, s44, 4096
    s_waitcnt lgkmcnt(14)
    buffer_store_dwordx4 v[64:67], v13, s[8:11], s44 offen offset:0 sc1
    s_waitcnt lgkmcnt(12)
    buffer_store_dwordx4 v[68:71], v13, s[8:11], s44 offen offset:1024 sc1
    s_waitcnt lgkmcnt(10)
    buffer_store_dwordx4 v[72:75], v13, s[8:11], s44 offen offset:2048 sc1
    s_waitcnt lgkmcnt(8)
    buffer_store_dwordx4 v[76:79], v13, s[8:11], s44 offen offset:3072 sc1
    s_waitcnt lgkmcnt(6)
    buffer_store_dwordx4 v[80:83], v13, s[8:11], s38 offen offset:0 sc1
    s_waitcnt lgkmcnt(4)
    buffer_store_dwordx4 v[84:87], v13, s[8:11], s38 offen offset:1024 sc1
    s_waitcnt lgkmcnt(2)
    buffer_store_dwordx4 v[88:91], v13, s[8:11], s38 offen offset:2048 sc1
    s_waitcnt lgkmcnt(0)
    buffer_store_dwordx4 v[92:95], v13, s[8:11], s38 offen offset:3072 sc1
L_t1_next_76:
    s_mov_b32 s53, 0
    s_cmp_lt_u32 s34, 64
    s_cselect_b32 s54, 1, 0x10000
    s_mov_b32 s12, s16
    s_mov_b32 s13, s17
    s_mov_b32 s14, s18
    s_mov_b32 s15, s19
    s_mov_b32 s36, s37
    s_mov_b32 s34, s35
    s_add_u32 s35, s35, s55
    s_lshr_b32 s38, s35, 5
    s_and_b32 s37, s35, 31
    s_lshl_b32 s37, s37, 8
    s_cmp_eq_u32 s38, 0
    s_cselect_b32 s16, s48, s50
    s_cselect_b32 s17, s49, s51
    s_cmp_eq_u32 s38, 2
    s_cselect_b32 s16, s46, s16
    s_cselect_b32 s17, s47, s17
    s_and_b32 s17, s17, 0xffff
    s_cmp_lt_u32 s35, 96
    s_cselect_b32 s18, 0x400000, 0
    s_mov_b32 s19, 0x20000
    s_cmp_lt_u32 s34, 96
    s_cbranch_scc1 L_t1_loop_73
    s_waitcnt vmcnt(0)
    s_barrier
    s_cmp_eq_u32 s54, 0
    s_cbranch_scc1 L_sig_85
    s_cmp_lg_u32 s32, 0
    s_cbranch_scc1 L_sig_85
    s_lshl_b32 s38, s33, 2
    s_add_u32 s38, s38, 128
    s_mov_b64 exec, 1
    v_mov_b32 v12, s38
    v_mov_b32 v13, s54
    global_atomic_add v12, v13, s[4:5]
    s_mov_b64 exec, -1
L_sig_85:
    s_mov_b32 s54, 0
    s_cmp_eq_u32 s82, 0
    s_cbranch_scc1 L_wk_reg_67
    v_mbcnt_lo_u32_b32 v1, -1, 0
    v_mbcnt_hi_u32_b32 v1, -1, v1
    s_mov_b32 s8, s6
    s_and_b32 s9, s7, 0xffff
    s_mov_b32 s10, 0x10000000
    s_mov_b32 s11, 0x20000
    s_mov_b32 s53, 9
    s_cmp_lt_u32 s84, 0
    s_cbranch_scc1 L_rnx_93
    s_cmp_ge_u32 s84, 128
    s_cbranch_scc1 L_rnx_93
    s_mov_b32 s53, 0
    s_sub_u32 s38, s84, 0
    s_mov_b32 s35, 0
    s_mov_b32 s34, s38
    s_cmp_lt_u32 s38, 32
    s_cbranch_scc1 L_rs_94
    s_mov_b32 s35, 1
    s_sub_u32 s34, s38, 32
L_rs_94:
    s_cmp_lt_u32 s38, 64
    s_cbranch_scc1 L_rs_95
    s_mov_b32 s35, 2
    s_sub_u32 s34, s38, 64
L_rs_95:
    s_cmp_lt_u32 s38, 96
    s_cbranch_scc1 L_rs_96
    s_mov_b32 s35, 3
    s_sub_u32 s34, s38, 96
L_rs_96:
L_rnx_93:
    s_cmp_lt_u32 s84, 128
    s_cbranch_scc1 L_rnx_97
    s_cmp_ge_u32 s84, 156
    s_cbranch_scc1 L_rnx_97
    s_mov_b32 s53, 1
    s_sub_u32 s38, s84, 128
    s_mov_b32 s35, 0
    s_mov_b32 s34, s38
    s_cmp_lt_u32 s38, 14
    s_cbranch_scc1 L_rs_98
    s_mov_b32 s35, 1
    s_sub_u32 s34, s38, 14
L_rs_98:
L_rnx_97:
    s_cmp_lt_u32 s84, 156
    s_cbranch_scc1 L_rnx_99
    s_cmp_ge_u32 s84, 188
    s_cbranch_scc1 L_rnx_99
    s_mov_b32 s53, 2
    s_sub_u32 s38, s84, 156
    s_mov_b32 s35, 0
    s_mov_b32 s34, s38
    s_cmp_lt_u32 s38, 16
    s_cbranch_scc1 L_rs_100
    s_mov_b32 s35, 1
    s_sub_u32 s34, s38, 16
L_rs_100:
L_rnx_99:
    s_cmp_lt_u32 s84, 188
    s_cbranch_scc1 L_rnx_101
    s_cmp_ge_u32 s84, 204
    s_cbranch_scc1 L_rnx_101
    s_mov_b32 s53, 3
    s_sub_u32 s38, s84, 188
    s_mov_b32 s35, 0
    s_mov_b32 s34, s38
    s_cmp_lt_u32 s38, 8
    s_cbranch_scc1 L_rs_102
    s_mov_b32 s35, 1
    s_sub_u32 s34, s38, 8
L_rs_102:
L_rnx_101:
    s_cmp_lt_u32 s84, 204
    s_cbranch_scc1 L_rnx_103
    s_cmp_ge_u32 s84, 220
    s_cbranch_scc1 L_rnx_103
    s_mov_b32 s53, 4
    s_sub_u32 s38, s84, 204
    s_mov_b32 s35, 0
    s_mov_b32 s34, s38
    s_cmp_lt_u32 s38, 8
    s_cbranch_scc1 L_rs_104
    s_mov_b32 s35, 1
    s_sub_u32 s34, s38, 8
L_rs_104:
L_rnx_103:
    s_cmp_lt_u32 s84, 220
    s_cbranch_scc1 L_rnx_105
    s_cmp_ge_u32 s84, 221
    s_cbranch_scc1 L_rnx_105
    s_mov_b32 s53, 5
    s_sub_u32 s38, s84, 220
    s_mov_b32 s35, 0
    s_mov_b32 s34, s38
L_rnx_105:
    s_cmp_eq_u32 s53, 9
    s_cbranch_scc1 L_noz_106
    s_cmp_eq_u32 s53, 5
    s_cbranch_scc1 L_relayz_107
    s_mov_b32 s38, 1
    s_cmp_eq_u32 s53, 1
    s_cselect_b32 s38, 7, s38
    s_cmp_eq_u32 s53, 2
    s_cselect_b32 s38, 9, s38
    s_cmp_eq_u32 s53, 3
    s_cselect_b32 s38, 5, s38
    s_cmp_eq_u32 s53, 4
    s_cselect_b32 s38, 11, s38
    s_add_u32 s42, s35, s38
    s_lshl_b32 s42, s42, 7
    s_lshl_b32 s38, s34, 2
    s_add_u32 s42, s42, s38
    s_add_u32 s42, s42, 0xa000000
    s_mov_b32 s38, 0
    s_cmp_lg_u32 s32, 0
    s_cbranch_scc1 L_sf_109
    s_mov_b64 exec, 1
    v_mov_b32 v2, 0
    v_mov_b32 v3, s38
    buffer_store_dword v3, v2, s[8:11], s42 offen sc1
    s_mov_b64 exec, -1
L_sf_109:
    s_branch L_noz_106
L_relayz_107:
    s_mov_b32 s42, 0xa000680
    s_mov_b32 s38, 0
    s_cmp_lg_u32 s32, 0
    s_cbranch_scc1 L_sf_110
    s_mov_b64 exec, 1
    v_mov_b32 v2, 0
    v_mov_b32 v3, s38
    buffer_store_dword v3, v2, s[8:11], s42 offen sc1
    s_mov_b64 exec, -1
L_sf_110:
    s_mov_b32 s42, 0xa000700
    s_mov_b32 s38, 0
    s_cmp_lg_u32 s32, 0
    s_cbranch_scc1 L_sf_111
    s_mov_b64 exec, 1
    v_mov_b32 v2, 0
    v_mov_b32 v3, s38
    buffer_store_dword v3, v2, s[8:11], s42 offen sc1
    s_mov_b64 exec, -1
L_sf_111:
    s_mov_b32 s42, 0xa000780
    s_mov_b32 s38, 0
    s_cmp_lg_u32 s32, 0
    s_cbranch_scc1 L_sf_112
    s_mov_b64 exec, 1
    v_mov_b32 v2, 0
    v_mov_b32 v3, s38
    buffer_store_dword v3, v2, s[8:11], s42 offen sc1
    s_mov_b64 exec, -1
L_sf_112:
    s_mov_b32 s42, 0xa000800
    s_mov_b32 s38, 0
    s_cmp_lg_u32 s32, 0
    s_cbranch_scc1 L_sf_113
    s_mov_b64 exec, 1
    v_mov_b32 v2, 0
    v_mov_b32 v3, s38
    buffer_store_dword v3, v2, s[8:11], s42 offen sc1
    s_mov_b64 exec, -1
L_sf_113:
L_noz_106:
    v_mov_b32 v4, -1
    v_mov_b32 v5, -1
    v_mov_b32 v6, -1
    v_mov_b32 v7, -1
    v_lshlrev_b32 v8, 4, v1
    s_lshl_b32 s46, s84, 2
    s_add_u32 s46, s46, s32
    s_mov_b32 s47, 0x70000000
    s_mov_b32 s48, s46
    s_cmp_lt_u32 s48, 512
    s_cbranch_scc0 L_fill_114
    s_lshl_b32 s47, s48, 10
    s_add_u32 s47, s47, 0x8f80000
    s_mov_b32 s48, 0x10000000
L_fill_114:
    s_sub_u32 s48, s48, 512
    s_cmp_lt_u32 s48, 64
    s_cbranch_scc0 L_fill_115
    s_lshl_b32 s47, s48, 10
    s_add_u32 s47, s47, 0x91f0000
    s_mov_b32 s48, 0x10000000
L_fill_115:
    s_sub_u32 s48, s48, 64
    s_cmp_lt_u32 s48, 64
    s_cbranch_scc0 L_fill_116
    s_lshl_b32 s47, s48, 10
    s_add_u32 s47, s47, 0x61f0000
    s_mov_b32 s48, 0x10000000
L_fill_116:
    s_sub_u32 s48, s48, 64
    s_cmp_lt_u32 s48, 224
    s_cbranch_scc0 L_fill_117
    s_lshl_b32 s47, s48, 10
    s_add_u32 s47, s47, 0x68c8000
    s_mov_b32 s48, 0x10000000
L_fill_117:
    s_sub_u32 s48, s48, 224
    s_cmp_lt_u32 s48, 256
    s_cbranch_scc0 L_fill_118
    s_lshl_b32 s47, s48, 10
    s_add_u32 s47, s47, 0x9bc0000
    s_mov_b32 s48, 0x10000000
L_fill_118:
    s_sub_u32 s48, s48, 256
    buffer_store_dwordx4 v[4:7], v8, s[8:11], s47 offen sc1
    s_add_u32 s46, s46, 896
    s_mov_b32 s47, 0x70000000
    s_mov_b32 s48, s46
    s_cmp_lt_u32 s48, 512
    s_cbranch_scc0 L_fill_119
    s_lshl_b32 s47, s48, 10
    s_add_u32 s47, s47, 0x8f80000
    s_mov_b32 s48, 0x10000000
L_fill_119:
    s_sub_u32 s48, s48, 512
    s_cmp_lt_u32 s48, 64
    s_cbranch_scc0 L_fill_120
    s_lshl_b32 s47, s48, 10
    s_add_u32 s47, s47, 0x91f0000
    s_mov_b32 s48, 0x10000000
L_fill_120:
    s_sub_u32 s48, s48, 64
    s_cmp_lt_u32 s48, 64
    s_cbranch_scc0 L_fill_121
    s_lshl_b32 s47, s48, 10
    s_add_u32 s47, s47, 0x61f0000
    s_mov_b32 s48, 0x10000000
L_fill_121:
    s_sub_u32 s48, s48, 64
    s_cmp_lt_u32 s48, 224
    s_cbranch_scc0 L_fill_122
    s_lshl_b32 s47, s48, 10
    s_add_u32 s47, s47, 0x68c8000
    s_mov_b32 s48, 0x10000000
L_fill_122:
    s_sub_u32 s48, s48, 224
    s_cmp_lt_u32 s48, 256
    s_cbranch_scc0 L_fill_123
    s_lshl_b32 s47, s48, 10
    s_add_u32 s47, s47, 0x9bc0000
    s_mov_b32 s48, 0x10000000
L_fill_123:
    s_sub_u32 s48, s48, 256
    buffer_store_dwordx4 v[4:7], v8, s[8:11], s47 offen sc1
    s_add_u32 s46, s46, 896
    s_waitcnt vmcnt(0)
    s_barrier
    s_cmp_lg_u32 s32, 0
    s_cbranch_scc1 L_ini_124
    s_mov_b64 exec, 1
    v_mov_b32 v2, 4
    v_mov_b32 v3, 1
    global_atomic_add v2, v3, s[4:5]
    s_mov_b64 exec, -1
L_ini_124:
    s_cmp_eq_u32 s53, 9
    s_cbranch_scc1 L_end_1
    s_mov_b32 s43, 0
    s_mov_b32 s38, 4
    s_cmp_lg_u32 s32, 0
    s_cbranch_scc1 L_wc_ok_126
L_wc_125:
    v_mov_b32 v2, s38
    global_load_dword v3, v2, s[4:5] sc1
    s_waitcnt vmcnt(0)
    s_nop 0
    v_readfirstlane_b32 s41, v3
    s_nop 3
    s_lshr_b32 s41, s41, 0
    s_and_b32 s41, s41, 0xffff
    s_cmp_ge_u32 s41, 256
    s_cbranch_scc1 L_wc_ok_126
    s_add_u32 s43, s43, 1
    s_cmp_lt_u32 s43, 0x100000
    s_cbranch_scc0 L_wc_ok_126
    s_sleep 32
    s_branch L_wc_125
L_wc_ok_126:
    s_barrier
    s_cmp_eq_u32 s53, 0
    s_cbranch_scc1 L_role_a1_86
    s_cmp_eq_u32 s53, 1
    s_cbranch_scc1 L_role_f1_87
    s_cmp_eq_u32 s53, 2
    s_cbranch_scc1 L_role_f2_88
    s_cmp_eq_u32 s53, 3
    s_cbranch_scc1 L_role_r1_89
    s_cmp_eq_u32 s53, 4
    s_cbranch_scc1 L_role_r2_90
    s_cmp_eq_u32 s53, 5
    s_cbranch_scc1 L_role_rl_91
L_role_a1_86:
    s_mov_b32 s33, s35
    s_mov_b32 s36, 4
    s_mov_b32 s43, 0
    s_add_u32 s42, s35, 1
    s_lshl_b32 s42, s42, 7
    s_lshl_b32 s38, s34, 2
    s_add_u32 s42, s42, s38
    s_add_u32 s42, s42, 0xa000000
    s_load_dwordx2 s[22:23], s[0:1], 40
    s_waitcnt lgkmcnt(0)
    s_mov_b32 s12, s22
    s_and_b32 s13, s23, 0xffff
    s_mov_b32 s14, 0x400000
    s_mov_b32 s15, 0x20000
    v_lshrrev_b32 v2, 4, v1
    v_and_b32 v3, 15, v1
    v_lshrrev_b32 v3, 2, v3
    v_and_b32 v4, 3, v1
    v_lshrrev_b32 v5, 1, v2
    v_lshlrev_b32 v5, 3, v5
    v_add_u32 v5, v5, v3
    v_lshlrev_b32 v5, 8, v5
    v_and_b32 v6, 1, v2
    v_lshlrev_b32 v6, 1, v6
    v_lshrrev_b32 v7, 1, v4
    v_add_u32 v6, v6, v7
    v_and_b32 v7, 1, v4
    v_lshl_add_u32 v5, v7, 3, v5
    v_lshl_add_u32 v5, v6, 4, v5
    v_xor_b32 v6, s32, v3
    v_lshl_add_u32 v8, v6, 6, v5
    v_add_u32 v9, 0x10000, v8
    v_and_b32 v2, 31, v1
    v_and_b32 v3, 15, v1
    v_lshrrev_b32 v4, 5, v1
    v_xor_b32 v3, v3, v4
    v_lshlrev_b32 v3, 4, v3
    v_lshl_add_u32 v3, v2, 8, v3
    v_add_u32 v10, 131072, v3
    v_add_u32 v11, 139264, v3
    v_add_u32 v12, 147456, v3
    v_add_u32 v13, 155648, v3
    v_lshlrev_b32 v14, 4, v1
    s_lshl_b32 s44, s32, 13
    s_add_u32 s44, s44, 131072
    s_lshr_b32 s47, s34, 2
    s_and_b32 s48, s34, 3
    s_lshl_b32 s49, s47, 19
    s_lshl_b32 s38, s48, 8
    s_add_u32 s38, s38, s49
    s_mov_b32 s46, 4
    v_lshrrev_b32 v4, 4, v1
    v_and_b32 v5, 15, v1
    v_lshlrev_b32 v6, 2, v4
    v_xor_b32 v5, v5, v6
    v_lshlrev_b32 v5, 4, v5
    v_mul_u32_u24 v4, 1024, v4
    v_add_u32 v4, v4, v5
    s_mul_i32 s39, s32, 32768
    s_add_u32 s38, s38, s39
    s_lshl_b32 s39, s32, 13
    s_mov_b32 s40, 0
L_res_127:
    s_mov_b32 s41, 0
L_resi_128:
    s_mov_b32 m0, s39
    s_add_u32 s41, s41, 1
    buffer_load_dwordx4 v4, s[12:15], s38 offen lds
    s_add_u32 s38, s38, 4096
    s_add_u32 s39, s39, 1024
    s_cmp_lt_u32 s41, 8
    s_cbranch_scc1 L_resi_128
    s_add_u32 s38, s38, 98304
    s_add_u32 s39, s39, 24576
    s_add_u32 s40, s40, 1
    s_cmp_lt_u32 s40, s46
    s_cbranch_scc1 L_res_127
    s_waitcnt vmcnt(0)
    s_barrier
    s_lshl_b32 s50, s47, 2
    s_add_u32 s50, s50, s32
    v_and_b32 v15, 15, v1
    v_lshrrev_b32 v16, 4, v1
    v_and_b32 v2, 1, v15
    v_mov_b32 v3, 0x3f80
    v_mov_b32 v4, 0x3f800000
    v_cmp_eq_u32 vcc, 1, v2
    s_nop 1
    v_cndmask_b32 v20, v3, v4, vcc
    v_mov_b32 v21, v20
    v_mov_b32 v22, v20
    v_mov_b32 v23, v20
    v_xor_b32 v2, v16, v15
    v_lshlrev_b32 v2, 4, v2
    v_lshl_add_u32 v2, v15, 8, v2
    v_add_u32 v17, s44, v2
    v_lshlrev_b32 v2, 5, v15
    v_lshrrev_b32 v3, 3, v15
    v_lshlrev_b32 v3, 7, v3
    v_xor_b32 v2, v2, v3
    v_lshl_add_u32 v2, v16, 3, v2
    v_add_u32 v18, s44, v2
    v_lshlrev_b32 v2, 8, v16
    v_lshrrev_b32 v3, 2, v15
    v_lshl_add_u32 v2, v3, 5, v2
    v_and_b32 v3, 3, v15
    v_lshl_add_u32 v2, v3, 3, v2
    v_and_b32 v3, 1, v16
    v_lshl_add_u32 v2, v3, 7, v2
    v_add_u32 v19, s44, v2
    v_xor_b32 v24, 128, v19
    v_lshrrev_b32 v2, 1, v16
    v_xor_b32 v2, v2, v15
    v_lshlrev_b32 v2, 4, v2
    v_and_b32 v3, 1, v16
    v_lshl_add_u32 v2, v3, 3, v2
    v_lshl_add_u32 v2, v15, 8, v2
    v_add_u32 v25, s44, v2
    s_mov_b32 s51, 0x3e0293ee
    v_mov_b32 v176, 0
    v_mov_b32 v177, 0
L_a1_top_129:
    s_cmp_ge_u32 s33, 64
    s_cbranch_scc1 L_a1_done_130
    s_lshr_b32 s38, s33, 2
    s_lshl_b32 s38, s38, 2
    s_add_u32 s38, s38, 128
    s_lshl_b32 s52, s33, 5
    s_add_u32 s52, s52, s50
    s_lshl_b32 s52, s52, 13
    s_add_u32 s38, s52, 0x2000000
    buffer_load_dwordx4 v[128:131], v14, s[8:11], s38 offen offset:0 sc1
    buffer_load_dwordx4 v[132:135], v14, s[8:11], s38 offen offset:1024 sc1
    buffer_load_dwordx4 v[136:139], v14, s[8:11], s38 offen offset:2048 sc1
    buffer_load_dwordx4 v[140:143], v14, s[8:11], s38 offen offset:3072 sc1
    s_add_u32 s38, s38, 4096
    buffer_load_dwordx4 v[144:147], v14, s[8:11], s38 offen offset:0 sc1
    buffer_load_dwordx4 v[148:151], v14, s[8:11], s38 offen offset:1024 sc1
    buffer_load_dwordx4 v[152:155], v14, s[8:11], s38 offen offset:2048 sc1
    buffer_load_dwordx4 v[156:159], v14, s[8:11], s38 offen offset:3072 sc1
    s_add_u32 s38, s52, 0x1000000
    s_add_u32 s39, s44, 0
    s_mov_b32 m0, s39
    s_nop 0
    buffer_load_dwordx4 v14, s[8:11], s38 offen offset:0 sc1 lds
    buffer_load_dwordx4 v14, s[8:11], s38 offen offset:1024 sc1 lds
    buffer_load_dwordx4 v14, s[8:11], s38 offen offset:2048 sc1 lds
    buffer_load_dwordx4 v14, s[8:11], s38 offen offset:3072 sc1 lds
    s_add_u32 s38, s38, 4096
    s_add_u32 s39, s44, 4096
    s_mov_b32 m0, s39
    s_nop 0
    buffer_load_dwordx4 v14, s[8:11], s38 offen offset:0 sc1 lds
    buffer_load_dwordx4 v14, s[8:11], s38 offen offset:1024 sc1 lds
    buffer_load_dwordx4 v14, s[8:11], s38 offen offset:2048 sc1 lds
    buffer_load_dwordx4 v14, s[8:11], s38 offen offset:3072 sc1 lds
    s_waitcnt vmcnt(0)
    v_xor_b32 v2, 0, v17
    ds_read_b128 v[96:99], v2 offset:0
    ds_read_b128 v[112:115], v2 offset:4096
    v_xor_b32 v2, 64, v17
    ds_read_b128 v[100:103], v2 offset:0
    ds_read_b128 v[116:119], v2 offset:4096
    v_xor_b32 v2, 128, v17
    ds_read_b128 v[104:107], v2 offset:0
    ds_read_b128 v[120:123], v2 offset:4096
    v_xor_b32 v2, 192, v17
    ds_read_b128 v[108:111], v2 offset:0
    ds_read_b128 v[124:127], v2 offset:4096
    s_waitcnt lgkmcnt(0)
    s_add_u32 s38, s52, 0x0
    s_add_u32 s39, s44, 0
    s_mov_b32 m0, s39
    s_nop 0
    buffer_load_dwordx4 v14, s[8:11], s38 offen offset:0 sc1 lds
    buffer_load_dwordx4 v14, s[8:11], s38 offen offset:1024 sc1 lds
    buffer_load_dwordx4 v14, s[8:11], s38 offen offset:2048 sc1 lds
    buffer_load_dwordx4 v14, s[8:11], s38 offen offset:3072 sc1 lds
    s_add_u32 s38, s38, 4096
    s_add_u32 s39, s44, 4096
    s_mov_b32 m0, s39
    s_nop 0
    buffer_load_dwordx4 v14, s[8:11], s38 offen offset:0 sc1 lds
    buffer_load_dwordx4 v14, s[8:11], s38 offen offset:1024 sc1 lds
    buffer_load_dwordx4 v14, s[8:11], s38 offen offset:2048 sc1 lds
    buffer_load_dwordx4 v14, s[8:11], s38 offen offset:3072 sc1 lds
    s_waitcnt vmcnt(0)
    v_xor_b32 v2, 0, v17
    ds_read_b128 v[64:67], v2 offset:0
    ds_read_b128 v[80:83], v2 offset:4096
    v_xor_b32 v2, 64, v17
    ds_read_b128 v[68:71], v2 offset:0
    ds_read_b128 v[84:87], v2 offset:4096
    v_xor_b32 v2, 128, v17
    ds_read_b128 v[72:75], v2 offset:0
    ds_read_b128 v[88:91], v2 offset:4096
    v_xor_b32 v2, 192, v17
    ds_read_b128 v[76:79], v2 offset:0
    ds_read_b128 v[92:95], v2 offset:4096
    s_waitcnt lgkmcnt(0)
    s_add_u32 s38, s35, 13
    s_lshl_b32 s38, s38, 7
    s_add_u32 s38, s38, 0xa000000
    s_add_u32 s39, s33, 1
    s_cmp_eq_u32 s33, 63
    s_cbranch_scc1 L_a1_63_131
    s_cmp_lg_u32 s32, 0
    s_cbranch_scc1 L_wf_ok_134
    v_min_u32 v2, 0, v1
    v_lshlrev_b32 v2, 2, v2
L_wf_133:
    buffer_load_dword v3, v2, s[8:11], s38 offen sc1
    s_waitcnt vmcnt(0)
    v_cmp_gt_u32 vcc, s39, v3
    s_cbranch_vccz L_wf_ok_134
    s_add_u32 s43, s43, 1
    s_cmp_lt_u32 s43, 0x100000
    s_cbranch_scc0 L_wf_ok_134
    s_cmp_ge_u32 s33, 62
    s_cbranch_scc1 L_wf_133
    s_sleep 8
    s_branch L_wf_133
L_wf_ok_134:
    s_barrier
    s_branch L_a1_j_132
L_a1_63_131:
    s_lshl_b32 s38, s47, 4
    s_add_u32 s38, s38, 0xa000a00
    s_mov_b32 s39, 1
    s_cmp_lg_u32 s32, 0
    s_cbranch_scc1 L_wf_ok_136
    v_min_u32 v2, 3, v1
    v_lshlrev_b32 v2, 2, v2
L_wf_135:
    buffer_load_dword v3, v2, s[8:11], s38 offen sc1
    s_waitcnt vmcnt(0)
    v_cmp_gt_u32 vcc, s39, v3
    s_cbranch_vccz L_wf_ok_136
    s_add_u32 s43, s43, 1
    s_cmp_lt_u32 s43, 0x100000
    s_cbranch_scc0 L_wf_ok_136
    s_cmp_ge_u32 s33, 62
    s_cbranch_scc1 L_wf_135
    s_sleep 8
    s_branch L_wf_135
L_wf_ok_136:
    s_barrier
L_a1_j_132:
    s_add_u32 s38, s52, 0x3000000
    buffer_load_dwordx4 v[160:163], v14, s[8:11], s38 offen offset:0 sc1
    buffer_load_dwordx4 v[164:167], v14, s[8:11], s38 offen offset:2048 sc1
    s_add_u32 s38, s38, 4096
    buffer_load_dwordx4 v[168:171], v14, s[8:11], s38 offen offset:0 sc1
    buffer_load_dwordx4 v[172:175], v14, s[8:11], s38 offen offset:2048 sc1
    s_waitcnt vmcnt(0)
    ds_write_b32 v18, v161 offset:0
    ds_write_b32 v18, v163 offset:512
    ds_write_b32 v18, v165 offset:1024
    ds_write_b32 v18, v167 offset:1536
    ds_write_b32 v18, v169 offset:2048
    ds_write_b32 v18, v171 offset:2560
    ds_write_b32 v18, v173 offset:3072
    ds_write_b32 v18, v175 offset:3584
    s_waitcnt lgkmcnt(0)
    ds_read_b64_tr_b16 v[180:181], v19 offset:0
    ds_read_b64_tr_b16 v[182:183], v24 offset:0
    ds_read_b64_tr_b16 v[184:185], v19 offset:1024
    ds_read_b64_tr_b16 v[186:187], v24 offset:1024
    ds_read_b64_tr_b16 v[188:189], v19 offset:2048
    ds_read_b64_tr_b16 v[190:191], v24 offset:2048
    ds_read_b64_tr_b16 v[192:193], v19 offset:3072
    ds_read_b64_tr_b16 v[194:195], v24 offset:3072
    v_mfma_f32_16x16x32_bf16 v[200:203], v[96:99], v[64:67], 0
    v_mfma_f32_16x16x32_bf16 v[200:203], v[100:103], v[68:71], v[200:203]
    v_mfma_f32_16x16x32_bf16 v[200:203], v[104:107], v[72:75], v[200:203]
    v_mfma_f32_16x16x32_bf16 v[200:203], v[108:111], v[76:79], v[200:203]
    v_mfma_f32_16x16x32_bf16 v[212:215], v[96:99], v[80:83], 0
    v_mfma_f32_16x16x32_bf16 v[212:215], v[100:103], v[84:87], v[212:215]
    v_mfma_f32_16x16x32_bf16 v[212:215], v[104:107], v[88:91], v[212:215]
    v_mfma_f32_16x16x32_bf16 v[212:215], v[108:111], v[92:95], v[212:215]
    v_mfma_f32_16x16x32_bf16 v[216:219], v[112:115], v[80:83], 0
    v_mfma_f32_16x16x32_bf16 v[216:219], v[116:119], v[84:87], v[216:219]
    v_mfma_f32_16x16x32_bf16 v[216:219], v[120:123], v[88:91], v[216:219]
    v_mfma_f32_16x16x32_bf16 v[216:219], v[124:127], v[92:95], v[216:219]
    s_waitcnt lgkmcnt(0)
    v_mfma_f32_16x16x32_bf16 v[208:211], v[180:183], v[64:67], 0
    v_mfma_f32_16x16x32_bf16 v[208:211], v[184:187], v[68:71], v[208:211]
    v_mfma_f32_16x16x32_bf16 v[208:211], v[188:191], v[72:75], v[208:211]
    v_mfma_f32_16x16x32_bf16 v[208:211], v[192:195], v[76:79], v[208:211]
    v_mfma_f32_16x16x32_bf16 v[220:223], v[180:183], v[80:83], 0
    v_mfma_f32_16x16x32_bf16 v[220:223], v[184:187], v[84:87], v[220:223]
    v_mfma_f32_16x16x32_bf16 v[220:223], v[188:191], v[88:91], v[220:223]
    v_mfma_f32_16x16x32_bf16 v[220:223], v[192:195], v[92:95], v[220:223]
    v_lshlrev_b32 v5, 2, v16
    v_mov_b32 v7, 0xff800000
    s_nop 6
    v_add_u32 v6, 0, v5
    v_cmp_le_u32 vcc, v6, v15
    s_nop 1
    v_cndmask_b32 v200, v7, v200, vcc
    v_cndmask_b32 v216, v7, v216, vcc
    v_add_u32 v6, 1, v5
    v_cmp_le_u32 vcc, v6, v15
    s_nop 1
    v_cndmask_b32 v201, v7, v201, vcc
    v_cndmask_b32 v217, v7, v217, vcc
    v_add_u32 v6, 2, v5
    v_cmp_le_u32 vcc, v6, v15
    s_nop 1
    v_cndmask_b32 v202, v7, v202, vcc
    v_cndmask_b32 v218, v7, v218, vcc
    v_add_u32 v6, 3, v5
    v_cmp_le_u32 vcc, v6, v15
    s_nop 1
    v_cndmask_b32 v203, v7, v203, vcc
    v_cndmask_b32 v219, v7, v219, vcc
    v_max_f32 v5, v200, v201
    v_max_f32 v5, v5, v202
    v_max_f32 v5, v5, v203
    v_max_f32 v5, v5, v208
    v_max_f32 v5, v5, v209
    v_mov_b32 v6, v5
    s_nop 1
    v_permlane16_swap_b32 v5, v6
    s_nop 1
    v_max_f32 v5, v5, v6
    v_mov_b32 v6, v5
    s_nop 1
    v_permlane32_swap_b32 v5, v6
    s_nop 1
    v_max_f32 v5, v5, v6
    v_mul_f32 v5, s51, v5
    v_fma_f32 v200, v200, s51, -v5
    v_fma_f32 v201, v201, s51, -v5
    v_fma_f32 v202, v202, s51, -v5
    v_fma_f32 v203, v203, s51, -v5
    v_fma_f32 v208, v208, s51, -v5
    v_fma_f32 v209, v209, s51, -v5
    v_exp_f32 v200, v200
    v_exp_f32 v201, v201
    v_exp_f32 v202, v202
    v_exp_f32 v203, v203
    v_exp_f32 v208, v208
    v_exp_f32 v209, v209
    s_nop 0
    v_cvt_pk_bf16_f32 v32, v200, v201
    v_cvt_pk_bf16_f32 v33, v202, v203
    v_mov_b32 v34, 0
    v_mov_b32 v35, 0
    v_cvt_pk_bf16_f32 v36, v208, v209
    v_mov_b32 v37, 0
    v_mov_b32 v38, 0
    v_mov_b32 v39, 0
    v_max_f32 v5, v212, v213
    v_max_f32 v5, v5, v214
    v_max_f32 v5, v5, v215
    v_max_f32 v5, v5, v216
    v_max_f32 v5, v5, v217
    v_max_f32 v5, v5, v218
    v_max_f32 v5, v5, v219
    v_max_f32 v5, v5, v220
    v_max_f32 v5, v5, v221
    v_mov_b32 v6, v5
    s_nop 1
    v_permlane16_swap_b32 v5, v6
    s_nop 1
    v_max_f32 v5, v5, v6
    v_mov_b32 v6, v5
    s_nop 1
    v_permlane32_swap_b32 v5, v6
    s_nop 1
    v_max_f32 v5, v5, v6
    v_mul_f32 v5, s51, v5
    v_fma_f32 v212, v212, s51, -v5
    v_fma_f32 v213, v213, s51, -v5
    v_fma_f32 v214, v214, s51, -v5
    v_fma_f32 v215, v215, s51, -v5
    v_fma_f32 v216, v216, s51, -v5
    v_fma_f32 v217, v217, s51, -v5
    v_fma_f32 v218, v218, s51, -v5
    v_fma_f32 v219, v219, s51, -v5
    v_fma_f32 v220, v220, s51, -v5
    v_fma_f32 v221, v221, s51, -v5
    v_exp_f32 v212, v212
    v_exp_f32 v213, v213
    v_exp_f32 v214, v214
    v_exp_f32 v215, v215
    v_exp_f32 v216, v216
    v_exp_f32 v217, v217
    v_exp_f32 v218, v218
    v_exp_f32 v219, v219
    v_exp_f32 v220, v220
    v_exp_f32 v221, v221
    s_nop 0
    v_cvt_pk_bf16_f32 v40, v212, v213
    v_cvt_pk_bf16_f32 v41, v214, v215
    v_cvt_pk_bf16_f32 v42, v216, v217
    v_cvt_pk_bf16_f32 v43, v218, v219
    v_cvt_pk_bf16_f32 v44, v220, v221
    v_mov_b32 v45, 0
    v_mov_b32 v46, 0
    v_mov_b32 v47, 0
    s_nop 1
    v_mfma_f32_16x16x32_bf16 v[48:51], v[20:23], v[32:35], 0
    v_mfma_f32_16x16x32_bf16 v[64:67], v[128:131], v[32:35], 0
    v_mfma_f32_16x16x32_bf16 v[68:71], v[132:135], v[32:35], 0
    v_mfma_f32_16x16x32_bf16 v[72:75], v[136:139], v[32:35], 0
    v_mfma_f32_16x16x32_bf16 v[76:79], v[140:143], v[32:35], 0
    v_mfma_f32_16x16x32_bf16 v[80:83], v[144:147], v[32:35], 0
    v_mfma_f32_16x16x32_bf16 v[84:87], v[148:151], v[32:35], 0
    v_mfma_f32_16x16x32_bf16 v[88:91], v[152:155], v[32:35], 0
    v_mfma_f32_16x16x32_bf16 v[92:95], v[156:159], v[32:35], 0
    v_mfma_f32_16x16x32_bf16 v[48:51], v[20:23], v[36:39], v[48:51]
    v_mfma_f32_16x16x32_bf16 v[64:67], v[160:163], v[36:39], v[64:67]
    v_mfma_f32_16x16x32_bf16 v[68:71], v[162:165], v[36:39], v[68:71]
    v_mfma_f32_16x16x32_bf16 v[72:75], v[164:167], v[36:39], v[72:75]
    v_mfma_f32_16x16x32_bf16 v[76:79], v[166:169], v[36:39], v[76:79]
    v_mfma_f32_16x16x32_bf16 v[80:83], v[168:171], v[36:39], v[80:83]
    v_mfma_f32_16x16x32_bf16 v[84:87], v[170:173], v[36:39], v[84:87]
    v_mfma_f32_16x16x32_bf16 v[88:91], v[172:175], v[36:39], v[88:91]
    v_mfma_f32_16x16x32_bf16 v[92:95], v[174:177], v[36:39], v[92:95]
    v_mfma_f32_16x16x32_bf16 v[52:55], v[20:23], v[40:43], 0
    v_mfma_f32_16x16x32_bf16 v[96:99], v[128:131], v[40:43], 0
    v_mfma_f32_16x16x32_bf16 v[100:103], v[132:135], v[40:43], 0
    v_mfma_f32_16x16x32_bf16 v[104:107], v[136:139], v[40:43], 0
    v_mfma_f32_16x16x32_bf16 v[108:111], v[140:143], v[40:43], 0
    v_mfma_f32_16x16x32_bf16 v[112:115], v[144:147], v[40:43], 0
    v_mfma_f32_16x16x32_bf16 v[116:119], v[148:151], v[40:43], 0
    v_mfma_f32_16x16x32_bf16 v[120:123], v[152:155], v[40:43], 0
    v_mfma_f32_16x16x32_bf16 v[124:127], v[156:159], v[40:43], 0
    v_mfma_f32_16x16x32_bf16 v[52:55], v[20:23], v[44:47], v[52:55]
    v_mfma_f32_16x16x32_bf16 v[96:99], v[160:163], v[44:47], v[96:99]
    v_mfma_f32_16x16x32_bf16 v[100:103], v[162:165], v[44:47], v[100:103]
    v_mfma_f32_16x16x32_bf16 v[104:107], v[164:167], v[44:47], v[104:107]
    v_mfma_f32_16x16x32_bf16 v[108:111], v[166:169], v[44:47], v[108:111]
    v_mfma_f32_16x16x32_bf16 v[112:115], v[168:171], v[44:47], v[112:115]
    v_mfma_f32_16x16x32_bf16 v[116:119], v[170:173], v[44:47], v[116:119]
    v_mfma_f32_16x16x32_bf16 v[120:123], v[172:175], v[44:47], v[120:123]
    v_mfma_f32_16x16x32_bf16 v[124:127], v[174:177], v[44:47], v[124:127]
    s_nop 8
    v_add_f32 v48, v48, v49
    v_rcp_f32 v48, v48
    s_nop 0
    v_mul_f32 v64, v64, v48
    v_mul_f32 v65, v65, v48
    v_mul_f32 v66, v66, v48
    v_mul_f32 v67, v67, v48
    v_cvt_pk_bf16_f32 v64, v64, v65
    v_cvt_pk_bf16_f32 v65, v66, v67
    v_xor_b32 v5, 0, v25
    ds_write_b64 v5, v[64:65] offset:0
    v_mul_f32 v68, v68, v48
    v_mul_f32 v69, v69, v48
    v_mul_f32 v70, v70, v48
    v_mul_f32 v71, v71, v48
    v_cvt_pk_bf16_f32 v68, v68, v69
    v_cvt_pk_bf16_f32 v69, v70, v71
    v_xor_b32 v5, 32, v25
    ds_write_b64 v5, v[68:69] offset:0
    v_mul_f32 v72, v72, v48
    v_mul_f32 v73, v73, v48
    v_mul_f32 v74, v74, v48
    v_mul_f32 v75, v75, v48
    v_cvt_pk_bf16_f32 v72, v72, v73
    v_cvt_pk_bf16_f32 v73, v74, v75
    v_xor_b32 v5, 64, v25
    ds_write_b64 v5, v[72:73] offset:0
    v_mul_f32 v76, v76, v48
    v_mul_f32 v77, v77, v48
    v_mul_f32 v78, v78, v48
    v_mul_f32 v79, v79, v48
    v_cvt_pk_bf16_f32 v76, v76, v77
    v_cvt_pk_bf16_f32 v77, v78, v79
    v_xor_b32 v5, 96, v25
    ds_write_b64 v5, v[76:77] offset:0
    v_mul_f32 v80, v80, v48
    v_mul_f32 v81, v81, v48
    v_mul_f32 v82, v82, v48
    v_mul_f32 v83, v83, v48
    v_cvt_pk_bf16_f32 v80, v80, v81
    v_cvt_pk_bf16_f32 v81, v82, v83
    v_xor_b32 v5, 128, v25
    ds_write_b64 v5, v[80:81] offset:0
    v_mul_f32 v84, v84, v48
    v_mul_f32 v85, v85, v48
    v_mul_f32 v86, v86, v48
    v_mul_f32 v87, v87, v48
    v_cvt_pk_bf16_f32 v84, v84, v85
    v_cvt_pk_bf16_f32 v85, v86, v87
    v_xor_b32 v5, 160, v25
    ds_write_b64 v5, v[84:85] offset:0
    v_mul_f32 v88, v88, v48
    v_mul_f32 v89, v89, v48
    v_mul_f32 v90, v90, v48
    v_mul_f32 v91, v91, v48
    v_cvt_pk_bf16_f32 v88, v88, v89
    v_cvt_pk_bf16_f32 v89, v90, v91
    v_xor_b32 v5, 192, v25
    ds_write_b64 v5, v[88:89] offset:0
    v_mul_f32 v92, v92, v48
    v_mul_f32 v93, v93, v48
    v_mul_f32 v94, v94, v48
    v_mul_f32 v95, v95, v48
    v_cvt_pk_bf16_f32 v92, v92, v93
    v_cvt_pk_bf16_f32 v93, v94, v95
    v_xor_b32 v5, 224, v25
    ds_write_b64 v5, v[92:93] offset:0
    v_add_f32 v52, v52, v53
    v_rcp_f32 v52, v52
    s_nop 0
    v_mul_f32 v96, v96, v52
    v_mul_f32 v97, v97, v52
    v_mul_f32 v98, v98, v52
    v_mul_f32 v99, v99, v52
    v_cvt_pk_bf16_f32 v96, v96, v97
    v_cvt_pk_bf16_f32 v97, v98, v99
    v_xor_b32 v5, 0, v25
    ds_write_b64 v5, v[96:97] offset:4096
    v_mul_f32 v100, v100, v52
    v_mul_f32 v101, v101, v52
    v_mul_f32 v102, v102, v52
    v_mul_f32 v103, v103, v52
    v_cvt_pk_bf16_f32 v100, v100, v101
    v_cvt_pk_bf16_f32 v101, v102, v103
    v_xor_b32 v5, 32, v25
    ds_write_b64 v5, v[100:101] offset:4096
    v_mul_f32 v104, v104, v52
    v_mul_f32 v105, v105, v52
    v_mul_f32 v106, v106, v52
    v_mul_f32 v107, v107, v52
    v_cvt_pk_bf16_f32 v104, v104, v105
    v_cvt_pk_bf16_f32 v105, v106, v107
    v_xor_b32 v5, 64, v25
    ds_write_b64 v5, v[104:105] offset:4096
    v_mul_f32 v108, v108, v52
    v_mul_f32 v109, v109, v52
    v_mul_f32 v110, v110, v52
    v_mul_f32 v111, v111, v52
    v_cvt_pk_bf16_f32 v108, v108, v109
    v_cvt_pk_bf16_f32 v109, v110, v111
    v_xor_b32 v5, 96, v25
    ds_write_b64 v5, v[108:109] offset:4096
    v_mul_f32 v112, v112, v52
    v_mul_f32 v113, v113, v52
    v_mul_f32 v114, v114, v52
    v_mul_f32 v115, v115, v52
    v_cvt_pk_bf16_f32 v112, v112, v113
    v_cvt_pk_bf16_f32 v113, v114, v115
    v_xor_b32 v5, 128, v25
    ds_write_b64 v5, v[112:113] offset:4096
    v_mul_f32 v116, v116, v52
    v_mul_f32 v117, v117, v52
    v_mul_f32 v118, v118, v52
    v_mul_f32 v119, v119, v52
    v_cvt_pk_bf16_f32 v116, v116, v117
    v_cvt_pk_bf16_f32 v117, v118, v119
    v_xor_b32 v5, 160, v25
    ds_write_b64 v5, v[116:117] offset:4096
    v_mul_f32 v120, v120, v52
    v_mul_f32 v121, v121, v52
    v_mul_f32 v122, v122, v52
    v_mul_f32 v123, v123, v52
    v_cvt_pk_bf16_f32 v120, v120, v121
    v_cvt_pk_bf16_f32 v121, v122, v123
    v_xor_b32 v5, 192, v25
    ds_write_b64 v5, v[120:121] offset:4096
    v_mul_f32 v124, v124, v52
    v_mul_f32 v125, v125, v52
    v_mul_f32 v126, v126, v52
    v_mul_f32 v127, v127, v52
    v_cvt_pk_bf16_f32 v124, v124, v125
    v_cvt_pk_bf16_f32 v125, v126, v127
    v_xor_b32 v5, 224, v25
    ds_write_b64 v5, v[124:125] offset:4096
    s_waitcnt lgkmcnt(0)
    s_barrier
    v_xor_b32 v2, 0, v10
    ds_read_b128 v[48:51], v2
    ds_read_b64_tr_b16 v[64:65], v8 offset:0
    ds_read_b64_tr_b16 v[66:67], v8 offset:1024
    v_xor_b32 v3, 32, v10
    ds_read_b128 v[52:55], v3
    ds_read_b64_tr_b16 v[68:69], v8 offset:4096
    ds_read_b64_tr_b16 v[70:71], v8 offset:5120
    v_xor_b32 v2, 64, v10
    ds_read_b128 v[56:59], v2
    ds_read_b64_tr_b16 v[72:73], v8 offset:8192
    ds_read_b64_tr_b16 v[74:75], v8 offset:9216
    s_waitcnt lgkmcnt(6)
    v_mfma_f32_32x32x16_bf16 v[32:47], v[64:67], v[48:51], 0
    v_xor_b32 v3, 96, v10
    ds_read_b128 v[60:63], v3
    ds_read_b64_tr_b16 v[76:77], v8 offset:12288
    ds_read_b64_tr_b16 v[78:79], v8 offset:13312
    s_waitcnt lgkmcnt(6)
    v_mfma_f32_32x32x16_bf16 v[32:47], v[68:71], v[52:55], v[32:47]
    v_xor_b32 v2, 128, v10
    ds_read_b128 v[48:51], v2
    ds_read_b64_tr_b16 v[64:65], v8 offset:16384
    ds_read_b64_tr_b16 v[66:67], v8 offset:17408
    s_waitcnt lgkmcnt(6)
    v_mfma_f32_32x32x16_bf16 v[32:47], v[72:75], v[56:59], v[32:47]
    v_xor_b32 v3, 160, v10
    ds_read_b128 v[52:55], v3
    ds_read_b64_tr_b16 v[68:69], v8 offset:20480
    ds_read_b64_tr_b16 v[70:71], v8 offset:21504
    s_waitcnt lgkmcnt(6)
    v_mfma_f32_32x32x16_bf16 v[32:47], v[76:79], v[60:63], v[32:47]
    v_xor_b32 v2, 192, v10
    ds_read_b128 v[56:59], v2
    ds_read_b64_tr_b16 v[72:73], v8 offset:24576
    ds_read_b64_tr_b16 v[74:75], v8 offset:25600
    s_waitcnt lgkmcnt(6)
    v_mfma_f32_32x32x16_bf16 v[32:47], v[64:67], v[48:51], v[32:47]
    v_xor_b32 v3, 224, v10
    ds_read_b128 v[60:63], v3
    ds_read_b64_tr_b16 v[76:77], v8 offset:28672
    ds_read_b64_tr_b16 v[78:79], v8 offset:29696
    s_waitcnt lgkmcnt(6)
    v_mfma_f32_32x32x16_bf16 v[32:47], v[68:71], v[52:55], v[32:47]
    v_xor_b32 v2, 0, v11
    ds_read_b128 v[48:51], v2
    ds_read_b64_tr_b16 v[64:65], v8 offset:32768
    ds_read_b64_tr_b16 v[66:67], v8 offset:33792
    s_waitcnt lgkmcnt(6)
    v_mfma_f32_32x32x16_bf16 v[32:47], v[72:75], v[56:59], v[32:47]
    v_xor_b32 v3, 32, v11
    ds_read_b128 v[52:55], v3
    ds_read_b64_tr_b16 v[68:69], v8 offset:36864
    ds_read_b64_tr_b16 v[70:71], v8 offset:37888
    s_waitcnt lgkmcnt(6)
    v_mfma_f32_32x32x16_bf16 v[32:47], v[76:79], v[60:63], v[32:47]
    v_xor_b32 v2, 64, v11
    ds_read_b128 v[56:59], v2
    ds_read_b64_tr_b16 v[72:73], v8 offset:40960
    ds_read_b64_tr_b16 v[74:75], v8 offset:41984
    s_waitcnt lgkmcnt(6)
    v_mfma_f32_32x32x16_bf16 v[32:47], v[64:67], v[48:51], v[32:47]
    v_xor_b32 v3, 96, v11
    ds_read_b128 v[60:63], v3
    ds_read_b64_tr_b16 v[76:77], v8 offset:45056
    ds_read_b64_tr_b16 v[78:79], v8 offset:46080
    s_waitcnt lgkmcnt(6)
    v_mfma_f32_32x32x16_bf16 v[32:47], v[68:71], v[52:55], v[32:47]
    v_xor_b32 v2, 128, v11
    ds_read_b128 v[48:51], v2
    ds_read_b64_tr_b16 v[64:65], v8 offset:49152
    ds_read_b64_tr_b16 v[66:67], v8 offset:50176
    s_waitcnt lgkmcnt(6)
    v_mfma_f32_32x32x16_bf16 v[32:47], v[72:75], v[56:59], v[32:47]
    v_xor_b32 v3, 160, v11
    ds_read_b128 v[52:55], v3
    ds_read_b64_tr_b16 v[68:69], v8 offset:53248
    ds_read_b64_tr_b16 v[70:71], v8 offset:54272
    s_waitcnt lgkmcnt(6)
    v_mfma_f32_32x32x16_bf16 v[32:47], v[76:79], v[60:63], v[32:47]
    v_xor_b32 v2, 192, v11
    ds_read_b128 v[56:59], v2
    ds_read_b64_tr_b16 v[72:73], v8 offset:57344
    ds_read_b64_tr_b16 v[74:75], v8 offset:58368
    s_waitcnt lgkmcnt(6)
    v_mfma_f32_32x32x16_bf16 v[32:47], v[64:67], v[48:51], v[32:47]
    v_xor_b32 v3, 224, v11
    ds_read_b128 v[60:63], v3
    ds_read_b64_tr_b16 v[76:77], v8 offset:61440
    ds_read_b64_tr_b16 v[78:79], v8 offset:62464
    s_waitcnt lgkmcnt(6)
    v_mfma_f32_32x32x16_bf16 v[32:47], v[68:71], v[52:55], v[32:47]
    v_xor_b32 v2, 0, v12
    ds_read_b128 v[48:51], v2
    ds_read_b64_tr_b16 v[64:65], v9 offset:0
    ds_read_b64_tr_b16 v[66:67], v9 offset:1024
    s_waitcnt lgkmcnt(6)
    v_mfma_f32_32x32x16_bf16 v[32:47], v[72:75], v[56:59], v[32:47]
    v_xor_b32 v3, 32, v12
    ds_read_b128 v[52:55], v3
    ds_read_b64_tr_b16 v[68:69], v9 offset:4096
    ds_read_b64_tr_b16 v[70:71], v9 offset:5120
    s_waitcnt lgkmcnt(6)
    v_mfma_f32_32x32x16_bf16 v[32:47], v[76:79], v[60:63], v[32:47]
    v_xor_b32 v2, 64, v12
    ds_read_b128 v[56:59], v2
    ds_read_b64_tr_b16 v[72:73], v9 offset:8192
    ds_read_b64_tr_b16 v[74:75], v9 offset:9216
    s_waitcnt lgkmcnt(6)
    v_mfma_f32_32x32x16_bf16 v[32:47], v[64:67], v[48:51], v[32:47]
    v_xor_b32 v3, 96, v12
    ds_read_b128 v[60:63], v3
    ds_read_b64_tr_b16 v[76:77], v9 offset:12288
    ds_read_b64_tr_b16 v[78:79], v9 offset:13312
    s_waitcnt lgkmcnt(6)
    v_mfma_f32_32x32x16_bf16 v[32:47], v[68:71], v[52:55], v[32:47]
    v_xor_b32 v2, 128, v12
    ds_read_b128 v[48:51], v2
    ds_read_b64_tr_b16 v[64:65], v9 offset:16384
    ds_read_b64_tr_b16 v[66:67], v9 offset:17408
    s_waitcnt lgkmcnt(6)
    v_mfma_f32_32x32x16_bf16 v[32:47], v[72:75], v[56:59], v[32:47]
    v_xor_b32 v3, 160, v12
    ds_read_b128 v[52:55], v3
    ds_read_b64_tr_b16 v[68:69], v9 offset:20480
    ds_read_b64_tr_b16 v[70:71], v9 offset:21504
    s_waitcnt lgkmcnt(6)
    v_mfma_f32_32x32x16_bf16 v[32:47], v[76:79], v[60:63], v[32:47]
    v_xor_b32 v2, 192, v12
    ds_read_b128 v[56:59], v2
    ds_read_b64_tr_b16 v[72:73], v9 offset:24576
    ds_read_b64_tr_b16 v[74:75], v9 offset:25600
    s_waitcnt lgkmcnt(6)
    v_mfma_f32_32x32x16_bf16 v[32:47], v[64:67], v[48:51], v[32:47]
    v_xor_b32 v3, 224, v12
    ds_read_b128 v[60:63], v3
    ds_read_b64_tr_b16 v[76:77], v9 offset:28672
    ds_read_b64_tr_b16 v[78:79], v9 offset:29696
    s_waitcnt lgkmcnt(6)
    v_mfma_f32_32x32x16_bf16 v[32:47], v[68:71], v[52:55], v[32:47]
    v_xor_b32 v2, 0, v13
    ds_read_b128 v[48:51], v2
    ds_read_b64_tr_b16 v[64:65], v9 offset:32768
    ds_read_b64_tr_b16 v[66:67], v9 offset:33792
    s_waitcnt lgkmcnt(6)
    v_mfma_f32_32x32x16_bf16 v[32:47], v[72:75], v[56:59], v[32:47]
    v_xor_b32 v3, 32, v13
    ds_read_b128 v[52:55], v3
    ds_read_b64_tr_b16 v[68:69], v9 offset:36864
    ds_read_b64_tr_b16 v[70:71], v9 offset:37888
    s_waitcnt lgkmcnt(6)
    v_mfma_f32_32x32x16_bf16 v[32:47], v[76:79], v[60:63], v[32:47]
    v_xor_b32 v2, 64, v13
    ds_read_b128 v[56:59], v2
    ds_read_b64_tr_b16 v[72:73], v9 offset:40960
    ds_read_b64_tr_b16 v[74:75], v9 offset:41984
    s_waitcnt lgkmcnt(6)
    v_mfma_f32_32x32x16_bf16 v[32:47], v[64:67], v[48:51], v[32:47]
    v_xor_b32 v3, 96, v13
    ds_read_b128 v[60:63], v3
    ds_read_b64_tr_b16 v[76:77], v9 offset:45056
    ds_read_b64_tr_b16 v[78:79], v9 offset:46080
    s_waitcnt lgkmcnt(6)
    v_mfma_f32_32x32x16_bf16 v[32:47], v[68:71], v[52:55], v[32:47]
    v_xor_b32 v2, 128, v13
    ds_read_b128 v[48:51], v2
    ds_read_b64_tr_b16 v[64:65], v9 offset:49152
    ds_read_b64_tr_b16 v[66:67], v9 offset:50176
    s_waitcnt lgkmcnt(6)
    v_mfma_f32_32x32x16_bf16 v[32:47], v[72:75], v[56:59], v[32:47]
    v_xor_b32 v3, 160, v13
    ds_read_b128 v[52:55], v3
    ds_read_b64_tr_b16 v[68:69], v9 offset:53248
    ds_read_b64_tr_b16 v[70:71], v9 offset:54272
    s_waitcnt lgkmcnt(6)
    v_mfma_f32_32x32x16_bf16 v[32:47], v[76:79], v[60:63], v[32:47]
    v_xor_b32 v2, 192, v13
    ds_read_b128 v[56:59], v2
    ds_read_b64_tr_b16 v[72:73], v9 offset:57344
    ds_read_b64_tr_b16 v[74:75], v9 offset:58368
    s_waitcnt lgkmcnt(6)
    v_mfma_f32_32x32x16_bf16 v[32:47], v[64:67], v[48:51], v[32:47]
    v_xor_b32 v3, 224, v13
    ds_read_b128 v[60:63], v3
    ds_read_b64_tr_b16 v[76:77], v9 offset:61440
    ds_read_b64_tr_b16 v[78:79], v9 offset:62464
    s_waitcnt lgkmcnt(6)
    v_mfma_f32_32x32x16_bf16 v[32:47], v[68:71], v[52:55], v[32:47]
    s_waitcnt lgkmcnt(3)
    v_mfma_f32_32x32x16_bf16 v[32:47], v[72:75], v[56:59], v[32:47]
    s_waitcnt lgkmcnt(0)
    v_mfma_f32_32x32x16_bf16 v[32:47], v[76:79], v[60:63], v[32:47]
    s_nop 11
    s_lshl_b32 s45, s33, 5
    s_add_u32 s45, s45, s34
    s_lshl_b32 s45, s45, 13
    s_add_u32 s45, s45, 0x8000000
    s_barrier
    v_cvt_pk_bf16_f32 v48, v32, v33
    v_cvt_pk_bf16_f32 v49, v34, v35
    v_cvt_pk_bf16_f32 v50, v36, v37
    v_cvt_pk_bf16_f32 v51, v38, v39
    s_nop 1
    v_permlane32_swap_b32 v48, v50
    v_permlane32_swap_b32 v49, v51
    s_lshl_b32 s38, s32, 2
    s_add_u32 s38, s38, 0
    s_lshl_b32 s38, s38, 4
    v_xor_b32 v2, s38, v10
    ds_write_b128 v2, v[48:51]
    v_cvt_pk_bf16_f32 v52, v40, v41
    v_cvt_pk_bf16_f32 v53, v42, v43
    v_cvt_pk_bf16_f32 v54, v44, v45
    v_cvt_pk_bf16_f32 v55, v46, v47
    s_nop 1
    v_permlane32_swap_b32 v52, v54
    v_permlane32_swap_b32 v53, v55
    s_lshl_b32 s38, s32, 2
    s_add_u32 s38, s38, 2
    s_lshl_b32 s38, s38, 4
    v_xor_b32 v2, s38, v10
    ds_write_b128 v2, v[52:55]
    s_waitcnt lgkmcnt(0)
    s_barrier
    s_lshl_b32 s38, s32, 11
    s_add_u32 s39, s38, 131072
    v_add_u32 v2, s39, v14
    ds_read_b128 v[48:51], v2
    ds_read_b128 v[52:55], v2 offset:1024
    s_add_u32 s38, s38, s45
    s_waitcnt lgkmcnt(1)
    buffer_store_dwordx4 v[48:51], v14, s[8:11], s38 offen sc1
    s_waitcnt lgkmcnt(0)
    buffer_store_dwordx4 v[52:55], v14, s[8:11], s38 offen offset:1024 sc1
    s_waitcnt vmcnt(0)
    s_barrier
    s_add_u32 s38, s33, 1
    s_cmp_lg_u32 s32, 0
    s_cbranch_scc1 L_sf_137
    s_mov_b64 exec, 1
    v_mov_b32 v2, 0
    v_mov_b32 v3, s38
    buffer_store_dword v3, v2, s[8:11], s42 offen sc1
    s_mov_b64 exec, -1
L_sf_137:
    s_add_u32 s33, s33, s36
    s_branch L_a1_top_129
L_a1_done_130:
    s_branch L_end_1
L_role_f1_87:
    s_mov_b32 s33, s35
    s_mov_b32 s36, 2
    s_mov_b32 s43, 0
    s_add_u32 s42, s35, 7
    s_lshl_b32 s42, s42, 7
    s_lshl_b32 s38, s34, 2
    s_add_u32 s42, s42, s38
    s_add_u32 s42, s42, 0xa000000
    s_load_dwordx2 s[22:23], s[0:1], 64
    s_waitcnt lgkmcnt(0)
    s_mov_b32 s12, s22
    s_and_b32 s13, s23, 0xffff
    s_mov_b32 s14, 0x1c0000
    s_mov_b32 s15, 0x20000
    v_lshrrev_b32 v2, 4, v1
    v_and_b32 v3, 15, v1
    v_lshrrev_b32 v3, 2, v3
    v_and_b32 v4, 3, v1
    v_lshrrev_b32 v5, 1, v2
    v_lshlrev_b32 v5, 3, v5
    v_add_u32 v5, v5, v3
    v_lshlrev_b32 v5, 8, v5
    v_and_b32 v6, 1, v2
    v_lshlrev_b32 v6, 1, v6
    v_lshrrev_b32 v7, 1, v4
    v_add_u32 v6, v6, v7
    v_and_b32 v7, 1, v4
    v_lshl_add_u32 v5, v7, 3, v5
    v_lshl_add_u32 v5, v6, 4, v5
    v_xor_b32 v6, s32, v3
    v_lshl_add_u32 v8, v6, 6, v5
    v_add_u32 v9, 0x10000, v8
    v_and_b32 v2, 31, v1
    v_and_b32 v3, 15, v1
    v_lshrrev_b32 v4, 5, v1
    v_xor_b32 v3, v3, v4
    v_lshlrev_b32 v3, 4, v3
    v_lshl_add_u32 v3, v2, 8, v3
    v_add_u32 v10, 131072, v3
    v_add_u32 v11, 139264, v3
    v_add_u32 v12, 147456, v3
    v_add_u32 v13, 155648, v3
    v_lshlrev_b32 v14, 4, v1
    s_lshl_b32 s44, s32, 13
    s_add_u32 s44, s44, 131072
    s_lshl_b32 s38, s34, 8
    s_mov_b32 s46, 4
    v_lshrrev_b32 v4, 4, v1
    v_and_b32 v5, 15, v1
    v_lshlrev_b32 v6, 2, v4
    v_xor_b32 v5, v5, v6
    v_lshlrev_b32 v5, 4, v5
    v_mul_u32_u24 v4, 3584, v4
    v_add_u32 v4, v4, v5
    s_mul_i32 s39, s32, 114688
    s_add_u32 s38, s38, s39
    s_lshl_b32 s39, s32, 13
    s_mov_b32 s40, 0
L_res_138:
    s_mov_b32 s41, 0
L_resi_139:
    s_mov_b32 m0, s39
    s_add_u32 s41, s41, 1
    buffer_load_dwordx4 v4, s[12:15], s38 offen lds
    s_add_u32 s38, s38, 14336
    s_add_u32 s39, s39, 1024
    s_cmp_lt_u32 s41, 8
    s_cbranch_scc1 L_resi_139
    s_add_u32 s38, s38, 344064
    s_add_u32 s39, s39, 24576
    s_add_u32 s40, s40, 1
    s_cmp_lt_u32 s40, s46
    s_cbranch_scc1 L_res_138
    s_waitcnt vmcnt(0)
    s_barrier
L_ff_top_140:
    s_cmp_ge_u32 s33, 64
    s_cbranch_scc1 L_ff_done_141
    s_cmp_ge_u32 s33, 62
    s_cbranch_scc1 L_ff_direct_142
    s_and_b32 s38, s33, 1
    s_add_u32 s38, s38, 5
    s_lshl_b32 s38, s38, 7
    s_add_u32 s38, s38, 0xa000000
    s_add_u32 s39, s33, 1
    s_cmp_lg_u32 s32, 0
    s_cbranch_scc1 L_wf_ok_145
    v_min_u32 v2, 7, v1
    v_lshlrev_b32 v2, 2, v2
L_wf_144:
    buffer_load_dword v3, v2, s[8:11], s38 offen sc1
    s_waitcnt vmcnt(0)
    v_cmp_gt_u32 vcc, s39, v3
    s_cbranch_vccz L_wf_ok_145
    s_add_u32 s43, s43, 1
    s_cmp_lt_u32 s43, 0x100000
    s_cbranch_scc0 L_wf_ok_145
    s_cmp_ge_u32 s33, 62
    s_cbranch_scc1 L_wf_144
    s_sleep 8
    s_branch L_wf_144
L_wf_ok_145:
    s_barrier
    s_lshl_b32 s38, s33, 2
    s_add_u32 s38, s38, s32
    s_lshl_b32 s38, s38, 13
    s_add_u32 s38, s38, 0x9000000
    s_add_u32 s39, s44, 0
    s_mov_b32 m0, s39
    s_nop 0
    buffer_load_dwordx4 v14, s[8:11], s38 offen offset:0 sc1 lds
    buffer_load_dwordx4 v14, s[8:11], s38 offen offset:1024 sc1 lds
    buffer_load_dwordx4 v14, s[8:11], s38 offen offset:2048 sc1 lds
    buffer_load_dwordx4 v14, s[8:11], s38 offen offset:3072 sc1 lds
    s_add_u32 s38, s38, 4096
    s_add_u32 s39, s44, 4096
    s_mov_b32 m0, s39
    s_nop 0
    buffer_load_dwordx4 v14, s[8:11], s38 offen offset:0 sc1 lds
    buffer_load_dwordx4 v14, s[8:11], s38 offen offset:1024 sc1 lds
    buffer_load_dwordx4 v14, s[8:11], s38 offen offset:2048 sc1 lds
    buffer_load_dwordx4 v14, s[8:11], s38 offen offset:3072 sc1 lds
L_ff_skip_146:
    s_waitcnt vmcnt(0)
    s_branch L_ff_staged_143
L_ff_direct_142:
    s_lshl_b32 s38, s33, 2
    s_add_u32 s38, s38, s32
    s_lshl_b32 s38, s38, 13
    s_add_u32 s38, s38, 0x9000000
    s_add_u32 s39, s38, 4096
L_ff_again_147:
    buffer_load_dwordx4 v[64:67], v14, s[8:11], s38 offen offset:0 sc1
    buffer_load_dwordx4 v[68:71], v14, s[8:11], s38 offen offset:1024 sc1
    buffer_load_dwordx4 v[72:75], v14, s[8:11], s38 offen offset:2048 sc1
    buffer_load_dwordx4 v[76:79], v14, s[8:11], s38 offen offset:3072 sc1
    buffer_load_dwordx4 v[80:83], v14, s[8:11], s39 offen offset:0 sc1
    buffer_load_dwordx4 v[84:87], v14, s[8:11], s39 offen offset:1024 sc1
    buffer_load_dwordx4 v[88:91], v14, s[8:11], s39 offen offset:2048 sc1
    buffer_load_dwordx4 v[92:95], v14, s[8:11], s39 offen offset:3072 sc1
    s_waitcnt vmcnt(0)
    v_max3_u32 v2, v64, v65, v66
    v_max3_u32 v2, v2, v67, v68
    v_max3_u32 v2, v2, v69, v70
    v_max3_u32 v2, v2, v71, v72
    v_max3_u32 v2, v2, v73, v74
    v_max3_u32 v2, v2, v75, v76
    v_max3_u32 v2, v2, v77, v78
    v_max3_u32 v2, v2, v79, v80
    v_max3_u32 v2, v2, v81, v82
    v_max3_u32 v2, v2, v83, v84
    v_max3_u32 v2, v2, v85, v86
    v_max3_u32 v2, v2, v87, v88
    v_max3_u32 v2, v2, v89, v90
    v_max3_u32 v2, v2, v91, v92
    v_max3_u32 v2, v2, v93, v94
    v_max_u32 v2, v2, v95
    v_cmp_eq_u32 vcc, -1, v2
    s_cbranch_vccz L_ff_have_148
    s_add_u32 s43, s43, 1
    s_cmp_lt_u32 s43, 0x100000
    s_cbranch_scc0 L_ff_have_148
    s_sleep 2
    s_branch L_ff_again_147
L_ff_have_148:
    v_add_u32 v2, s44, v14
    ds_write_b128 v2, v[64:67] offset:0
    ds_write_b128 v2, v[68:71] offset:1024
    ds_write_b128 v2, v[72:75] offset:2048
    ds_write_b128 v2, v[76:79] offset:3072
    ds_write_b128 v2, v[80:83] offset:4096
    ds_write_b128 v2, v[84:87] offset:5120
    ds_write_b128 v2, v[88:91] offset:6144
    ds_write_b128 v2, v[92:95] offset:7168
    s_waitcnt lgkmcnt(0)
L_ff_staged_143:
    s_barrier
    v_xor_b32 v2, 0, v10
    ds_read_b128 v[48:51], v2
    ds_read_b64_tr_b16 v[64:65], v8 offset:0
    ds_read_b64_tr_b16 v[66:67], v8 offset:1024
    v_xor_b32 v3, 32, v10
    ds_read_b128 v[52:55], v3
    ds_read_b64_tr_b16 v[68:69], v8 offset:4096
    ds_read_b64_tr_b16 v[70:71], v8 offset:5120
    v_xor_b32 v2, 64, v10
    ds_read_b128 v[56:59], v2
    ds_read_b64_tr_b16 v[72:73], v8 offset:8192
    ds_read_b64_tr_b16 v[74:75], v8 offset:9216
    s_waitcnt lgkmcnt(6)
    v_mfma_f32_32x32x16_bf16 v[32:47], v[64:67], v[48:51], 0
    v_xor_b32 v3, 96, v10
    ds_read_b128 v[60:63], v3
    ds_read_b64_tr_b16 v[76:77], v8 offset:12288
    ds_read_b64_tr_b16 v[78:79], v8 offset:13312
    s_waitcnt lgkmcnt(6)
    v_mfma_f32_32x32x16_bf16 v[32:47], v[68:71], v[52:55], v[32:47]
    v_xor_b32 v2, 128, v10
    ds_read_b128 v[48:51], v2
    ds_read_b64_tr_b16 v[64:65], v8 offset:16384
    ds_read_b64_tr_b16 v[66:67], v8 offset:17408
    s_waitcnt lgkmcnt(6)
    v_mfma_f32_32x32x16_bf16 v[32:47], v[72:75], v[56:59], v[32:47]
    v_xor_b32 v3, 160, v10
    ds_read_b128 v[52:55], v3
    ds_read_b64_tr_b16 v[68:69], v8 offset:20480
    ds_read_b64_tr_b16 v[70:71], v8 offset:21504
    s_waitcnt lgkmcnt(6)
    v_mfma_f32_32x32x16_bf16 v[32:47], v[76:79], v[60:63], v[32:47]
    v_xor_b32 v2, 192, v10
    ds_read_b128 v[56:59], v2
    ds_read_b64_tr_b16 v[72:73], v8 offset:24576
    ds_read_b64_tr_b16 v[74:75], v8 offset:25600
    s_waitcnt lgkmcnt(6)
    v_mfma_f32_32x32x16_bf16 v[32:47], v[64:67], v[48:51], v[32:47]
    v_xor_b32 v3, 224, v10
    ds_read_b128 v[60:63], v3
    ds_read_b64_tr_b16 v[76:77], v8 offset:28672
    ds_read_b64_tr_b16 v[78:79], v8 offset:29696
    s_waitcnt lgkmcnt(6)
    v_mfma_f32_32x32x16_bf16 v[32:47], v[68:71], v[52:55], v[32:47]
    v_xor_b32 v2, 0, v11
    ds_read_b128 v[48:51], v2
    ds_read_b64_tr_b16 v[64:65], v8 offset:32768
    ds_read_b64_tr_b16 v[66:67], v8 offset:33792
    s_waitcnt lgkmcnt(6)
    v_mfma_f32_32x32x16_bf16 v[32:47], v[72:75], v[56:59], v[32:47]
    v_xor_b32 v3, 32, v11
    ds_read_b128 v[52:55], v3
    ds_read_b64_tr_b16 v[68:69], v8 offset:36864
    ds_read_b64_tr_b16 v[70:71], v8 offset:37888
    s_waitcnt lgkmcnt(6)
    v_mfma_f32_32x32x16_bf16 v[32:47], v[76:79], v[60:63], v[32:47]
    v_xor_b32 v2, 64, v11
    ds_read_b128 v[56:59], v2
    ds_read_b64_tr_b16 v[72:73], v8 offset:40960
    ds_read_b64_tr_b16 v[74:75], v8 offset:41984
    s_waitcnt lgkmcnt(6)
    v_mfma_f32_32x32x16_bf16 v[32:47], v[64:67], v[48:51], v[32:47]
    v_xor_b32 v3, 96, v11
    ds_read_b128 v[60:63], v3
    ds_read_b64_tr_b16 v[76:77], v8 offset:45056
    ds_read_b64_tr_b16 v[78:79], v8 offset:46080
    s_waitcnt lgkmcnt(6)
    v_mfma_f32_32x32x16_bf16 v[32:47], v[68:71], v[52:55], v[32:47]
    v_xor_b32 v2, 128, v11
    ds_read_b128 v[48:51], v2
    ds_read_b64_tr_b16 v[64:65], v8 offset:49152
    ds_read_b64_tr_b16 v[66:67], v8 offset:50176
    s_waitcnt lgkmcnt(6)
    v_mfma_f32_32x32x16_bf16 v[32:47], v[72:75], v[56:59], v[32:47]
    v_xor_b32 v3, 160, v11
    ds_read_b128 v[52:55], v3
    ds_read_b64_tr_b16 v[68:69], v8 offset:53248
    ds_read_b64_tr_b16 v[70:71], v8 offset:54272
    s_waitcnt lgkmcnt(6)
    v_mfma_f32_32x32x16_bf16 v[32:47], v[76:79], v[60:63], v[32:47]
    v_xor_b32 v2, 192, v11
    ds_read_b128 v[56:59], v2
    ds_read_b64_tr_b16 v[72:73], v8 offset:57344
    ds_read_b64_tr_b16 v[74:75], v8 offset:58368
    s_waitcnt lgkmcnt(6)
    v_mfma_f32_32x32x16_bf16 v[32:47], v[64:67], v[48:51], v[32:47]
    v_xor_b32 v3, 224, v11
    ds_read_b128 v[60:63], v3
    ds_read_b64_tr_b16 v[76:77], v8 offset:61440
    ds_read_b64_tr_b16 v[78:79], v8 offset:62464
    s_waitcnt lgkmcnt(6)
    v_mfma_f32_32x32x16_bf16 v[32:47], v[68:71], v[52:55], v[32:47]
    v_xor_b32 v2, 0, v12
    ds_read_b128 v[48:51], v2
    ds_read_b64_tr_b16 v[64:65], v9 offset:0
    ds_read_b64_tr_b16 v[66:67], v9 offset:1024
    s_waitcnt lgkmcnt(6)
    v_mfma_f32_32x32x16_bf16 v[32:47], v[72:75], v[56:59], v[32:47]
    v_xor_b32 v3, 32, v12
    ds_read_b128 v[52:55], v3
    ds_read_b64_tr_b16 v[68:69], v9 offset:4096
    ds_read_b64_tr_b16 v[70:71], v9 offset:5120
    s_waitcnt lgkmcnt(6)
    v_mfma_f32_32x32x16_bf16 v[32:47], v[76:79], v[60:63], v[32:47]
    v_xor_b32 v2, 64, v12
    ds_read_b128 v[56:59], v2
    ds_read_b64_tr_b16 v[72:73], v9 offset:8192
    ds_read_b64_tr_b16 v[74:75], v9 offset:9216
    s_waitcnt lgkmcnt(6)
    v_mfma_f32_32x32x16_bf16 v[32:47], v[64:67], v[48:51], v[32:47]
    v_xor_b32 v3, 96, v12
    ds_read_b128 v[60:63], v3
    ds_read_b64_tr_b16 v[76:77], v9 offset:12288
    ds_read_b64_tr_b16 v[78:79], v9 offset:13312
    s_waitcnt lgkmcnt(6)
    v_mfma_f32_32x32x16_bf16 v[32:47], v[68:71], v[52:55], v[32:47]
    v_xor_b32 v2, 128, v12
    ds_read_b128 v[48:51], v2
    ds_read_b64_tr_b16 v[64:65], v9 offset:16384
    ds_read_b64_tr_b16 v[66:67], v9 offset:17408
    s_waitcnt lgkmcnt(6)
    v_mfma_f32_32x32x16_bf16 v[32:47], v[72:75], v[56:59], v[32:47]
    v_xor_b32 v3, 160, v12
    ds_read_b128 v[52:55], v3
    ds_read_b64_tr_b16 v[68:69], v9 offset:20480
    ds_read_b64_tr_b16 v[70:71], v9 offset:21504
    s_waitcnt lgkmcnt(6)
    v_mfma_f32_32x32x16_bf16 v[32:47], v[76:79], v[60:63], v[32:47]
    v_xor_b32 v2, 192, v12
    ds_read_b128 v[56:59], v2
    ds_read_b64_tr_b16 v[72:73], v9 offset:24576
    ds_read_b64_tr_b16 v[74:75], v9 offset:25600
    s_waitcnt lgkmcnt(6)
    v_mfma_f32_32x32x16_bf16 v[32:47], v[64:67], v[48:51], v[32:47]
    v_xor_b32 v3, 224, v12
    ds_read_b128 v[60:63], v3
    ds_read_b64_tr_b16 v[76:77], v9 offset:28672
    ds_read_b64_tr_b16 v[78:79], v9 offset:29696
    s_waitcnt lgkmcnt(6)
    v_mfma_f32_32x32x16_bf16 v[32:47], v[68:71], v[52:55], v[32:47]
    v_xor_b32 v2, 0, v13
    ds_read_b128 v[48:51], v2
    ds_read_b64_tr_b16 v[64:65], v9 offset:32768
    ds_read_b64_tr_b16 v[66:67], v9 offset:33792
    s_waitcnt lgkmcnt(6)
    v_mfma_f32_32x32x16_bf16 v[32:47], v[72:75], v[56:59], v[32:47]
    v_xor_b32 v3, 32, v13
    ds_read_b128 v[52:55], v3
    ds_read_b64_tr_b16 v[68:69], v9 offset:36864
    ds_read_b64_tr_b16 v[70:71], v9 offset:37888
    s_waitcnt lgkmcnt(6)
    v_mfma_f32_32x32x16_bf16 v[32:47], v[76:79], v[60:63], v[32:47]
    v_xor_b32 v2, 64, v13
    ds_read_b128 v[56:59], v2
    ds_read_b64_tr_b16 v[72:73], v9 offset:40960
    ds_read_b64_tr_b16 v[74:75], v9 offset:41984
    s_waitcnt lgkmcnt(6)
    v_mfma_f32_32x32x16_bf16 v[32:47], v[64:67], v[48:51], v[32:47]
    v_xor_b32 v3, 96, v13
    ds_read_b128 v[60:63], v3
    ds_read_b64_tr_b16 v[76:77], v9 offset:45056
    ds_read_b64_tr_b16 v[78:79], v9 offset:46080
    s_waitcnt lgkmcnt(6)
    v_mfma_f32_32x32x16_bf16 v[32:47], v[68:71], v[52:55], v[32:47]
    v_xor_b32 v2, 128, v13
    ds_read_b128 v[48:51], v2
    ds_read_b64_tr_b16 v[64:65], v9 offset:49152
    ds_read_b64_tr_b16 v[66:67], v9 offset:50176
    s_waitcnt lgkmcnt(6)
    v_mfma_f32_32x32x16_bf16 v[32:47], v[72:75], v[56:59], v[32:47]
    v_xor_b32 v3, 160, v13
    ds_read_b128 v[52:55], v3
    ds_read_b64_tr_b16 v[68:69], v9 offset:53248
    ds_read_b64_tr_b16 v[70:71], v9 offset:54272
    s_waitcnt lgkmcnt(6)
    v_mfma_f32_32x32x16_bf16 v[32:47], v[76:79], v[60:63], v[32:47]
    v_xor_b32 v2, 192, v13
    ds_read_b128 v[56:59], v2
    ds_read_b64_tr_b16 v[72:73], v9 offset:57344
    ds_read_b64_tr_b16 v[74:75], v9 offset:58368
    s_waitcnt lgkmcnt(6)
    v_mfma_f32_32x32x16_bf16 v[32:47], v[64:67], v[48:51], v[32:47]
    v_xor_b32 v3, 224, v13
    ds_read_b128 v[60:63], v3
    ds_read_b64_tr_b16 v[76:77], v9 offset:61440
    ds_read_b64_tr_b16 v[78:79], v9 offset:62464
    s_waitcnt lgkmcnt(6)
    v_mfma_f32_32x32x16_bf16 v[32:47], v[68:71], v[52:55], v[32:47]
    s_waitcnt lgkmcnt(3)
    v_mfma_f32_32x32x16_bf16 v[32:47], v[72:75], v[56:59], v[32:47]
    s_waitcnt lgkmcnt(0)
    v_mfma_f32_32x32x16_bf16 v[32:47], v[76:79], v[60:63], v[32:47]
    s_nop 11
    s_mul_i32 s45, s33, 14
    s_add_u32 s45, s45, s34
    s_lshl_b32 s45, s45, 13
    s_add_u32 s45, s45, 0x6200000
    s_barrier
    v_max_f32 v32, 0, v32
    v_max_f32 v33, 0, v33
    v_max_f32 v34, 0, v34
    v_max_f32 v35, 0, v35
    v_max_f32 v36, 0, v36
    v_max_f32 v37, 0, v37
    v_max_f32 v38, 0, v38
    v_max_f32 v39, 0, v39
    v_cvt_pk_bf16_f32 v48, v32, v33
    v_cvt_pk_bf16_f32 v49, v34, v35
    v_cvt_pk_bf16_f32 v50, v36, v37
    v_cvt_pk_bf16_f32 v51, v38, v39
    s_nop 1
    v_permlane32_swap_b32 v48, v50
    v_permlane32_swap_b32 v49, v51
    s_lshl_b32 s38, s32, 2
    s_add_u32 s38, s38, 0
    s_lshl_b32 s38, s38, 4
    v_xor_b32 v2, s38, v10
    ds_write_b128 v2, v[48:51]
    v_max_f32 v40, 0, v40
    v_max_f32 v41, 0, v41
    v_max_f32 v42, 0, v42
    v_max_f32 v43, 0, v43
    v_max_f32 v44, 0, v44
    v_max_f32 v45, 0, v45
    v_max_f32 v46, 0, v46
    v_max_f32 v47, 0, v47
    v_cvt_pk_bf16_f32 v52, v40, v41
    v_cvt_pk_bf16_f32 v53, v42, v43
    v_cvt_pk_bf16_f32 v54, v44, v45
    v_cvt_pk_bf16_f32 v55, v46, v47
    s_nop 1
    v_permlane32_swap_b32 v52, v54
    v_permlane32_swap_b32 v53, v55
    s_lshl_b32 s38, s32, 2
    s_add_u32 s38, s38, 2
    s_lshl_b32 s38, s38, 4
    v_xor_b32 v2, s38, v10
    ds_write_b128 v2, v[52:55]
    s_waitcnt lgkmcnt(0)
    s_barrier
    s_lshl_b32 s38, s32, 11
    s_add_u32 s39, s38, 131072
    v_add_u32 v2, s39, v14
    ds_read_b128 v[48:51], v2
    ds_read_b128 v[52:55], v2 offset:1024
    s_add_u32 s38, s38, s45
    s_waitcnt lgkmcnt(1)
    buffer_store_dwordx4 v[48:51], v14, s[8:11], s38 offen sc1
    s_waitcnt lgkmcnt(0)
    buffer_store_dwordx4 v[52:55], v14, s[8:11], s38 offen offset:1024 sc1
    s_waitcnt vmcnt(0)
    s_barrier
    s_add_u32 s38, s33, 1
    s_cmp_lg_u32 s32, 0
    s_cbranch_scc1 L_sf_149
    s_mov_b64 exec, 1
    v_mov_b32 v2, 0
    v_mov_b32 v3, s38
    buffer_store_dword v3, v2, s[8:11], s42 offen sc1
    s_mov_b64 exec, -1
L_sf_149:
    s_add_u32 s33, s33, s36
    s_branch L_ff_top_140
L_ff_done_141:
    s_branch L_end_1
L_role_f2_88:
    s_mov_b32 s33, s35
    s_mov_b32 s36, 2
    s_mov_b32 s43, 0
    s_add_u32 s42, s35, 9
    s_lshl_b32 s42, s42, 7
    s_lshl_b32 s38, s34, 2
    s_add_u32 s42, s42, s38
    s_add_u32 s42, s42, 0xa000000
    s_load_dwordx2 s[22:23], s[0:1], 72
    s_waitcnt lgkmcnt(0)
    s_mov_b32 s12, s22
    s_and_b32 s13, s23, 0xffff
    s_mov_b32 s14, 0x1c0000
    s_mov_b32 s15, 0x20000
    v_lshrrev_b32 v2, 4, v1
    v_and_b32 v3, 15, v1
    v_lshrrev_b32 v3, 2, v3
    v_and_b32 v4, 3, v1
    v_lshrrev_b32 v5, 1, v2
    v_lshlrev_b32 v5, 3, v5
    v_add_u32 v5, v5, v3
    v_lshlrev_b32 v5, 8, v5
    v_and_b32 v6, 1, v2
    v_lshlrev_b32 v6, 1, v6
    v_lshrrev_b32 v7, 1, v4
    v_add_u32 v6, v6, v7
    v_and_b32 v7, 1, v4
    v_lshl_add_u32 v5, v7, 3, v5
    v_lshl_add_u32 v5, v6, 4, v5
    v_xor_b32 v6, s32, v3
    v_lshl_add_u32 v8, v6, 6, v5
    v_add_u32 v9, 0x10000, v8
    v_and_b32 v2, 31, v1
    v_and_b32 v3, 15, v1
    v_lshrrev_b32 v4, 5, v1
    v_xor_b32 v3, v3, v4
    v_lshlrev_b32 v3, 4, v3
    v_lshl_add_u32 v3, v2, 8, v3
    v_add_u32 v10, 131072, v3
    v_add_u32 v11, 139264, v3
    v_add_u32 v12, 147456, v3
    v_add_u32 v13, 155648, v3
    v_lshlrev_b32 v14, 4, v1
    s_lshl_b32 s44, s32, 13
    s_add_u32 s44, s44, 131072
    s_lshr_b32 s47, s34, 2
    s_lshl_b32 s48, s47, 2
    s_cmp_eq_u32 s47, 3
    s_cselect_b32 s48, 11, s48
    s_cmp_ge_u32 s47, 2
    s_cselect_b32 s46, 3, 4
    s_lshl_b32 s49, s48, 17
    s_and_b32 s38, s34, 3
    s_lshl_b32 s38, s38, 8
    s_add_u32 s38, s38, s49
    v_lshrrev_b32 v4, 4, v1
    v_and_b32 v5, 15, v1
    v_lshlrev_b32 v6, 2, v4
    v_xor_b32 v5, v5, v6
    v_lshlrev_b32 v5, 4, v5
    v_mul_u32_u24 v4, 1024, v4
    v_add_u32 v4, v4, v5
    s_mul_i32 s39, s32, 32768
    s_add_u32 s38, s38, s39
    s_lshl_b32 s39, s32, 13
    s_mov_b32 s40, 0
L_res_150:
    s_mov_b32 s41, 0
L_resi_151:
    s_mov_b32 m0, s39
    s_add_u32 s41, s41, 1
    buffer_load_dwordx4 v4, s[12:15], s38 offen lds
    s_add_u32 s38, s38, 4096
    s_add_u32 s39, s39, 1024
    s_cmp_lt_u32 s41, 8
    s_cbranch_scc1 L_resi_151
    s_add_u32 s38, s38, 98304
    s_add_u32 s39, s39, 24576
    s_add_u32 s40, s40, 1
    s_cmp_lt_u32 s40, s46
    s_cbranch_scc1 L_res_150
    s_waitcnt vmcnt(0)
    s_barrier
L_ff_top_152:
    s_cmp_ge_u32 s33, 64
    s_cbranch_scc1 L_ff_done_153
    s_cmp_ge_u32 s33, 62
    s_cbranch_scc1 L_ff_direct_154
    s_and_b32 s38, s33, 1
    s_add_u32 s38, s38, 7
    s_lshl_b32 s38, s38, 7
    s_add_u32 s38, s38, 0xa000000
    s_add_u32 s39, s33, 1
    s_cmp_lg_u32 s32, 0
    s_cbranch_scc1 L_wf_ok_157
    v_min_u32 v2, 13, v1
    v_lshlrev_b32 v2, 2, v2
L_wf_156:
    buffer_load_dword v3, v2, s[8:11], s38 offen sc1
    s_waitcnt vmcnt(0)
    v_cmp_gt_u32 vcc, s39, v3
    s_cbranch_vccz L_wf_ok_157
    s_add_u32 s43, s43, 1
    s_cmp_lt_u32 s43, 0x100000
    s_cbranch_scc0 L_wf_ok_157
    s_cmp_ge_u32 s33, 62
    s_cbranch_scc1 L_wf_156
    s_sleep 8
    s_branch L_wf_156
L_wf_ok_157:
    s_barrier
    s_cmp_ge_u32 s32, s46
    s_cbranch_scc1 L_ff_skip_158
    s_mul_i32 s38, s33, 14
    s_add_u32 s38, s38, s48
    s_add_u32 s38, s38, s32
    s_lshl_b32 s38, s38, 13
    s_add_u32 s38, s38, 0x6200000
    s_add_u32 s39, s44, 0
    s_mov_b32 m0, s39
    s_nop 0
    buffer_load_dwordx4 v14, s[8:11], s38 offen offset:0 sc1 lds
    buffer_load_dwordx4 v14, s[8:11], s38 offen offset:1024 sc1 lds
    buffer_load_dwordx4 v14, s[8:11], s38 offen offset:2048 sc1 lds
    buffer_load_dwordx4 v14, s[8:11], s38 offen offset:3072 sc1 lds
    s_add_u32 s38, s38, 4096
    s_add_u32 s39, s44, 4096
    s_mov_b32 m0, s39
    s_nop 0
    buffer_load_dwordx4 v14, s[8:11], s38 offen offset:0 sc1 lds
    buffer_load_dwordx4 v14, s[8:11], s38 offen offset:1024 sc1 lds
    buffer_load_dwordx4 v14, s[8:11], s38 offen offset:2048 sc1 lds
    buffer_load_dwordx4 v14, s[8:11], s38 offen offset:3072 sc1 lds
L_ff_skip_158:
    s_waitcnt vmcnt(0)
    s_branch L_ff_staged_155
L_ff_direct_154:
    s_cmp_ge_u32 s32, s46
    s_cbranch_scc1 L_ff_staged_155
    s_mul_i32 s38, s33, 14
    s_add_u32 s38, s38, s48
    s_add_u32 s38, s38, s32
    s_lshl_b32 s38, s38, 13
    s_add_u32 s38, s38, 0x6200000
    s_add_u32 s39, s38, 4096
L_ff_again_159:
    buffer_load_dwordx4 v[64:67], v14, s[8:11], s38 offen offset:0 sc1
    buffer_load_dwordx4 v[68:71], v14, s[8:11], s38 offen offset:1024 sc1
    buffer_load_dwordx4 v[72:75], v14, s[8:11], s38 offen offset:2048 sc1
    buffer_load_dwordx4 v[76:79], v14, s[8:11], s38 offen offset:3072 sc1
    buffer_load_dwordx4 v[80:83], v14, s[8:11], s39 offen offset:0 sc1
    buffer_load_dwordx4 v[84:87], v14, s[8:11], s39 offen offset:1024 sc1
    buffer_load_dwordx4 v[88:91], v14, s[8:11], s39 offen offset:2048 sc1
    buffer_load_dwordx4 v[92:95], v14, s[8:11], s39 offen offset:3072 sc1
    s_waitcnt vmcnt(0)
    v_max3_u32 v2, v64, v65, v66
    v_max3_u32 v2, v2, v67, v68
    v_max3_u32 v2, v2, v69, v70
    v_max3_u32 v2, v2, v71, v72
    v_max3_u32 v2, v2, v73, v74
    v_max3_u32 v2, v2, v75, v76
    v_max3_u32 v2, v2, v77, v78
    v_max3_u32 v2, v2, v79, v80
    v_max3_u32 v2, v2, v81, v82
    v_max3_u32 v2, v2, v83, v84
    v_max3_u32 v2, v2, v85, v86
    v_max3_u32 v2, v2, v87, v88
    v_max3_u32 v2, v2, v89, v90
    v_max3_u32 v2, v2, v91, v92
    v_max3_u32 v2, v2, v93, v94
    v_max_u32 v2, v2, v95
    v_cmp_eq_u32 vcc, -1, v2
    s_cbranch_vccz L_ff_have_160
    s_add_u32 s43, s43, 1
    s_cmp_lt_u32 s43, 0x100000
    s_cbranch_scc0 L_ff_have_160
    s_sleep 2
    s_branch L_ff_again_159
L_ff_have_160:
    v_add_u32 v2, s44, v14
    ds_write_b128 v2, v[64:67] offset:0
    ds_write_b128 v2, v[68:71] offset:1024
    ds_write_b128 v2, v[72:75] offset:2048
    ds_write_b128 v2, v[76:79] offset:3072
    ds_write_b128 v2, v[80:83] offset:4096
    ds_write_b128 v2, v[84:87] offset:5120
    ds_write_b128 v2, v[88:91] offset:6144
    ds_write_b128 v2, v[92:95] offset:7168
    s_waitcnt lgkmcnt(0)
L_ff_staged_155:
    s_barrier
    s_cmp_eq_u32 s46, 3
    s_cbranch_scc1 L_ff3_161
    v_xor_b32 v2, 0, v10
    ds_read_b128 v[48:51], v2
    ds_read_b64_tr_b16 v[64:65], v8 offset:0
    ds_read_b64_tr_b16 v[66:67], v8 offset:1024
    v_xor_b32 v3, 32, v10
    ds_read_b128 v[52:55], v3
    ds_read_b64_tr_b16 v[68:69], v8 offset:4096
    ds_read_b64_tr_b16 v[70:71], v8 offset:5120
    v_xor_b32 v2, 64, v10
    ds_read_b128 v[56:59], v2
    ds_read_b64_tr_b16 v[72:73], v8 offset:8192
    ds_read_b64_tr_b16 v[74:75], v8 offset:9216
    s_waitcnt lgkmcnt(6)
    v_mfma_f32_32x32x16_bf16 v[32:47], v[64:67], v[48:51], 0
    v_xor_b32 v3, 96, v10
    ds_read_b128 v[60:63], v3
    ds_read_b64_tr_b16 v[76:77], v8 offset:12288
    ds_read_b64_tr_b16 v[78:79], v8 offset:13312
    s_waitcnt lgkmcnt(6)
    v_mfma_f32_32x32x16_bf16 v[32:47], v[68:71], v[52:55], v[32:47]
    v_xor_b32 v2, 128, v10
    ds_read_b128 v[48:51], v2
    ds_read_b64_tr_b16 v[64:65], v8 offset:16384
    ds_read_b64_tr_b16 v[66:67], v8 offset:17408
    s_waitcnt lgkmcnt(6)
    v_mfma_f32_32x32x16_bf16 v[32:47], v[72:75], v[56:59], v[32:47]
    v_xor_b32 v3, 160, v10
    ds_read_b128 v[52:55], v3
    ds_read_b64_tr_b16 v[68:69], v8 offset:20480
    ds_read_b64_tr_b16 v[70:71], v8 offset:21504
    s_waitcnt lgkmcnt(6)
    v_mfma_f32_32x32x16_bf16 v[32:47], v[76:79], v[60:63], v[32:47]
    v_xor_b32 v2, 192, v10
    ds_read_b128 v[56:59], v2
    ds_read_b64_tr_b16 v[72:73], v8 offset:24576
    ds_read_b64_tr_b16 v[74:75], v8 offset:25600
    s_waitcnt lgkmcnt(6)
    v_mfma_f32_32x32x16_bf16 v[32:47], v[64:67], v[48:51], v[32:47]
    v_xor_b32 v3, 224, v10
    ds_read_b128 v[60:63], v3
    ds_read_b64_tr_b16 v[76:77], v8 offset:28672
    ds_read_b64_tr_b16 v[78:79], v8 offset:29696
    s_waitcnt lgkmcnt(6)
    v_mfma_f32_32x32x16_bf16 v[32:47], v[68:71], v[52:55], v[32:47]
    v_xor_b32 v2, 0, v11
    ds_read_b128 v[48:51], v2
    ds_read_b64_tr_b16 v[64:65], v8 offset:32768
    ds_read_b64_tr_b16 v[66:67], v8 offset:33792
    s_waitcnt lgkmcnt(6)
    v_mfma_f32_32x32x16_bf16 v[32:47], v[72:75], v[56:59], v[32:47]
    v_xor_b32 v3, 32, v11
    ds_read_b128 v[52:55], v3
    ds_read_b64_tr_b16 v[68:69], v8 offset:36864
    ds_read_b64_tr_b16 v[70:71], v8 offset:37888
    s_waitcnt lgkmcnt(6)
    v_mfma_f32_32x32x16_bf16 v[32:47], v[76:79], v[60:63], v[32:47]
    v_xor_b32 v2, 64, v11
    ds_read_b128 v[56:59], v2
    ds_read_b64_tr_b16 v[72:73], v8 offset:40960
    ds_read_b64_tr_b16 v[74:75], v8 offset:41984
    s_waitcnt lgkmcnt(6)
    v_mfma_f32_32x32x16_bf16 v[32:47], v[64:67], v[48:51], v[32:47]
    v_xor_b32 v3, 96, v11
    ds_read_b128 v[60:63], v3
    ds_read_b64_tr_b16 v[76:77], v8 offset:45056
    ds_read_b64_tr_b16 v[78:79], v8 offset:46080
    s_waitcnt lgkmcnt(6)
    v_mfma_f32_32x32x16_bf16 v[32:47], v[68:71], v[52:55], v[32:47]
    v_xor_b32 v2, 128, v11
    ds_read_b128 v[48:51], v2
    ds_read_b64_tr_b16 v[64:65], v8 offset:49152
    ds_read_b64_tr_b16 v[66:67], v8 offset:50176
    s_waitcnt lgkmcnt(6)
    v_mfma_f32_32x32x16_bf16 v[32:47], v[72:75], v[56:59], v[32:47]
    v_xor_b32 v3, 160, v11
    ds_read_b128 v[52:55], v3
    ds_read_b64_tr_b16 v[68:69], v8 offset:53248
    ds_read_b64_tr_b16 v[70:71], v8 offset:54272
    s_waitcnt lgkmcnt(6)
    v_mfma_f32_32x32x16_bf16 v[32:47], v[76:79], v[60:63], v[32:47]
    v_xor_b32 v2, 192, v11
    ds_read_b128 v[56:59], v2
    ds_read_b64_tr_b16 v[72:73], v8 offset:57344
    ds_read_b64_tr_b16 v[74:75], v8 offset:58368
    s_waitcnt lgkmcnt(6)
    v_mfma_f32_32x32x16_bf16 v[32:47], v[64:67], v[48:51], v[32:47]
    v_xor_b32 v3, 224, v11
    ds_read_b128 v[60:63], v3
    ds_read_b64_tr_b16 v[76:77], v8 offset:61440
    ds_read_b64_tr_b16 v[78:79], v8 offset:62464
    s_waitcnt lgkmcnt(6)
    v_mfma_f32_32x32x16_bf16 v[32:47], v[68:71], v[52:55], v[32:47]
    v_xor_b32 v2, 0, v12
    ds_read_b128 v[48:51], v2
    ds_read_b64_tr_b16 v[64:65], v9 offset:0
    ds_read_b64_tr_b16 v[66:67], v9 offset:1024
    s_waitcnt lgkmcnt(6)
    v_mfma_f32_32x32x16_bf16 v[32:47], v[72:75], v[56:59], v[32:47]
    v_xor_b32 v3, 32, v12
    ds_read_b128 v[52:55], v3
    ds_read_b64_tr_b16 v[68:69], v9 offset:4096
    ds_read_b64_tr_b16 v[70:71], v9 offset:5120
    s_waitcnt lgkmcnt(6)
    v_mfma_f32_32x32x16_bf16 v[32:47], v[76:79], v[60:63], v[32:47]
    v_xor_b32 v2, 64, v12
    ds_read_b128 v[56:59], v2
    ds_read_b64_tr_b16 v[72:73], v9 offset:8192
    ds_read_b64_tr_b16 v[74:75], v9 offset:9216
    s_waitcnt lgkmcnt(6)
    v_mfma_f32_32x32x16_bf16 v[32:47], v[64:67], v[48:51], v[32:47]
    v_xor_b32 v3, 96, v12
    ds_read_b128 v[60:63], v3
    ds_read_b64_tr_b16 v[76:77], v9 offset:12288
    ds_read_b64_tr_b16 v[78:79], v9 offset:13312
    s_waitcnt lgkmcnt(6)
    v_mfma_f32_32x32x16_bf16 v[32:47], v[68:71], v[52:55], v[32:47]
    v_xor_b32 v2, 128, v12
    ds_read_b128 v[48:51], v2
    ds_read_b64_tr_b16 v[64:65], v9 offset:16384
    ds_read_b64_tr_b16 v[66:67], v9 offset:17408
    s_waitcnt lgkmcnt(6)
    v_mfma_f32_32x32x16_bf16 v[32:47], v[72:75], v[56:59], v[32:47]
    v_xor_b32 v3, 160, v12
    ds_read_b128 v[52:55], v3
    ds_read_b64_tr_b16 v[68:69], v9 offset:20480
    ds_read_b64_tr_b16 v[70:71], v9 offset:21504
    s_waitcnt lgkmcnt(6)
    v_mfma_f32_32x32x16_bf16 v[32:47], v[76:79], v[60:63], v[32:47]
    v_xor_b32 v2, 192, v12
    ds_read_b128 v[56:59], v2
    ds_read_b64_tr_b16 v[72:73], v9 offset:24576
    ds_read_b64_tr_b16 v[74:75], v9 offset:25600
    s_waitcnt lgkmcnt(6)
    v_mfma_f32_32x32x16_bf16 v[32:47], v[64:67], v[48:51], v[32:47]
    v_xor_b32 v3, 224, v12
    ds_read_b128 v[60:63], v3
    ds_read_b64_tr_b16 v[76:77], v9 offset:28672
    ds_read_b64_tr_b16 v[78:79], v9 offset:29696
    s_waitcnt lgkmcnt(6)
    v_mfma_f32_32x32x16_bf16 v[32:47], v[68:71], v[52:55], v[32:47]
    v_xor_b32 v2, 0, v13
    ds_read_b128 v[48:51], v2
    ds_read_b64_tr_b16 v[64:65], v9 offset:32768
    ds_read_b64_tr_b16 v[66:67], v9 offset:33792
    s_waitcnt lgkmcnt(6)
    v_mfma_f32_32x32x16_bf16 v[32:47], v[72:75], v[56:59], v[32:47]
    v_xor_b32 v3, 32, v13
    ds_read_b128 v[52:55], v3
    ds_read_b64_tr_b16 v[68:69], v9 offset:36864
    ds_read_b64_tr_b16 v[70:71], v9 offset:37888
    s_waitcnt lgkmcnt(6)
    v_mfma_f32_32x32x16_bf16 v[32:47], v[76:79], v[60:63], v[32:47]
    v_xor_b32 v2, 64, v13
    ds_read_b128 v[56:59], v2
    ds_read_b64_tr_b16 v[72:73], v9 offset:40960
    ds_read_b64_tr_b16 v[74:75], v9 offset:41984
    s_waitcnt lgkmcnt(6)
    v_mfma_f32_32x32x16_bf16 v[32:47], v[64:67], v[48:51], v[32:47]
    v_xor_b32 v3, 96, v13
    ds_read_b128 v[60:63], v3
    ds_read_b64_tr_b16 v[76:77], v9 offset:45056
    ds_read_b64_tr_b16 v[78:79], v9 offset:46080
    s_waitcnt lgkmcnt(6)
    v_mfma_f32_32x32x16_bf16 v[32:47], v[68:71], v[52:55], v[32:47]
    v_xor_b32 v2, 128, v13
    ds_read_b128 v[48:51], v2
    ds_read_b64_tr_b16 v[64:65], v9 offset:49152
    ds_read_b64_tr_b16 v[66:67], v9 offset:50176
    s_waitcnt lgkmcnt(6)
    v_mfma_f32_32x32x16_bf16 v[32:47], v[72:75], v[56:59], v[32:47]
    v_xor_b32 v3, 160, v13
    ds_read_b128 v[52:55], v3
    ds_read_b64_tr_b16 v[68:69], v9 offset:53248
    ds_read_b64_tr_b16 v[70:71], v9 offset:54272
    s_waitcnt lgkmcnt(6)
    v_mfma_f32_32x32x16_bf16 v[32:47], v[76:79], v[60:63], v[32:47]
    v_xor_b32 v2, 192, v13
    ds_read_b128 v[56:59], v2
    ds_read_b64_tr_b16 v[72:73], v9 offset:57344
    ds_read_b64_tr_b16 v[74:75], v9 offset:58368
    s_waitcnt lgkmcnt(6)
    v_mfma_f32_32x32x16_bf16 v[32:47], v[64:67], v[48:51], v[32:47]
    v_xor_b32 v3, 224, v13
    ds_read_b128 v[60:63], v3
    ds_read_b64_tr_b16 v[76:77], v9 offset:61440
    ds_read_b64_tr_b16 v[78:79], v9 offset:62464
    s_waitcnt lgkmcnt(6)
    v_mfma_f32_32x32x16_bf16 v[32:47], v[68:71], v[52:55], v[32:47]
    s_waitcnt lgkmcnt(3)
    v_mfma_f32_32x32x16_bf16 v[32:47], v[72:75], v[56:59], v[32:47]
    s_waitcnt lgkmcnt(0)
    v_mfma_f32_32x32x16_bf16 v[32:47], v[76:79], v[60:63], v[32:47]
    s_nop 11
    s_branch L_ffj_162
L_ff3_161:
    v_xor_b32 v2, 0, v10
    ds_read_b128 v[48:51], v2
    ds_read_b64_tr_b16 v[64:65], v8 offset:0
    ds_read_b64_tr_b16 v[66:67], v8 offset:1024
    v_xor_b32 v3, 32, v10
    ds_read_b128 v[52:55], v3
    ds_read_b64_tr_b16 v[68:69], v8 offset:4096
    ds_read_b64_tr_b16 v[70:71], v8 offset:5120
    v_xor_b32 v2, 64, v10
    ds_read_b128 v[56:59], v2
    ds_read_b64_tr_b16 v[72:73], v8 offset:8192
    ds_read_b64_tr_b16 v[74:75], v8 offset:9216
    s_waitcnt lgkmcnt(6)
    v_mfma_f32_32x32x16_bf16 v[32:47], v[64:67], v[48:51], 0
    v_xor_b32 v3, 96, v10
    ds_read_b128 v[60:63], v3
    ds_read_b64_tr_b16 v[76:77], v8 offset:12288
    ds_read_b64_tr_b16 v[78:79], v8 offset:13312
    s_waitcnt lgkmcnt(6)
    v_mfma_f32_32x32x16_bf16 v[32:47], v[68:71], v[52:55], v[32:47]
    v_xor_b32 v2, 128, v10
    ds_read_b128 v[48:51], v2
    ds_read_b64_tr_b16 v[64:65], v8 offset:16384
    ds_read_b64_tr_b16 v[66:67], v8 offset:17408
    s_waitcnt lgkmcnt(6)
    v_mfma_f32_32x32x16_bf16 v[32:47], v[72:75], v[56:59], v[32:47]
    v_xor_b32 v3, 160, v10
    ds_read_b128 v[52:55], v3
    ds_read_b64_tr_b16 v[68:69], v8 offset:20480
    ds_read_b64_tr_b16 v[70:71], v8 offset:21504
    s_waitcnt lgkmcnt(6)
    v_mfma_f32_32x32x16_bf16 v[32:47], v[76:79], v[60:63], v[32:47]
    v_xor_b32 v2, 192, v10
    ds_read_b128 v[56:59], v2
    ds_read_b64_tr_b16 v[72:73], v8 offset:24576
    ds_read_b64_tr_b16 v[74:75], v8 offset:25600
    s_waitcnt lgkmcnt(6)
    v_mfma_f32_32x32x16_bf16 v[32:47], v[64:67], v[48:51], v[32:47]
    v_xor_b32 v3, 224, v10
    ds_read_b128 v[60:63], v3
    ds_read_b64_tr_b16 v[76:77], v8 offset:28672
    ds_read_b64_tr_b16 v[78:79], v8 offset:29696
    s_waitcnt lgkmcnt(6)
    v_mfma_f32_32x32x16_bf16 v[32:47], v[68:71], v[52:55], v[32:47]
    v_xor_b32 v2, 0, v11
    ds_read_b128 v[48:51], v2
    ds_read_b64_tr_b16 v[64:65], v8 offset:32768
    ds_read_b64_tr_b16 v[66:67], v8 offset:33792
    s_waitcnt lgkmcnt(6)
    v_mfma_f32_32x32x16_bf16 v[32:47], v[72:75], v[56:59], v[32:47]
    v_xor_b32 v3, 32, v11
    ds_read_b128 v[52:55], v3
    ds_read_b64_tr_b16 v[68:69], v8 offset:36864
    ds_read_b64_tr_b16 v[70:71], v8 offset:37888
    s_waitcnt lgkmcnt(6)
    v_mfma_f32_32x32x16_bf16 v[32:47], v[76:79], v[60:63], v[32:47]
    v_xor_b32 v2, 64, v11
    ds_read_b128 v[56:59], v2
    ds_read_b64_tr_b16 v[72:73], v8 offset:40960
    ds_read_b64_tr_b16 v[74:75], v8 offset:41984
    s_waitcnt lgkmcnt(6)
    v_mfma_f32_32x32x16_bf16 v[32:47], v[64:67], v[48:51], v[32:47]
    v_xor_b32 v3, 96, v11
    ds_read_b128 v[60:63], v3
    ds_read_b64_tr_b16 v[76:77], v8 offset:45056
    ds_read_b64_tr_b16 v[78:79], v8 offset:46080
    s_waitcnt lgkmcnt(6)
    v_mfma_f32_32x32x16_bf16 v[32:47], v[68:71], v[52:55], v[32:47]
    v_xor_b32 v2, 128, v11
    ds_read_b128 v[48:51], v2
    ds_read_b64_tr_b16 v[64:65], v8 offset:49152
    ds_read_b64_tr_b16 v[66:67], v8 offset:50176
    s_waitcnt lgkmcnt(6)
    v_mfma_f32_32x32x16_bf16 v[32:47], v[72:75], v[56:59], v[32:47]
    v_xor_b32 v3, 160, v11
    ds_read_b128 v[52:55], v3
    ds_read_b64_tr_b16 v[68:69], v8 offset:53248
    ds_read_b64_tr_b16 v[70:71], v8 offset:54272
    s_waitcnt lgkmcnt(6)
    v_mfma_f32_32x32x16_bf16 v[32:47], v[76:79], v[60:63], v[32:47]
    v_xor_b32 v2, 192, v11
    ds_read_b128 v[56:59], v2
    ds_read_b64_tr_b16 v[72:73], v8 offset:57344
    ds_read_b64_tr_b16 v[74:75], v8 offset:58368
    s_waitcnt lgkmcnt(6)
    v_mfma_f32_32x32x16_bf16 v[32:47], v[64:67], v[48:51], v[32:47]
    v_xor_b32 v3, 224, v11
    ds_read_b128 v[60:63], v3
    ds_read_b64_tr_b16 v[76:77], v8 offset:61440
    ds_read_b64_tr_b16 v[78:79], v8 offset:62464
    s_waitcnt lgkmcnt(6)
    v_mfma_f32_32x32x16_bf16 v[32:47], v[68:71], v[52:55], v[32:47]
    v_xor_b32 v2, 0, v12
    ds_read_b128 v[48:51], v2
    ds_read_b64_tr_b16 v[64:65], v9 offset:0
    ds_read_b64_tr_b16 v[66:67], v9 offset:1024
    s_waitcnt lgkmcnt(6)
    v_mfma_f32_32x32x16_bf16 v[32:47], v[72:75], v[56:59], v[32:47]
    v_xor_b32 v3, 32, v12
    ds_read_b128 v[52:55], v3
    ds_read_b64_tr_b16 v[68:69], v9 offset:4096
    ds_read_b64_tr_b16 v[70:71], v9 offset:5120
    s_waitcnt lgkmcnt(6)
    v_mfma_f32_32x32x16_bf16 v[32:47], v[76:79], v[60:63], v[32:47]
    v_xor_b32 v2, 64, v12
    ds_read_b128 v[56:59], v2
    ds_read_b64_tr_b16 v[72:73], v9 offset:8192
    ds_read_b64_tr_b16 v[74:75], v9 offset:9216
    s_waitcnt lgkmcnt(6)
    v_mfma_f32_32x32x16_bf16 v[32:47], v[64:67], v[48:51], v[32:47]
    v_xor_b32 v3, 96, v12
    ds_read_b128 v[60:63], v3
    ds_read_b64_tr_b16 v[76:77], v9 offset:12288
    ds_read_b64_tr_b16 v[78:79], v9 offset:13312
    s_waitcnt lgkmcnt(6)
    v_mfma_f32_32x32x16_bf16 v[32:47], v[68:71], v[52:55], v[32:47]
    v_xor_b32 v2, 128, v12
    ds_read_b128 v[48:51], v2
    ds_read_b64_tr_b16 v[64:65], v9 offset:16384
    ds_read_b64_tr_b16 v[66:67], v9 offset:17408
    s_waitcnt lgkmcnt(6)
    v_mfma_f32_32x32x16_bf16 v[32:47], v[72:75], v[56:59], v[32:47]
    v_xor_b32 v3, 160, v12
    ds_read_b128 v[52:55], v3
    ds_read_b64_tr_b16 v[68:69], v9 offset:20480
    ds_read_b64_tr_b16 v[70:71], v9 offset:21504
    s_waitcnt lgkmcnt(6)
    v_mfma_f32_32x32x16_bf16 v[32:47], v[76:79], v[60:63], v[32:47]
    v_xor_b32 v2, 192, v12
    ds_read_b128 v[56:59], v2
    ds_read_b64_tr_b16 v[72:73], v9 offset:24576
    ds_read_b64_tr_b16 v[74:75], v9 offset:25600
    s_waitcnt lgkmcnt(6)
    v_mfma_f32_32x32x16_bf16 v[32:47], v[64:67], v[48:51], v[32:47]
    v_xor_b32 v3, 224, v12
    ds_read_b128 v[60:63], v3
    ds_read_b64_tr_b16 v[76:77], v9 offset:28672
    ds_read_b64_tr_b16 v[78:79], v9 offset:29696
    s_waitcnt lgkmcnt(6)
    v_mfma_f32_32x32x16_bf16 v[32:47], v[68:71], v[52:55], v[32:47]
    s_waitcnt lgkmcnt(3)
    v_mfma_f32_32x32x16_bf16 v[32:47], v[72:75], v[56:59], v[32:47]
    s_waitcnt lgkmcnt(0)
    v_mfma_f32_32x32x16_bf16 v[32:47], v[76:79], v[60:63], v[32:47]
    s_nop 11
L_ffj_162:
    s_lshl_b32 s45, s33, 4
    s_add_u32 s45, s45, s34
    s_lshl_b32 s45, s45, 13
    s_add_u32 s45, s45, 0x9400000
    s_barrier
    v_cvt_pk_bf16_f32 v48, v32, v33
    v_cvt_pk_bf16_f32 v49, v34, v35
    v_cvt_pk_bf16_f32 v50, v36, v37
    v_cvt_pk_bf16_f32 v51, v38, v39
    s_nop 1
    v_permlane32_swap_b32 v48, v50
    v_permlane32_swap_b32 v49, v51
    s_lshl_b32 s38, s32, 2
    s_add_u32 s38, s38, 0
    s_lshl_b32 s38, s38, 4
    v_xor_b32 v2, s38, v10
    ds_write_b128 v2, v[48:51]
    v_cvt_pk_bf16_f32 v52, v40, v41
    v_cvt_pk_bf16_f32 v53, v42, v43
    v_cvt_pk_bf16_f32 v54, v44, v45
    v_cvt_pk_bf16_f32 v55, v46, v47
    s_nop 1
    v_permlane32_swap_b32 v52, v54
    v_permlane32_swap_b32 v53, v55
    s_lshl_b32 s38, s32, 2
    s_add_u32 s38, s38, 2
    s_lshl_b32 s38, s38, 4
    v_xor_b32 v2, s38, v10
    ds_write_b128 v2, v[52:55]
    s_waitcnt lgkmcnt(0)
    s_barrier
    s_lshl_b32 s38, s32, 11
    s_add_u32 s39, s38, 131072
    v_add_u32 v2, s39, v14
    ds_read_b128 v[48:51], v2
    ds_read_b128 v[52:55], v2 offset:1024
    s_add_u32 s38, s38, s45
    s_waitcnt lgkmcnt(1)
    buffer_store_dwordx4 v[48:51], v14, s[8:11], s38 offen sc1
    s_waitcnt lgkmcnt(0)
    buffer_store_dwordx4 v[52:55], v14, s[8:11], s38 offen offset:1024 sc1
    s_waitcnt vmcnt(0)
    s_barrier
    s_add_u32 s38, s33, 1
    s_cmp_lg_u32 s32, 0
    s_cbranch_scc1 L_sf_163
    s_mov_b64 exec, 1
    v_mov_b32 v2, 0
    v_mov_b32 v3, s38
    buffer_store_dword v3, v2, s[8:11], s42 offen sc1
    s_mov_b64 exec, -1
L_sf_163:
    s_add_u32 s33, s33, s36
    s_branch L_ff_top_152
L_ff_done_153:
    s_branch L_end_1
L_role_r1_89:
    s_mov_b32 s33, s35
    s_mov_b32 s36, 2
    s_mov_b32 s43, 0
    s_add_u32 s42, s35, 5
    s_lshl_b32 s42, s42, 7
    s_lshl_b32 s38, s34, 2
    s_add_u32 s42, s42, s38
    s_add_u32 s42, s42, 0xa000000
    s_load_dwordx2 s[22:23], s[0:1], 0
    s_waitcnt lgkmcnt(0)
    s_mov_b32 s16, s22
    s_and_b32 s17, s23, 0xffff
    s_mov_b32 s18, 0x200000
    s_mov_b32 s19, 0x20000
    s_lshl_b32 s46, s34, 2
    s_add_u32 s46, s46, s32
    s_and_b32 s47, s46, 15
    v_and_b32 v4, 15, v1
    v_xor_b32 v4, s47, v4
    v_lshlrev_b32 v4, 4, v4
    v_lshrrev_b32 v5, 4, v1
    v_lshl_add_u32 v4, v5, 13, v4
    s_lshl_b32 s47, s46, 8
    v_add_u32 v4, s47, v4
    v_lshlrev_b32 v5, 4, v1
    s_mov_b32 s48, 0xffff0000
L_rd_top_164:
    s_cmp_ge_u32 s33, 64
    s_cbranch_scc1 L_rd_done_165
    s_cmp_ge_u32 s33, 62
    s_cbranch_scc1 L_rd_direct_166
    s_and_b32 s38, s33, 3
    s_add_u32 s38, s38, 1
    s_lshl_b32 s38, s38, 7
    s_add_u32 s38, s38, 0xa000000
    s_add_u32 s39, s33, 1
    s_cmp_lg_u32 s32, 0
    s_cbranch_scc1 L_wf_ok_170
    v_min_u32 v2, 31, v1
    v_lshlrev_b32 v2, 2, v2
L_wf_169:
    buffer_load_dword v3, v2, s[8:11], s38 offen sc1
    s_waitcnt vmcnt(0)
    v_cmp_gt_u32 vcc, s39, v3
    s_cbranch_vccz L_wf_ok_170
    s_add_u32 s43, s43, 1
    s_cmp_lt_u32 s43, 0x100000
    s_cbranch_scc0 L_wf_ok_170
    s_cmp_ge_u32 s33, 62
    s_cbranch_scc1 L_wf_169
    s_sleep 8
    s_branch L_wf_169
L_wf_ok_170:
    s_barrier
    s_mul_i32 s38, s33, 262144
    s_add_u32 s38, s38, 0x8000000
    buffer_load_dwordx4 v[16:19], v4, s[8:11], s38 offen sc1
    s_add_u32 s38, s38, 32768
    buffer_load_dwordx4 v[20:23], v4, s[8:11], s38 offen sc1
    s_add_u32 s38, s38, 32768
    buffer_load_dwordx4 v[24:27], v4, s[8:11], s38 offen sc1
    s_add_u32 s38, s38, 32768
    buffer_load_dwordx4 v[28:31], v4, s[8:11], s38 offen sc1
    s_add_u32 s38, s38, 32768
    buffer_load_dwordx4 v[32:35], v4, s[8:11], s38 offen sc1
    s_add_u32 s38, s38, 32768
    buffer_load_dwordx4 v[36:39], v4, s[8:11], s38 offen sc1
    s_add_u32 s38, s38, 32768
    buffer_load_dwordx4 v[40:43], v4, s[8:11], s38 offen sc1
    s_add_u32 s38, s38, 32768
    buffer_load_dwordx4 v[44:47], v4, s[8:11], s38 offen sc1
    s_lshl_b32 s39, s33, 5
    s_add_u32 s39, s39, s46
    s_lshl_b32 s39, s39, 10
    buffer_load_dwordx4 v[48:51], v5, s[16:19], s39 offen
    s_waitcnt vmcnt(0)
    s_branch L_rd_have_168
L_rd_direct_166:
L_rd_again_167:
    s_mul_i32 s38, s33, 262144
    s_add_u32 s38, s38, 0x8000000
    buffer_load_dwordx4 v[16:19], v4, s[8:11], s38 offen sc1
    s_add_u32 s38, s38, 32768
    buffer_load_dwordx4 v[20:23], v4, s[8:11], s38 offen sc1
    s_add_u32 s38, s38, 32768
    buffer_load_dwordx4 v[24:27], v4, s[8:11], s38 offen sc1
    s_add_u32 s38, s38, 32768
    buffer_load_dwordx4 v[28:31], v4, s[8:11], s38 offen sc1
    s_add_u32 s38, s38, 32768
    buffer_load_dwordx4 v[32:35], v4, s[8:11], s38 offen sc1
    s_add_u32 s38, s38, 32768
    buffer_load_dwordx4 v[36:39], v4, s[8:11], s38 offen sc1
    s_add_u32 s38, s38, 32768
    buffer_load_dwordx4 v[40:43], v4, s[8:11], s38 offen sc1
    s_add_u32 s38, s38, 32768
    buffer_load_dwordx4 v[44:47], v4, s[8:11], s38 offen sc1
    s_lshl_b32 s39, s33, 5
    s_add_u32 s39, s39, s46
    s_lshl_b32 s39, s39, 10
    buffer_load_dwordx4 v[48:51], v5, s[16:19], s39 offen
    s_waitcnt vmcnt(0)
    v_max3_u32 v6, v16, v17, v18
    v_max3_u32 v6, v6, v19, v20
    v_max3_u32 v6, v6, v21, v22
    v_max3_u32 v6, v6, v23, v24
    v_max3_u32 v6, v6, v25, v26
    v_max3_u32 v6, v6, v27, v28
    v_max3_u32 v6, v6, v29, v30
    v_max3_u32 v6, v6, v31, v32
    v_max3_u32 v6, v6, v33, v34
    v_max3_u32 v6, v6, v35, v36
    v_max3_u32 v6, v6, v37, v38
    v_max3_u32 v6, v6, v39, v40
    v_max3_u32 v6, v6, v41, v42
    v_max3_u32 v6, v6, v43, v44
    v_max3_u32 v6, v6, v45, v46
    v_max_u32 v6, v6, v47
    v_cmp_eq_u32 vcc, -1, v6
    s_cbranch_vccz L_rd_have_168
    s_add_u32 s43, s43, 1
    s_cmp_lt_u32 s43, 0x100000
    s_cbranch_scc0 L_rd_have_168
    s_sleep 2
    s_branch L_rd_again_167
L_rd_have_168:
    v_lshlrev_b32 v52, 16, v16
    v_and_b32 v53, s48, v16
    v_lshlrev_b32 v6, 16, v20
    v_and_b32 v7, s48, v20
    v_add_f32 v52, v52, v6
    v_add_f32 v53, v53, v7
    v_lshlrev_b32 v6, 16, v24
    v_and_b32 v7, s48, v24
    v_add_f32 v52, v52, v6
    v_add_f32 v53, v53, v7
    v_lshlrev_b32 v6, 16, v28
    v_and_b32 v7, s48, v28
    v_add_f32 v52, v52, v6
    v_add_f32 v53, v53, v7
    v_lshlrev_b32 v6, 16, v32
    v_and_b32 v7, s48, v32
    v_add_f32 v52, v52, v6
    v_add_f32 v53, v53, v7
    v_lshlrev_b32 v6, 16, v36
    v_and_b32 v7, s48, v36
    v_add_f32 v52, v52, v6
    v_add_f32 v53, v53, v7
    v_lshlrev_b32 v6, 16, v40
    v_and_b32 v7, s48, v40
    v_add_f32 v52, v52, v6
    v_add_f32 v53, v53, v7
    v_lshlrev_b32 v6, 16, v44
    v_and_b32 v7, s48, v44
    v_add_f32 v52, v52, v6
    v_add_f32 v53, v53, v7
    v_cvt_pk_bf16_f32 v6, v52, v53
    v_lshlrev_b32 v52, 16, v6
    v_and_b32 v53, s48, v6
    v_lshlrev_b32 v6, 16, v48
    v_and_b32 v7, s48, v48
    v_add_f32 v52, v52, v6
    v_add_f32 v53, v53, v7
    v_cvt_pk_bf16_f32 v60, v52, v53
    v_lshlrev_b32 v54, 16, v17
    v_and_b32 v55, s48, v17
    v_lshlrev_b32 v6, 16, v21
    v_and_b32 v7, s48, v21
    v_add_f32 v54, v54, v6
    v_add_f32 v55, v55, v7
    v_lshlrev_b32 v6, 16, v25
    v_and_b32 v7, s48, v25
    v_add_f32 v54, v54, v6
    v_add_f32 v55, v55, v7
    v_lshlrev_b32 v6, 16, v29
    v_and_b32 v7, s48, v29
    v_add_f32 v54, v54, v6
    v_add_f32 v55, v55, v7
    v_lshlrev_b32 v6, 16, v33
    v_and_b32 v7, s48, v33
    v_add_f32 v54, v54, v6
    v_add_f32 v55, v55, v7
    v_lshlrev_b32 v6, 16, v37
    v_and_b32 v7, s48, v37
    v_add_f32 v54, v54, v6
    v_add_f32 v55, v55, v7
    v_lshlrev_b32 v6, 16, v41
    v_and_b32 v7, s48, v41
    v_add_f32 v54, v54, v6
    v_add_f32 v55, v55, v7
    v_lshlrev_b32 v6, 16, v45
    v_and_b32 v7, s48, v45
    v_add_f32 v54, v54, v6
    v_add_f32 v55, v55, v7
    v_cvt_pk_bf16_f32 v6, v54, v55
    v_lshlrev_b32 v54, 16, v6
    v_and_b32 v55, s48, v6
    v_lshlrev_b32 v6, 16, v49
    v_and_b32 v7, s48, v49
    v_add_f32 v54, v54, v6
    v_add_f32 v55, v55, v7
    v_cvt_pk_bf16_f32 v61, v54, v55
    v_lshlrev_b32 v56, 16, v18
    v_and_b32 v57, s48, v18
    v_lshlrev_b32 v6, 16, v22
    v_and_b32 v7, s48, v22
    v_add_f32 v56, v56, v6
    v_add_f32 v57, v57, v7
    v_lshlrev_b32 v6, 16, v26
    v_and_b32 v7, s48, v26
    v_add_f32 v56, v56, v6
    v_add_f32 v57, v57, v7
    v_lshlrev_b32 v6, 16, v30
    v_and_b32 v7, s48, v30
    v_add_f32 v56, v56, v6
    v_add_f32 v57, v57, v7
    v_lshlrev_b32 v6, 16, v34
    v_and_b32 v7, s48, v34
    v_add_f32 v56, v56, v6
    v_add_f32 v57, v57, v7
    v_lshlrev_b32 v6, 16, v38
    v_and_b32 v7, s48, v38
    v_add_f32 v56, v56, v6
    v_add_f32 v57, v57, v7
    v_lshlrev_b32 v6, 16, v42
    v_and_b32 v7, s48, v42
    v_add_f32 v56, v56, v6
    v_add_f32 v57, v57, v7
    v_lshlrev_b32 v6, 16, v46
    v_and_b32 v7, s48, v46
    v_add_f32 v56, v56, v6
    v_add_f32 v57, v57, v7
    v_cvt_pk_bf16_f32 v6, v56, v57
    v_lshlrev_b32 v56, 16, v6
    v_and_b32 v57, s48, v6
    v_lshlrev_b32 v6, 16, v50
    v_and_b32 v7, s48, v50
    v_add_f32 v56, v56, v6
    v_add_f32 v57, v57, v7
    v_cvt_pk_bf16_f32 v62, v56, v57
    v_lshlrev_b32 v58, 16, v19
    v_and_b32 v59, s48, v19
    v_lshlrev_b32 v6, 16, v23
    v_and_b32 v7, s48, v23
    v_add_f32 v58, v58, v6
    v_add_f32 v59, v59, v7
    v_lshlrev_b32 v6, 16, v27
    v_and_b32 v7, s48, v27
    v_add_f32 v58, v58, v6
    v_add_f32 v59, v59, v7
    v_lshlrev_b32 v6, 16, v31
    v_and_b32 v7, s48, v31
    v_add_f32 v58, v58, v6
    v_add_f32 v59, v59, v7
    v_lshlrev_b32 v6, 16, v35
    v_and_b32 v7, s48, v35
    v_add_f32 v58, v58, v6
    v_add_f32 v59, v59, v7
    v_lshlrev_b32 v6, 16, v39
    v_and_b32 v7, s48, v39
    v_add_f32 v58, v58, v6
    v_add_f32 v59, v59, v7
    v_lshlrev_b32 v6, 16, v43
    v_and_b32 v7, s48, v43
    v_add_f32 v58, v58, v6
    v_add_f32 v59, v59, v7
    v_lshlrev_b32 v6, 16, v47
    v_and_b32 v7, s48, v47
    v_add_f32 v58, v58, v6
    v_add_f32 v59, v59, v7
    v_cvt_pk_bf16_f32 v6, v58, v59
    v_lshlrev_b32 v58, 16, v6
    v_and_b32 v59, s48, v6
    v_lshlrev_b32 v6, 16, v51
    v_and_b32 v7, s48, v51
    v_add_f32 v58, v58, v6
    v_add_f32 v59, v59, v7
    v_cvt_pk_bf16_f32 v63, v58, v59
    s_add_u32 s40, s39, 0x6000000
    buffer_store_dwordx4 v[60:63], v5, s[8:11], s40 offen sc1
    v_lshlrev_b32 v52, 16, v60
    v_and_b32 v53, s48, v60
    v_lshlrev_b32 v54, 16, v61
    v_and_b32 v55, s48, v61
    v_lshlrev_b32 v56, 16, v62
    v_and_b32 v57, s48, v62
    v_lshlrev_b32 v58, 16, v63
    v_and_b32 v59, s48, v63
    v_add_f32 v6, v52, v53
    v_add_f32 v6, v6, v54
    v_add_f32 v6, v6, v55
    v_add_f32 v6, v6, v56
    v_add_f32 v6, v6, v57
    v_add_f32 v6, v6, v58
    v_add_f32 v6, v6, v59
    s_nop 1
    v_add_f32_dpp v6, v6, v6 row_ror:1 row_mask:0xf bank_mask:0xf
    s_nop 1
    v_add_f32_dpp v6, v6, v6 row_ror:2 row_mask:0xf bank_mask:0xf
    s_nop 1
    v_add_f32_dpp v6, v6, v6 row_ror:4 row_mask:0xf bank_mask:0xf
    s_nop 1
    v_add_f32_dpp v6, v6, v6 row_ror:8 row_mask:0xf bank_mask:0xf
    v_mov_b32 v7, v6
    s_nop 1
    v_permlane16_swap_b32 v6, v7
    s_nop 1
    v_add_f32 v6, v6, v7
    v_mov_b32 v7, v6
    s_nop 1
    v_permlane32_swap_b32 v6, v7
    s_nop 1
    v_add_f32 v6, v6, v7
    v_mul_f32 v6, 0x3b000000, v6
    v_sub_f32 v52, v52, v6
    v_sub_f32 v53, v53, v6
    v_sub_f32 v54, v54, v6
    v_sub_f32 v55, v55, v6
    v_sub_f32 v56, v56, v6
    v_sub_f32 v57, v57, v6
    v_sub_f32 v58, v58, v6
    v_sub_f32 v59, v59, v6
    v_mul_f32 v6, v52, v52
    v_fmac_f32 v6, v53, v53
    v_fmac_f32 v6, v54, v54
    v_fmac_f32 v6, v55, v55
    v_fmac_f32 v6, v56, v56
    v_fmac_f32 v6, v57, v57
    v_fmac_f32 v6, v58, v58
    v_fmac_f32 v6, v59, v59
    s_nop 1
    v_add_f32_dpp v6, v6, v6 row_ror:1 row_mask:0xf bank_mask:0xf
    s_nop 1
    v_add_f32_dpp v6, v6, v6 row_ror:2 row_mask:0xf bank_mask:0xf
    s_nop 1
    v_add_f32_dpp v6, v6, v6 row_ror:4 row_mask:0xf bank_mask:0xf
    s_nop 1
    v_add_f32_dpp v6, v6, v6 row_ror:8 row_mask:0xf bank_mask:0xf
    v_mov_b32 v7, v6
    s_nop 1
    v_permlane16_swap_b32 v6, v7
    s_nop 1
    v_add_f32 v6, v6, v7
    v_mov_b32 v7, v6
    s_nop 1
    v_permlane32_swap_b32 v6, v7
    s_nop 1
    v_add_f32 v6, v6, v7
    v_mul_f32 v6, 0x3b000000, v6
    v_add_f32 v6, 0x3727c5ac, v6
    v_rsq_f32 v6, v6
    s_nop 0
    v_mul_f32 v52, v52, v6
    v_mul_f32 v53, v53, v6
    v_cvt_pk_bf16_f32 v64, v52, v53
    v_mul_f32 v54, v54, v6
    v_mul_f32 v55, v55, v6
    v_cvt_pk_bf16_f32 v65, v54, v55
    v_mul_f32 v56, v56, v6
    v_mul_f32 v57, v57, v6
    v_cvt_pk_bf16_f32 v66, v56, v57
    v_mul_f32 v58, v58, v6
    v_mul_f32 v59, v59, v6
    v_cvt_pk_bf16_f32 v67, v58, v59
    s_lshl_b32 s40, s33, 15
    s_add_u32 s40, s40, 0x9000000
    buffer_store_dwordx4 v[64:67], v4, s[8:11], s40 offen sc1
    s_waitcnt vmcnt(0)
    s_barrier
    s_add_u32 s38, s33, 1
    s_cmp_lg_u32 s32, 0
    s_cbranch_scc1 L_sf_171
    s_mov_b64 exec, 1
    v_mov_b32 v2, 0
    v_mov_b32 v3, s38
    buffer_store_dword v3, v2, s[8:11], s42 offen sc1
    s_mov_b64 exec, -1
L_sf_171:
    s_add_u32 s33, s33, s36
    s_branch L_rd_top_164
L_rd_done_165:
    s_branch L_end_1
L_role_r2_90:
    s_mov_b32 s33, s35
    s_mov_b32 s36, 2
    s_mov_b32 s43, 0
    s_add_u32 s42, s35, 11
    s_lshl_b32 s42, s42, 7
    s_lshl_b32 s38, s34, 2
    s_add_u32 s42, s42, s38
    s_add_u32 s42, s42, 0xa000000
    s_load_dwordx2 s[22:23], s[0:1], 80
    s_waitcnt lgkmcnt(0)
    s_mov_b32 s16, s22
    s_and_b32 s17, s23, 0xffff
    s_mov_b32 s18, 0x200000
    s_mov_b32 s19, 0x20000
    s_lshl_b32 s46, s34, 2
    s_add_u32 s46, s46, s32
    s_and_b32 s47, s46, 15
    v_and_b32 v4, 15, v1
    v_xor_b32 v4, s47, v4
    v_lshlrev_b32 v4, 4, v4
    v_lshrrev_b32 v5, 4, v1
    v_lshl_add_u32 v4, v5, 13, v4
    s_lshl_b32 s47, s46, 8
    v_add_u32 v4, s47, v4
    v_lshlrev_b32 v5, 4, v1
    s_mov_b32 s48, 0xffff0000
L_rd_top_172:
    s_cmp_ge_u32 s33, 64
    s_cbranch_scc1 L_rd_done_173
    s_cmp_ge_u32 s33, 62
    s_cbranch_scc1 L_rd_direct_174
    s_and_b32 s38, s33, 1
    s_add_u32 s38, s38, 9
    s_lshl_b32 s38, s38, 7
    s_add_u32 s38, s38, 0xa000000
    s_add_u32 s39, s33, 1
    s_cmp_lg_u32 s32, 0
    s_cbranch_scc1 L_wf_ok_178
    v_min_u32 v2, 15, v1
    v_lshlrev_b32 v2, 2, v2
L_wf_177:
    buffer_load_dword v3, v2, s[8:11], s38 offen sc1
    s_waitcnt vmcnt(0)
    v_cmp_gt_u32 vcc, s39, v3
    s_cbranch_vccz L_wf_ok_178
    s_add_u32 s43, s43, 1
    s_cmp_lt_u32 s43, 0x100000
    s_cbranch_scc0 L_wf_ok_178
    s_cmp_ge_u32 s33, 62
    s_cbranch_scc1 L_wf_177
    s_sleep 8
    s_branch L_wf_177
L_wf_ok_178:
    s_barrier
    s_mul_i32 s38, s33, 131072
    s_add_u32 s38, s38, 0x9400000
    buffer_load_dwordx4 v[16:19], v4, s[8:11], s38 offen sc1
    s_add_u32 s38, s38, 32768
    buffer_load_dwordx4 v[20:23], v4, s[8:11], s38 offen sc1
    s_add_u32 s38, s38, 32768
    buffer_load_dwordx4 v[24:27], v4, s[8:11], s38 offen sc1
    s_add_u32 s38, s38, 32768
    buffer_load_dwordx4 v[28:31], v4, s[8:11], s38 offen sc1
    s_lshl_b32 s39, s33, 5
    s_add_u32 s39, s39, s46
    s_lshl_b32 s39, s39, 10
    s_add_u32 s40, s39, 0x6000000
    buffer_load_dwordx4 v[48:51], v5, s[8:11], s40 offen sc1
    s_waitcnt vmcnt(0)
    s_branch L_rd_have_176
L_rd_direct_174:
L_rd_again_175:
    s_mul_i32 s38, s33, 131072
    s_add_u32 s38, s38, 0x9400000
    buffer_load_dwordx4 v[16:19], v4, s[8:11], s38 offen sc1
    s_add_u32 s38, s38, 32768
    buffer_load_dwordx4 v[20:23], v4, s[8:11], s38 offen sc1
    s_add_u32 s38, s38, 32768
    buffer_load_dwordx4 v[24:27], v4, s[8:11], s38 offen sc1
    s_add_u32 s38, s38, 32768
    buffer_load_dwordx4 v[28:31], v4, s[8:11], s38 offen sc1
    s_lshl_b32 s39, s33, 5
    s_add_u32 s39, s39, s46
    s_lshl_b32 s39, s39, 10
    s_add_u32 s40, s39, 0x6000000
    buffer_load_dwordx4 v[48:51], v5, s[8:11], s40 offen sc1
    s_waitcnt vmcnt(0)
    v_max3_u32 v6, v16, v17, v18
    v_max3_u32 v6, v6, v19, v20
    v_max3_u32 v6, v6, v21, v22
    v_max3_u32 v6, v6, v23, v24
    v_max3_u32 v6, v6, v25, v26
    v_max3_u32 v6, v6, v27, v28
    v_max3_u32 v6, v6, v29, v30
    v_max3_u32 v6, v6, v31, v48
    v_max3_u32 v6, v6, v49, v50
    v_max_u32 v6, v6, v51
    v_cmp_eq_u32 vcc, -1, v6
    s_cbranch_vccz L_rd_have_176
    s_add_u32 s43, s43, 1
    s_cmp_lt_u32 s43, 0x100000
    s_cbranch_scc0 L_rd_have_176
    s_sleep 2
    s_branch L_rd_again_175
L_rd_have_176:
    v_lshlrev_b32 v52, 16, v16
    v_and_b32 v53, s48, v16
    v_lshlrev_b32 v6, 16, v20
    v_and_b32 v7, s48, v20
    v_add_f32 v52, v52, v6
    v_add_f32 v53, v53, v7
    v_lshlrev_b32 v6, 16, v24
    v_and_b32 v7, s48, v24
    v_add_f32 v52, v52, v6
    v_add_f32 v53, v53, v7
    v_lshlrev_b32 v6, 16, v28
    v_and_b32 v7, s48, v28
    v_add_f32 v52, v52, v6
    v_add_f32 v53, v53, v7
    v_cvt_pk_bf16_f32 v6, v52, v53
    v_lshlrev_b32 v52, 16, v6
    v_and_b32 v53, s48, v6
    v_lshlrev_b32 v6, 16, v48
    v_and_b32 v7, s48, v48
    v_add_f32 v52, v52, v6
    v_add_f32 v53, v53, v7
    v_cvt_pk_bf16_f32 v60, v52, v53
    v_lshlrev_b32 v54, 16, v17
    v_and_b32 v55, s48, v17
    v_lshlrev_b32 v6, 16, v21
    v_and_b32 v7, s48, v21
    v_add_f32 v54, v54, v6
    v_add_f32 v55, v55, v7
    v_lshlrev_b32 v6, 16, v25
    v_and_b32 v7, s48, v25
    v_add_f32 v54, v54, v6
    v_add_f32 v55, v55, v7
    v_lshlrev_b32 v6, 16, v29
    v_and_b32 v7, s48, v29
    v_add_f32 v54, v54, v6
    v_add_f32 v55, v55, v7
    v_cvt_pk_bf16_f32 v6, v54, v55
    v_lshlrev_b32 v54, 16, v6
    v_and_b32 v55, s48, v6
    v_lshlrev_b32 v6, 16, v49
    v_and_b32 v7, s48, v49
    v_add_f32 v54, v54, v6
    v_add_f32 v55, v55, v7
    v_cvt_pk_bf16_f32 v61, v54, v55
    v_lshlrev_b32 v56, 16, v18
    v_and_b32 v57, s48, v18
    v_lshlrev_b32 v6, 16, v22
    v_and_b32 v7, s48, v22
    v_add_f32 v56, v56, v6
    v_add_f32 v57, v57, v7
    v_lshlrev_b32 v6, 16, v26
    v_and_b32 v7, s48, v26
    v_add_f32 v56, v56, v6
    v_add_f32 v57, v57, v7
    v_lshlrev_b32 v6, 16, v30
    v_and_b32 v7, s48, v30
    v_add_f32 v56, v56, v6
    v_add_f32 v57, v57, v7
    v_cvt_pk_bf16_f32 v6, v56, v57
    v_lshlrev_b32 v56, 16, v6
    v_and_b32 v57, s48, v6
    v_lshlrev_b32 v6, 16, v50
    v_and_b32 v7, s48, v50
    v_add_f32 v56, v56, v6
    v_add_f32 v57, v57, v7
    v_cvt_pk_bf16_f32 v62, v56, v57
    v_lshlrev_b32 v58, 16, v19
    v_and_b32 v59, s48, v19
    v_lshlrev_b32 v6, 16, v23
    v_and_b32 v7, s48, v23
    v_add_f32 v58, v58, v6
    v_add_f32 v59, v59, v7
    v_lshlrev_b32 v6, 16, v27
    v_and_b32 v7, s48, v27
    v_add_f32 v58, v58, v6
    v_add_f32 v59, v59, v7
    v_lshlrev_b32 v6, 16, v31
    v_and_b32 v7, s48, v31
    v_add_f32 v58, v58, v6
    v_add_f32 v59, v59, v7
    v_cvt_pk_bf16_f32 v6, v58, v59
    v_lshlrev_b32 v58, 16, v6
    v_and_b32 v59, s48, v6
    v_lshlrev_b32 v6, 16, v51
    v_and_b32 v7, s48, v51
    v_add_f32 v58, v58, v6
    v_add_f32 v59, v59, v7
    v_cvt_pk_bf16_f32 v63, v58, v59
    buffer_store_dwordx4 v[60:63], v5, s[16:19], s39 offen
    s_add_u32 s33, s33, s36
    s_branch L_rd_top_172
L_rd_done_173:
    s_branch L_end_1
L_role_rl_91:
    s_cmp_lg_u32 s32, 0
    s_cbranch_scc1 L_rl_done_180
    s_mov_b64 exec, 1
    v_mov_b32 v2, 0
    s_mov_b32 s46, 0
    s_mov_b32 s43, 0
    s_mov_b32 s47, 0xa000000
L_rl_top_179:
    buffer_load_dword v3, v2, s[8:11], s47 offen sc1
    s_waitcnt vmcnt(0)
    s_nop 0
    v_readfirstlane_b32 s48, v3
    s_nop 3
    s_cmp_eq_u32 s48, s46
    s_cbranch_scc1 L_rl_same_181
    s_mov_b32 s46, s48
    s_mov_b32 s49, 0xa000680
    buffer_store_dword v3, v2, s[8:11], s49 offen sc1
    s_mov_b32 s49, 0xa000700
    buffer_store_dword v3, v2, s[8:11], s49 offen sc1
    s_mov_b32 s49, 0xa000780
    buffer_store_dword v3, v2, s[8:11], s49 offen sc1
    s_mov_b32 s49, 0xa000800
    buffer_store_dword v3, v2, s[8:11], s49 offen sc1
    s_cmp_ge_u32 s46, 63
    s_cbranch_scc1 L_rl_done_180
L_rl_same_181:
    s_add_u32 s43, s43, 1
    s_cmp_lt_u32 s43, 0x400000
    s_cbranch_scc0 L_rl_done_180
    s_sleep 1
    s_branch L_rl_top_179
L_rl_done_180:
    s_mov_b64 exec, -1
    s_branch L_end_1
L_end_1:
    s_endpgm
.section .rodata,"a"
.p2align 6
.amdhsa_kernel sequential_preLN__memory_aug_recurrent_mem_tr__dense_activation_relu__prompt_kernel
  .amdhsa_next_free_vgpr 512
  .amdhsa_next_free_sgpr 102
  .amdhsa_accum_offset 256
  .amdhsa_group_segment_fixed_size 0
  .amdhsa_kernarg_size 104
  .amdhsa_user_sgpr_count 2
  .amdhsa_user_sgpr_kernarg_segment_ptr 1
  .amdhsa_system_sgpr_workgroup_id_x 1
  .amdhsa_float_denorm_mode_32 3
  .amdhsa_float_denorm_mode_16_64 3
.end_amdhsa_kernel
```
